```python
import torch

def _softmax(x, axis=-1):
    return torch.softmax(x, dim=axis)
def _gelu(x):
    return torch.nn.functional.gelu(x, approximate="tanh")
def _silu(x):
    return torch.nn.functional.silu(x)
def _sigmoid(x):
    return torch.sigmoid(x)
def _layernorm(x, axis=-1, eps=1e-5):
    m = x.mean(dim=axis, keepdim=True)
    v = x.var(dim=axis, keepdim=True, unbiased=False)
    return (x - m) / torch.sqrt(v + eps)
def _scatter_add(tgt, idx, src, axis=0):
    return tgt.clone().index_add_(axis, idx, src)
def _segment_sum(src, seg, n):
    out = torch.zeros((n,) + src.shape[1:], dtype=src.dtype)
    return out.index_add_(0, seg, src)
def _pad(x, pw):
    flat = tuple(v for pair in reversed(pw) for v in pair)
    return torch.nn.functional.pad(x, flat)

kernel_name = 'concat_heads__spectral_fnet__grouped_kv_mqa__prompt'

def setup_inputs():

    _w = (lambda a: (lambda t: t.to(torch.bfloat16) if t.is_floating_point() else t)(torch.as_tensor(a)))
    def _A_setup():
        B, S, D = 1, 2048, 640
        ns = torch.arange(S)[:, None] * torch.arange(S)[None, :]
        nd = torch.arange(D)[:, None] * torch.arange(D)[None, :]
        Ws_re = torch.cos(-2.0 * torch.pi * ns / S).to(float)
        Ws_im = torch.sin(-2.0 * torch.pi * ns / S).to(float)
        Wd_re = torch.cos(-2.0 * torch.pi * nd / D).to(float)
        Wd_im = torch.sin(-2.0 * torch.pi * nd / D).to(float)
        return {
            "x": _w((lambda *s: torch.randn(*s, dtype=torch.bfloat16) * 0.05)(B, S, D)),
            "dft_seq_re": _w(Ws_re),
            "dft_seq_im": _w(Ws_im),
            "dft_hid_re": _w(Wd_re),
            "dft_hid_im": _w(Wd_im),
        }
    _A_in = _A_setup()

    def _B_setup():
        B, S, D, H = 1, 2048, 640, 32
        Dh = D // H
        return {
            "x": _w((lambda *s: torch.randn(*s, dtype=torch.bfloat16) * 0.05)(B, S, D)),
            "wq": _w((lambda *s: torch.randn(*s, dtype=torch.bfloat16) * 3.2)(D, H * Dh)),
            "wk": _w((lambda *s: torch.randn(*s, dtype=torch.bfloat16) * 3.2)(D, Dh)),
            "wv": _w((lambda *s: torch.randn(*s, dtype=torch.bfloat16) * 0.4)(D, Dh)),
            "wo": _w((lambda *s: torch.randn(*s, dtype=torch.bfloat16) * 0.4)(H * Dh, D)),
        }
    _B_in = _B_setup()

    return {
        "A_x": _A_in["x"],
        "A_dft_seq_re": _A_in["dft_seq_re"],
        "A_dft_seq_im": _A_in["dft_seq_im"],
        "A_dft_hid_re": _A_in["dft_hid_re"],
        "A_dft_hid_im": _A_in["dft_hid_im"],
        "B_x": _B_in["x"],
        "B_wq": _B_in["wq"],
        "B_wk": _B_in["wk"],
        "B_wv": _B_in["wv"],
        "B_wo": _B_in["wo"],
    }

def reference(A_x, A_dft_seq_re, A_dft_seq_im, A_dft_hid_re, A_dft_hid_im, B_x, B_wq, B_wk, B_wv, B_wo):
    def _A_ref(x, dft_seq_re, dft_seq_im, dft_hid_re, dft_hid_im):
        a = torch.einsum("bsd,ed->bse", x, dft_hid_re)
        b = torch.einsum("bsd,ed->bse", x, dft_hid_im)
        y = torch.einsum("ts,bse->bte", dft_seq_re, a) - torch.einsum("ts,bse->bte", dft_seq_im, b)
        return y

    def _B_ref(x, wq, wk, wv, wo):
        B, S, D = x.shape
        H = 32
        Dh = D // H
        q = (lambda x, *d: x.permute(*d))((x @ wq).reshape(B, S, H, Dh), 0, 2, 1, 3)
        k = x @ wk
        v = x @ wv
        scores = torch.einsum("bhqd,bkd->bhqk", q, k) * (Dh ** -0.5)
        p = _softmax(scores, axis=-1)
        o = torch.einsum("bhqk,bkd->bhqd", p, v)
        return (lambda x, *d: x.permute(*d))(o, 0, 2, 1, 3).reshape(B, S, H * Dh) @ wo

    a = _A_ref(A_x, A_dft_seq_re, A_dft_seq_im, A_dft_hid_re, A_dft_hid_im)
    b = _B_ref(B_x, B_wq, B_wk, B_wv, B_wo)
    return torch.concatenate([a, b], axis=-1)
```

```asm
; @launch grid=(256,1,1) block=(512,1,1) lds=163840
.amdgcn_target "amdgcn-amd-amdhsa--gfx950"
.text
.globl concat_heads__spectral_fnet__grouped_kv_mqa__prompt_kernel
.p2align 8
.type concat_heads__spectral_fnet__grouped_kv_mqa__prompt_kernel,@function
concat_heads__spectral_fnet__grouped_kv_mqa__prompt_kernel:
  s_cmp_ge_u32 s2, 256
  s_cbranch_scc1 L_end
  s_load_dwordx8 s[48:55], s[0:1], 40
  s_load_dwordx8 s[56:63], s[0:1], 72
  s_load_dwordx2 s[24:25], s[0:1], 0
  s_memrealtime s[68:69]
  s_getpc_b64 s[42:43]
L_pc:
  v_lshrrev_b32 v1, 6, v0
  v_and_b32 v0, 63, v0
  s_and_b32 s4, s2, 7
  v_readfirstlane_b32 s3, v1
  s_lshl_b32 s4, s4, 2
  v_lshlrev_b32 v2, 4, v0
  s_bfe_u32 s6, s2, 0x20003
  v_lshrrev_b32 v21, 3, v0
  s_add_u32 s4, s4, s6
  v_lshrrev_b32 v23, 4, v0
  s_lshr_b32 s5, s2, 5
  v_and_b32 v24, 7, v0
  s_and_b32 s7, s2, 0xf8
  s_add_u32 s7, s7, s3
  s_lshl_b32 s7, s7, 7
  v_mul_u32_u24 v22, ((L_tabend-L_pc-32768)/3)&0xffff80, v0
  v_add_u32 v22, s7, v22
  s_add_u32 s45, s6, s5
  s_mov_b64 exec, 15
  global_load_dword v255, v22, s[42:43]
  s_mov_b64 exec, -1
  v_xor_b32 v23, v23, v24
  s_mul_i32 s7, s45, 0x3334
  v_mul_u32_u24 v21, 0x500, v21
  s_lshr_b32 s7, s7, 16
  v_lshl_add_u32 v3, v23, 4, v21
  s_mul_i32 s7, s7, 5
  v_mov_b32 v17, 0
  v_mov_b32 v15, 0
  s_sub_u32 s45, s45, s7
  s_and_b32 s46, s5, 3
  s_lshl_b32 s7, s46, 1
  s_cmp_lt_u32 s5, 4
  s_cselect_b32 s47, s46, s7
  s_cselect_b32 s65, 4, 1
  s_mov_b32 s10, 2621440
  s_mov_b32 s11, 0x20000
  s_mov_b32 s22, 16777216
  s_mov_b32 s23, 0x20000
  s_cmp_ge_u32 s3, 4
  s_cbranch_scc1 L_loader
  s_and_b32 s6, s3, 1
  s_mul_i32 s6, s6, s65
  s_add_u32 s6, s6, s47
  s_and_b32 s7, s6, 1
  s_lshl_b32 s7, s7, 6
  v_xor_b32 v4, s7, v3
  s_lshl_b32 s7, s4, 3
  s_add_u32 s7, s7, s6
  s_mul_i32 s7, s7, 10240
  v_add_u32 v4, s7, v4
  s_lshr_b32 s36, s3, 1
  s_lshl_b32 s35, s36, 3
  s_add_u32 s35, s35, s6
  s_lshl_b32 s35, s35, 10
  s_add_u32 s35, s35, 25600
  s_lshl_b32 s36, s36, 7
  s_lshl_b32 s6, s45, 8
  s_add_u32 s36, s36, s6
  s_lshl_b32 m0, s3, 10
  s_mul_i32 s6, s45, 5120
  s_add_u32 s37, m0, s6
  s_mov_b32 s18, 25600
  s_mov_b32 s19, 0x20000
  s_cmp_lt_u32 s5, 4
  s_waitcnt lgkmcnt(0)
  s_cselect_b32 s16, s52, s54
  s_cselect_b32 s17, s53, s55
  s_lshr_b32 s6, s2, 3
  s_xor_b32 s7, s3, 1
  s_or_b32 s6, s6, s7
  s_cbranch_scc1 L_nonon
  s_or_b32 s68, s68, 1
  v_mov_b32 v16, s68
  s_mov_b64 exec, 1
  global_atomic_cmpswap v17, v[16:17], s[60:61] sc1
  s_mov_b64 exec, -1
L_nonon:
  buffer_load_dwordx4 v2, s[16:19], s37 offen  lds
  s_add_u32 m0, m0, 4096
  s_add_u32 s37, s37, 4096
  s_sub_u32 s7, s37, 25600
  s_min_u32 s37, s37, s7
  s_mov_b32 s8, s48
  s_mov_b32 s9, s49
  buffer_load_dwordx4 v2, s[16:19], s37 offen  lds
  s_add_u32 m0, m0, 4096
  s_add_u32 s37, s37, 4096
  s_sub_u32 s7, s37, 25600
  s_min_u32 s37, s37, s7
  buffer_load_dwordx4 v2, s[16:19], s37 offen  lds
  s_add_u32 m0, m0, 4096
  s_add_u32 s37, s37, 4096
  s_sub_u32 s7, s37, 25600
  s_min_u32 s37, s37, s7
  buffer_load_dwordx4 v2, s[16:19], s37 offen  lds
  s_add_u32 m0, m0, 4096
  s_add_u32 s37, s37, 4096
  s_sub_u32 s7, s37, 25600
  s_min_u32 s37, s37, s7
  buffer_load_dwordx4 v2, s[16:19], s37 offen  lds
  s_add_u32 m0, m0, 4096
  s_add_u32 s37, s37, 4096
  s_sub_u32 s7, s37, 25600
  s_min_u32 s37, s37, s7
  buffer_load_dwordx4 v2, s[16:19], s37 offen  lds
  s_add_u32 m0, m0, 4096
  s_add_u32 s37, s37, 4096
  s_sub_u32 s7, s37, 25600
  s_min_u32 s37, s37, s7
  s_cmp_lg_u32 s3, 0
  s_cbranch_scc1 L_nw0
  buffer_load_dwordx4 v2, s[16:19], s37 offen  lds
L_nw0:
  s_mov_b32 m0, s35
  s_nop 0
  buffer_load_dwordx4 v4, s[8:11], s36 offen  lds
  s_add_u32 m0, m0, 16384
  s_add_u32 s36, s36, 256
  s_sub_u32 s7, s36, 1280
  s_min_u32 s36, s36, s7
  buffer_load_dwordx4 v4, s[8:11], s36 offen  lds
  s_add_u32 m0, m0, 16384
  s_add_u32 s36, s36, 256
  s_sub_u32 s7, s36, 1280
  s_min_u32 s36, s36, s7
  buffer_load_dwordx4 v4, s[8:11], s36 offen  lds
  s_add_u32 m0, m0, 16384
  s_add_u32 s36, s36, 256
  s_sub_u32 s7, s36, 1280
  s_min_u32 s36, s36, s7
  buffer_load_dwordx4 v4, s[8:11], s36 offen  lds
  s_add_u32 m0, m0, 16384
  s_add_u32 s36, s36, 256
  s_sub_u32 s7, s36, 1280
  s_min_u32 s36, s36, s7
  buffer_load_dwordx4 v4, s[8:11], s36 offen  lds
  s_mov_b32 s28, s56
  s_mov_b32 s29, s57
  s_mov_b32 s32, s58
  s_mov_b32 s33, s59
  s_mov_b32 s40, s60
  s_mov_b32 s41, s61
  s_mov_b32 s20, s62
  s_mov_b32 s21, s63
  v_and_b32 v21, 15, v0
  v_lshrrev_b32 v22, 4, v0
  s_and_b32 s6, s3, 1
  s_lshl_b32 s7, s6, 12
  s_add_u32 s7, s7, 25600
  v_lshrrev_b32 v24, 1, v21
  v_xor_b32 v23, v22, v24
  v_lshl_add_u32 v24, v21, 7, s7
  v_lshl_add_u32 v8, v23, 4, v24
  v_xor_b32 v7, 64, v8
  s_lshr_b32 s66, s3, 1
  s_mul_i32 s66, s66, 96
  s_add_u32 s7, s66, 107520
  v_lshrrev_b32 v23, 2, v0
  v_mul_u32_u24 v23, 320, v23
  v_and_b32 v25, 3, v0
  v_lshl_add_u32 v23, v25, 3, v23
  v_and_b32 v24, 1, v22
  v_mul_u32_u24 v24, 160, v24
  v_add3_u32 v9, v23, v24, s7
  s_add_u32 s7, s7, 160
  v_sub_u32 v23, v23, v24
  v_add_u32 v10, s7, v23
  s_mul_i32 s7, s6, 5376
  s_add_u32 s7, s7, s66
  s_add_u32 s7, s7, 107520
  v_mul_u32_u24 v23, 168, v21
  v_lshl_add_u32 v23, v22, 3, v23
  v_add_u32 v13, s7, v23
  s_lshr_b32 s67, s3, 1
  s_lshl_b32 s7, s67, 11
  v_add_u32 v8, s7, v8
  v_add_u32 v7, s7, v7
  s_mul_i32 s7, s67, 4294963200
  s_add_u32 s7, s7, 2048
  v_add_u32 v32, s7, v8
  v_add_u32 v33, s7, v7
  s_sub_u32 s7, 64, s66
  v_add_u32 v11, s7, v9
  v_add_u32 v12, s7, v10
  s_mul_i32 s66, s67, 2688
  v_add_u32 v34, s66, v13
  v_add_u32 v35, s7, v34
  s_sub_u32 s66, 2688, s66
  v_add_u32 v13, s66, v13
  s_mov_b32 s48, 8
  s_cmp_lt_u32 s3, 2
  s_cbranch_scc1 L_nokv
  s_mov_b32 s48, 0
  v_lshrrev_b32 v26, 3, v21
  v_and_b32 v27, 7, v21
  v_mul_u32_u24 v23, s65, v26
  v_add_u32 v23, s47, v23
  v_and_b32 v24, 1, v23
  v_lshlrev_b32 v23, 10, v23
  v_lshl_add_u32 v23, v24, 6, v23
  v_lshl_add_u32 v23, v27, 7, v23
  v_lshrrev_b32 v24, 1, v27
  v_xor_b32 v24, v24, v22
  v_lshl_add_u32 v23, v24, 4, v23
  v_add_u32 v18, 25600, v23
  v_xor_b32 v19, 64, v18
  v_bfe_u32 v23, v0, 2, 2
  v_lshl_add_u32 v23, v22, 3, v23
  v_mul_u32_u24 v23, 40, v23
  s_cmp_eq_u32 s6, 0
  s_cselect_b64 vcc, -1, 0
  v_cndmask_b32 v25, 4, v25, vcc
  v_lshl_add_u32 v20, v25, 3, v23
  s_lshr_b32 s66, s4, 1
  s_mul_i32 s66, s66, 10240
  s_and_b32 s67, s4, 1
  v_lshrrev_b32 v24, 1, v22
  v_and_b32 v25, 1, v22
  s_cmp_ge_u32 s5, 4
  s_cbranch_scc1 L_kvV
  v_lshlrev_b32 v27, 4, v27
  v_lshl_add_u32 v23, v26, 11, v27
  v_lshl_add_u32 v23, v24, 9, v23
  v_lshl_add_u32 v23, v25, 3, v23
  v_lshl_add_u32 v27, v26, 3, v27
  v_cndmask_b32 v15, v27, v23, vcc
  s_lshl_b32 s7, s67, 9
  s_add_u32 s7, s7, 4096
  s_lshl_b32 s67, s67, 10
  s_cmp_eq_u32 s6, 0
  s_cselect_b32 s67, s67, s7
  s_cselect_b32 s64, -1, 0xffff
  s_cselect_b32 s65, -1, 0
  s_lshl_b32 s7, s46, 7
  s_add_u32 s66, s66, s7
  s_add_u32 s66, s66, s67
  s_waitcnt vmcnt(0)
  s_barrier
  global_load_dword v16, v17, s[40:41] sc1
  ds_read_b128 v[84:87], v18 offset:0
  ds_read_b64_tr_b16 v[88:89], v20 offset:0
  ds_read_b64_tr_b16 v[90:91], v20 offset:160
  ds_read_b128 v[92:95], v19 offset:0
  ds_read_b64_tr_b16 v[96:97], v20 offset:1280
  ds_read_b64_tr_b16 v[98:99], v20 offset:1440
  ds_read_b128 v[100:103], v18 offset:8192
  ds_read_b64_tr_b16 v[104:105], v20 offset:2560
  ds_read_b64_tr_b16 v[106:107], v20 offset:2720
  ds_read_b128 v[108:111], v19 offset:8192
  ds_read_b64_tr_b16 v[112:113], v20 offset:3840
  ds_read_b64_tr_b16 v[114:115], v20 offset:4000
  ds_read_b128 v[116:119], v18 offset:16384
  ds_read_b64_tr_b16 v[120:121], v20 offset:5120
  ds_read_b64_tr_b16 v[122:123], v20 offset:5280
  s_waitcnt lgkmcnt(12)
  v_mfma_f32_16x16x32_bf16 v[28:31], v[88:91], v[84:87], 0
  ds_read_b128 v[84:87], v19 offset:16384
  ds_read_b64_tr_b16 v[88:89], v20 offset:6400
  ds_read_b64_tr_b16 v[90:91], v20 offset:6560
  s_waitcnt lgkmcnt(12)
  v_mfma_f32_16x16x32_bf16 v[28:31], v[96:99], v[92:95], v[28:31]
  ds_read_b128 v[92:95], v18 offset:24576
  ds_read_b64_tr_b16 v[96:97], v20 offset:7680
  ds_read_b64_tr_b16 v[98:99], v20 offset:7840
  s_waitcnt lgkmcnt(12)
  v_mfma_f32_16x16x32_bf16 v[28:31], v[104:107], v[100:103], v[28:31]
  ds_read_b128 v[100:103], v19 offset:24576
  ds_read_b64_tr_b16 v[104:105], v20 offset:8960
  ds_read_b64_tr_b16 v[106:107], v20 offset:9120
  s_waitcnt lgkmcnt(12)
  v_mfma_f32_16x16x32_bf16 v[28:31], v[112:115], v[108:111], v[28:31]
  ds_read_b128 v[108:111], v18 offset:32768
  ds_read_b64_tr_b16 v[112:113], v20 offset:10240
  ds_read_b64_tr_b16 v[114:115], v20 offset:10400
  s_waitcnt lgkmcnt(12)
  v_mfma_f32_16x16x32_bf16 v[28:31], v[120:123], v[116:119], v[28:31]
  ds_read_b128 v[116:119], v19 offset:32768
  ds_read_b64_tr_b16 v[120:121], v20 offset:11520
  ds_read_b64_tr_b16 v[122:123], v20 offset:11680
  s_waitcnt lgkmcnt(12)
  v_mfma_f32_16x16x32_bf16 v[28:31], v[88:91], v[84:87], v[28:31]
  ds_read_b128 v[84:87], v18 offset:40960
  ds_read_b64_tr_b16 v[88:89], v20 offset:12800
  ds_read_b64_tr_b16 v[90:91], v20 offset:12960
  s_waitcnt lgkmcnt(12)
  v_mfma_f32_16x16x32_bf16 v[28:31], v[96:99], v[92:95], v[28:31]
  ds_read_b128 v[92:95], v19 offset:40960
  ds_read_b64_tr_b16 v[96:97], v20 offset:14080
  ds_read_b64_tr_b16 v[98:99], v20 offset:14240
  s_waitcnt lgkmcnt(12)
  v_mfma_f32_16x16x32_bf16 v[28:31], v[104:107], v[100:103], v[28:31]
  ds_read_b128 v[100:103], v18 offset:49152
  ds_read_b64_tr_b16 v[104:105], v20 offset:15360
  ds_read_b64_tr_b16 v[106:107], v20 offset:15520
  s_waitcnt lgkmcnt(12)
  v_mfma_f32_16x16x32_bf16 v[28:31], v[112:115], v[108:111], v[28:31]
  ds_read_b128 v[108:111], v19 offset:49152
  ds_read_b64_tr_b16 v[112:113], v20 offset:16640
  ds_read_b64_tr_b16 v[114:115], v20 offset:16800
  s_waitcnt lgkmcnt(12)
  v_mfma_f32_16x16x32_bf16 v[28:31], v[120:123], v[116:119], v[28:31]
  ds_read_b128 v[116:119], v18 offset:57344
  ds_read_b64_tr_b16 v[120:121], v20 offset:17920
  ds_read_b64_tr_b16 v[122:123], v20 offset:18080
  s_waitcnt lgkmcnt(12)
  v_mfma_f32_16x16x32_bf16 v[28:31], v[88:91], v[84:87], v[28:31]
  ds_read_b128 v[84:87], v19 offset:57344
  ds_read_b64_tr_b16 v[88:89], v20 offset:19200
  ds_read_b64_tr_b16 v[90:91], v20 offset:19360
  s_waitcnt lgkmcnt(12)
  v_mfma_f32_16x16x32_bf16 v[28:31], v[96:99], v[92:95], v[28:31]
  v_add_u32 v18, 0x10000, v18
  v_add_u32 v19, 0x10000, v19
  ds_read_b128 v[92:95], v18 offset:0
  ds_read_b64_tr_b16 v[96:97], v20 offset:20480
  ds_read_b64_tr_b16 v[98:99], v20 offset:20640
  s_waitcnt lgkmcnt(12)
  v_mfma_f32_16x16x32_bf16 v[28:31], v[104:107], v[100:103], v[28:31]
  ds_read_b128 v[100:103], v19 offset:0
  ds_read_b64_tr_b16 v[104:105], v20 offset:21760
  ds_read_b64_tr_b16 v[106:107], v20 offset:21920
  s_waitcnt lgkmcnt(12)
  v_mfma_f32_16x16x32_bf16 v[28:31], v[112:115], v[108:111], v[28:31]
  ds_read_b128 v[108:111], v18 offset:8192
  ds_read_b64_tr_b16 v[112:113], v20 offset:23040
  ds_read_b64_tr_b16 v[114:115], v20 offset:23200
  s_waitcnt lgkmcnt(12)
  v_mfma_f32_16x16x32_bf16 v[28:31], v[120:123], v[116:119], v[28:31]
  ds_read_b128 v[116:119], v19 offset:8192
  ds_read_b64_tr_b16 v[120:121], v20 offset:24320
  ds_read_b64_tr_b16 v[122:123], v20 offset:24480
  s_waitcnt lgkmcnt(12)
  v_mfma_f32_16x16x32_bf16 v[28:31], v[88:91], v[84:87], v[28:31]
  s_waitcnt lgkmcnt(9)
  v_mfma_f32_16x16x32_bf16 v[28:31], v[96:99], v[92:95], v[28:31]
  s_waitcnt lgkmcnt(6)
  v_mfma_f32_16x16x32_bf16 v[28:31], v[104:107], v[100:103], v[28:31]
  s_waitcnt lgkmcnt(3)
  v_mfma_f32_16x16x32_bf16 v[28:31], v[112:115], v[108:111], v[28:31]
  s_waitcnt lgkmcnt(0)
  v_mfma_f32_16x16x32_bf16 v[28:31], v[120:123], v[116:119], v[28:31]
  s_branch L_kvW
L_kvV:
  s_cmp_eq_u32 s6, 0
  s_cselect_b32 s7, 0x180, 64
  s_cselect_b32 s64, -1, 0x000f000f
  s_mov_b32 s65, s64
  v_mul_u32_u24 v24, s7, v24
  v_lshl_add_u32 v24, v21, 4, v24
  v_lshl_add_u32 v15, v25, 3, v24
  s_and_b32 s7, s46, 2
  s_add_u32 s67, s67, s7
  s_lshl_b32 s67, s67, 1
  s_and_b32 s7, s46, 1
  s_add_u32 s67, s67, s7
  s_mul_i32 s67, s67, 640
  s_lshl_b32 s7, s6, 8
  s_add_u32 s66, s66, s7
  s_add_u32 s66, s66, s67
  s_add_u32 s66, s66, 5120
  s_waitcnt vmcnt(0)
  s_barrier
  global_load_dword v16, v17, s[40:41] sc1
  ds_read_b128 v[84:87], v18 offset:0
  ds_read_b64_tr_b16 v[88:89], v20 offset:0
  ds_read_b64_tr_b16 v[90:91], v20 offset:160
  ds_read_b128 v[92:95], v19 offset:0
  ds_read_b64_tr_b16 v[96:97], v20 offset:1280
  ds_read_b64_tr_b16 v[98:99], v20 offset:1440
  ds_read_b128 v[100:103], v18 offset:8192
  ds_read_b64_tr_b16 v[104:105], v20 offset:2560
  ds_read_b64_tr_b16 v[106:107], v20 offset:2720
  ds_read_b128 v[108:111], v19 offset:8192
  ds_read_b64_tr_b16 v[112:113], v20 offset:3840
  ds_read_b64_tr_b16 v[114:115], v20 offset:4000
  ds_read_b128 v[116:119], v18 offset:16384
  ds_read_b64_tr_b16 v[120:121], v20 offset:5120
  ds_read_b64_tr_b16 v[122:123], v20 offset:5280
  s_waitcnt lgkmcnt(12)
  v_mfma_f32_16x16x32_bf16 v[28:31], v[84:87], v[88:91], 0
  ds_read_b128 v[84:87], v19 offset:16384
  ds_read_b64_tr_b16 v[88:89], v20 offset:6400
  ds_read_b64_tr_b16 v[90:91], v20 offset:6560
  s_waitcnt lgkmcnt(12)
  v_mfma_f32_16x16x32_bf16 v[28:31], v[92:95], v[96:99], v[28:31]
  ds_read_b128 v[92:95], v18 offset:24576
  ds_read_b64_tr_b16 v[96:97], v20 offset:7680
  ds_read_b64_tr_b16 v[98:99], v20 offset:7840
  s_waitcnt lgkmcnt(12)
  v_mfma_f32_16x16x32_bf16 v[28:31], v[100:103], v[104:107], v[28:31]
  ds_read_b128 v[100:103], v19 offset:24576
  ds_read_b64_tr_b16 v[104:105], v20 offset:8960
  ds_read_b64_tr_b16 v[106:107], v20 offset:9120
  s_waitcnt lgkmcnt(12)
  v_mfma_f32_16x16x32_bf16 v[28:31], v[108:111], v[112:115], v[28:31]
  ds_read_b128 v[108:111], v18 offset:32768
  ds_read_b64_tr_b16 v[112:113], v20 offset:10240
  ds_read_b64_tr_b16 v[114:115], v20 offset:10400
  s_waitcnt lgkmcnt(12)
  v_mfma_f32_16x16x32_bf16 v[28:31], v[116:119], v[120:123], v[28:31]
  ds_read_b128 v[116:119], v19 offset:32768
  ds_read_b64_tr_b16 v[120:121], v20 offset:11520
  ds_read_b64_tr_b16 v[122:123], v20 offset:11680
  s_waitcnt lgkmcnt(12)
  v_mfma_f32_16x16x32_bf16 v[28:31], v[84:87], v[88:91], v[28:31]
  ds_read_b128 v[84:87], v18 offset:40960
  ds_read_b64_tr_b16 v[88:89], v20 offset:12800
  ds_read_b64_tr_b16 v[90:91], v20 offset:12960
  s_waitcnt lgkmcnt(12)
  v_mfma_f32_16x16x32_bf16 v[28:31], v[92:95], v[96:99], v[28:31]
  ds_read_b128 v[92:95], v19 offset:40960
  ds_read_b64_tr_b16 v[96:97], v20 offset:14080
  ds_read_b64_tr_b16 v[98:99], v20 offset:14240
  s_waitcnt lgkmcnt(12)
  v_mfma_f32_16x16x32_bf16 v[28:31], v[100:103], v[104:107], v[28:31]
  ds_read_b128 v[100:103], v18 offset:49152
  ds_read_b64_tr_b16 v[104:105], v20 offset:15360
  ds_read_b64_tr_b16 v[106:107], v20 offset:15520
  s_waitcnt lgkmcnt(12)
  v_mfma_f32_16x16x32_bf16 v[28:31], v[108:111], v[112:115], v[28:31]
  ds_read_b128 v[108:111], v19 offset:49152
  ds_read_b64_tr_b16 v[112:113], v20 offset:16640
  ds_read_b64_tr_b16 v[114:115], v20 offset:16800
  s_waitcnt lgkmcnt(12)
  v_mfma_f32_16x16x32_bf16 v[28:31], v[116:119], v[120:123], v[28:31]
  ds_read_b128 v[116:119], v18 offset:57344
  ds_read_b64_tr_b16 v[120:121], v20 offset:17920
  ds_read_b64_tr_b16 v[122:123], v20 offset:18080
  s_waitcnt lgkmcnt(12)
  v_mfma_f32_16x16x32_bf16 v[28:31], v[84:87], v[88:91], v[28:31]
  ds_read_b128 v[84:87], v19 offset:57344
  ds_read_b64_tr_b16 v[88:89], v20 offset:19200
  ds_read_b64_tr_b16 v[90:91], v20 offset:19360
  s_waitcnt lgkmcnt(12)
  v_mfma_f32_16x16x32_bf16 v[28:31], v[92:95], v[96:99], v[28:31]
  v_add_u32 v18, 0x10000, v18
  v_add_u32 v19, 0x10000, v19
  ds_read_b128 v[92:95], v18 offset:0
  ds_read_b64_tr_b16 v[96:97], v20 offset:20480
  ds_read_b64_tr_b16 v[98:99], v20 offset:20640
  s_waitcnt lgkmcnt(12)
  v_mfma_f32_16x16x32_bf16 v[28:31], v[100:103], v[104:107], v[28:31]
  ds_read_b128 v[100:103], v19 offset:0
  ds_read_b64_tr_b16 v[104:105], v20 offset:21760
  ds_read_b64_tr_b16 v[106:107], v20 offset:21920
  s_waitcnt lgkmcnt(12)
  v_mfma_f32_16x16x32_bf16 v[28:31], v[108:111], v[112:115], v[28:31]
  ds_read_b128 v[108:111], v18 offset:8192
  ds_read_b64_tr_b16 v[112:113], v20 offset:23040
  ds_read_b64_tr_b16 v[114:115], v20 offset:23200
  s_waitcnt lgkmcnt(12)
  v_mfma_f32_16x16x32_bf16 v[28:31], v[116:119], v[120:123], v[28:31]
  ds_read_b128 v[116:119], v19 offset:8192
  ds_read_b64_tr_b16 v[120:121], v20 offset:24320
  ds_read_b64_tr_b16 v[122:123], v20 offset:24480
  s_waitcnt lgkmcnt(12)
  v_mfma_f32_16x16x32_bf16 v[28:31], v[84:87], v[88:91], v[28:31]
  s_waitcnt lgkmcnt(9)
  v_mfma_f32_16x16x32_bf16 v[28:31], v[92:95], v[96:99], v[28:31]
  s_waitcnt lgkmcnt(6)
  v_mfma_f32_16x16x32_bf16 v[28:31], v[100:103], v[104:107], v[28:31]
  s_waitcnt lgkmcnt(3)
  v_mfma_f32_16x16x32_bf16 v[28:31], v[108:111], v[112:115], v[28:31]
  s_waitcnt lgkmcnt(0)
  v_mfma_f32_16x16x32_bf16 v[28:31], v[116:119], v[120:123], v[28:31]
L_kvW:
  s_mov_b32 s38, s66
  s_mov_b64 s[36:37], s[64:65]
  s_cmp_lt_u32 s5, 4
  s_cselect_b32 s6, 0x3ea52b5c, 1.0
  s_mov_b32 s7, s6
  s_nop 2
  v_pk_mul_f32 v[28:29], v[28:29], s[6:7]
  v_pk_mul_f32 v[30:31], v[30:31], s[6:7]
  v_cvt_pk_bf16_f32 v28, v28, v29
  v_cvt_pk_bf16_f32 v29, v30, v31
  s_mov_b64 exec, s[64:65]
  buffer_store_dwordx2 v[28:29], v15, s[20:23], s66 offen sc1
  s_mov_b64 exec, -1
  s_branch L_kvE
L_nokv:
  s_waitcnt vmcnt(0)
  s_barrier
L_kvE:
  s_barrier
  ds_read_b128 v[84:87], v8 offset:0
  ds_read_b128 v[88:91], v32 offset:0
  ds_read_b64_tr_b16 v[92:93], v9 offset:0
  ds_read_b64_tr_b16 v[94:95], v10 offset:0
  ds_read_b64_tr_b16 v[96:97], v9 offset:32
  ds_read_b64_tr_b16 v[98:99], v10 offset:32
  ds_read_b64_tr_b16 v[100:101], v11 offset:0
  ds_read_b64_tr_b16 v[102:103], v12 offset:0
  ds_read_b128 v[104:107], v7 offset:0
  ds_read_b128 v[108:111], v33 offset:0
  ds_read_b64_tr_b16 v[112:113], v9 offset:5120
  ds_read_b64_tr_b16 v[114:115], v10 offset:5120
  ds_read_b64_tr_b16 v[116:117], v9 offset:5152
  ds_read_b64_tr_b16 v[118:119], v10 offset:5152
  ds_read_b64_tr_b16 v[120:121], v11 offset:5120
  ds_read_b64_tr_b16 v[122:123], v12 offset:5120
  s_and_b32 s57, s2, 7
  s_lshl_b32 s57, s57, 3
  s_bfe_u32 s6, s2, 0x30003
  s_add_u32 s57, s57, s6
  s_lshr_b32 s58, s2, 6
  s_lshr_b32 s60, s58, 1
  s_sub_u32 s6, 128, s57
  s_cmp_eq_u32 s57, 0
  s_cselect_b32 s6, 64, s6
  s_cselect_b32 s66, 0, 512
  s_mul_i32 s7, s66, 3
  s_cmp_eq_u32 s60, 0
  s_cselect_b32 s59, s57, s6
  s_cselect_b32 s66, s7, s66
  s_getreg_b32 s68, hwreg(HW_REG_IB_STS, 0, 4)
  s_or_b32 s68, s68, s48
  s_cbranch_scc1 L_nf0
  s_call_b64 s[52:53], L_flag1
L_nf0:
  s_waitcnt lgkmcnt(0)
  s_barrier
  s_getreg_b32 s68, hwreg(HW_REG_IB_STS, 0, 4)
  s_or_b32 s68, s68, s48
  s_cbranch_scc1 L_mf1
  s_call_b64 s[52:53], L_flag1
L_mf1:
  ds_read_b128 v[124:127], v8 offset:8192
  v_mfma_f32_16x16x32_bf16 v[200:203], v[92:95], v[84:87], 0
  ds_read_b128 v[128:131], v32 offset:8192
  ds_read_b64_tr_b16 v[132:133], v9 offset:10240
  v_mfma_f32_16x16x32_bf16 v[204:207], v[92:95], v[88:91], 0
  ds_read_b64_tr_b16 v[134:135], v10 offset:10240
  v_mfma_f32_16x16x32_bf16 v[208:211], v[96:99], v[84:87], 0
  ds_read_b64_tr_b16 v[136:137], v9 offset:10272
  ds_read_b64_tr_b16 v[138:139], v10 offset:10272
  v_mfma_f32_16x16x32_bf16 v[212:215], v[96:99], v[88:91], 0
  ds_read_b64_tr_b16 v[140:141], v11 offset:10240
  ds_read_b64_tr_b16 v[142:143], v12 offset:10240
  v_mfma_f32_16x16x32_bf16 v[216:219], v[100:103], v[84:87], 0
  ds_read_b128 v[144:147], v7 offset:8192
  v_mfma_f32_16x16x32_bf16 v[200:203], v[112:115], v[104:107], v[200:203]
  ds_read_b128 v[148:151], v33 offset:8192
  ds_read_b64_tr_b16 v[152:153], v9 offset:15360
  v_mfma_f32_16x16x32_bf16 v[204:207], v[112:115], v[108:111], v[204:207]
  ds_read_b64_tr_b16 v[154:155], v10 offset:15360
  v_mfma_f32_16x16x32_bf16 v[208:211], v[116:119], v[104:107], v[208:211]
  ds_read_b64_tr_b16 v[156:157], v9 offset:15392
  ds_read_b64_tr_b16 v[158:159], v10 offset:15392
  v_mfma_f32_16x16x32_bf16 v[212:215], v[116:119], v[108:111], v[212:215]
  ds_read_b64_tr_b16 v[160:161], v11 offset:15360
  ds_read_b64_tr_b16 v[162:163], v12 offset:15360
  v_mfma_f32_16x16x32_bf16 v[216:219], v[120:123], v[104:107], v[216:219]
  s_and_b32 s6, s58, 1
  s_lshl_b32 s6, s6, 10
  s_add_u32 s59, s59, s6
  v_and_b32 v21, 27, v0
  v_cmp_eq_u32 vcc, 24, v21
  v_mov_b32 v21, 0x3f803f80
  s_mov_b32 s64, 0xfffff
  s_mov_b32 s65, 0xfffff
  v_cndmask_b32 v164, 0, v21, vcc
  v_cndmask_b32 v165, 0, v21, vcc
  v_mov_b64 v[166:167], v[164:165]
  v_mov_b64 v[168:169], v[164:165]
  v_mov_b64 v[170:171], v[164:165]
  v_mov_b64 v[172:173], v[164:165]
  v_mov_b64 v[174:175], v[164:165]
  s_getreg_b32 s68, hwreg(HW_REG_IB_STS, 0, 4)
  s_or_b32 s68, s68, s48
  s_cbranch_scc1 L_nf1
  s_call_b64 s[52:53], L_flag1
L_nf1:
  s_waitcnt lgkmcnt(0)
  s_barrier
  s_getreg_b32 s68, hwreg(HW_REG_IB_STS, 0, 4)
  s_or_b32 s68, s68, s48
  s_cbranch_scc1 L_mf2
  s_call_b64 s[52:53], L_flag1
L_mf2:
  ds_read_b128 v[84:87], v8 offset:16384
  v_mfma_f32_16x16x32_bf16 v[200:203], v[132:135], v[124:127], v[200:203]
  ds_read_b128 v[88:91], v32 offset:16384
  ds_read_b64_tr_b16 v[92:93], v9 offset:20480
  v_mfma_f32_16x16x32_bf16 v[204:207], v[132:135], v[128:131], v[204:207]
  ds_read_b64_tr_b16 v[94:95], v10 offset:20480
  v_mfma_f32_16x16x32_bf16 v[208:211], v[136:139], v[124:127], v[208:211]
  ds_read_b64_tr_b16 v[96:97], v9 offset:20512
  ds_read_b64_tr_b16 v[98:99], v10 offset:20512
  v_mfma_f32_16x16x32_bf16 v[212:215], v[136:139], v[128:131], v[212:215]
  ds_read_b64_tr_b16 v[100:101], v11 offset:20480
  ds_read_b64_tr_b16 v[102:103], v12 offset:20480
  v_mfma_f32_16x16x32_bf16 v[216:219], v[140:143], v[124:127], v[216:219]
  ds_read_b128 v[104:107], v7 offset:16384
  v_mfma_f32_16x16x32_bf16 v[200:203], v[152:155], v[144:147], v[200:203]
  ds_read_b128 v[108:111], v33 offset:16384
  ds_read_b64_tr_b16 v[112:113], v9 offset:25600
  v_mfma_f32_16x16x32_bf16 v[204:207], v[152:155], v[148:151], v[204:207]
  ds_read_b64_tr_b16 v[114:115], v10 offset:25600
  v_mfma_f32_16x16x32_bf16 v[208:211], v[156:159], v[144:147], v[208:211]
  ds_read_b64_tr_b16 v[116:117], v9 offset:25632
  ds_read_b64_tr_b16 v[118:119], v10 offset:25632
  v_mfma_f32_16x16x32_bf16 v[212:215], v[156:159], v[148:151], v[212:215]
  ds_read_b64_tr_b16 v[120:121], v11 offset:25600
  ds_read_b64_tr_b16 v[122:123], v12 offset:25600
  v_mfma_f32_16x16x32_bf16 v[216:219], v[160:163], v[144:147], v[216:219]
  v_mov_b64 v[176:177], v[164:165]
  v_mov_b64 v[178:179], v[164:165]
  v_mov_b64 v[180:181], v[164:165]
  v_mov_b64 v[182:183], v[164:165]
  v_mov_b64 v[184:185], v[164:165]
  v_mov_b64 v[186:187], v[164:165]
  v_mov_b64 v[188:189], v[164:165]
  v_mov_b64 v[190:191], v[164:165]
  v_mov_b64 v[192:193], v[164:165]
  v_mov_b64 v[194:195], v[164:165]
  v_mov_b64 v[52:53], 0
  v_mov_b64 v[54:55], 0
  v_mov_b64 v[56:57], 0
  v_mov_b64 v[58:59], 0
  v_mov_b64 v[60:61], 0
  v_mov_b64 v[62:63], 0
  v_mov_b64 v[64:65], 0
  v_mov_b64 v[66:67], 0
  s_getreg_b32 s68, hwreg(HW_REG_IB_STS, 0, 4)
  s_or_b32 s68, s68, s48
  s_cbranch_scc1 L_nf2
  s_call_b64 s[52:53], L_flag1
L_nf2:
  s_waitcnt lgkmcnt(0)
  s_barrier
  s_getreg_b32 s68, hwreg(HW_REG_IB_STS, 0, 4)
  s_or_b32 s68, s68, s48
  s_cbranch_scc1 L_mf3
  s_call_b64 s[52:53], L_flag1
L_mf3:
  ds_read_b128 v[124:127], v8 offset:24576
  v_mfma_f32_16x16x32_bf16 v[200:203], v[92:95], v[84:87], v[200:203]
  ds_read_b128 v[128:131], v32 offset:24576
  ds_read_b64_tr_b16 v[132:133], v9 offset:30720
  v_mfma_f32_16x16x32_bf16 v[204:207], v[92:95], v[88:91], v[204:207]
  ds_read_b64_tr_b16 v[134:135], v10 offset:30720
  v_mfma_f32_16x16x32_bf16 v[208:211], v[96:99], v[84:87], v[208:211]
  ds_read_b64_tr_b16 v[136:137], v9 offset:30752
  ds_read_b64_tr_b16 v[138:139], v10 offset:30752
  v_mfma_f32_16x16x32_bf16 v[212:215], v[96:99], v[88:91], v[212:215]
  ds_read_b64_tr_b16 v[140:141], v11 offset:30720
  ds_read_b64_tr_b16 v[142:143], v12 offset:30720
  v_mfma_f32_16x16x32_bf16 v[216:219], v[100:103], v[84:87], v[216:219]
  ds_read_b128 v[144:147], v7 offset:24576
  v_mfma_f32_16x16x32_bf16 v[200:203], v[112:115], v[104:107], v[200:203]
  ds_read_b128 v[148:151], v33 offset:24576
  ds_read_b64_tr_b16 v[152:153], v9 offset:35840
  v_mfma_f32_16x16x32_bf16 v[204:207], v[112:115], v[108:111], v[204:207]
  ds_read_b64_tr_b16 v[154:155], v10 offset:35840
  v_mfma_f32_16x16x32_bf16 v[208:211], v[116:119], v[104:107], v[208:211]
  ds_read_b64_tr_b16 v[156:157], v9 offset:35872
  ds_read_b64_tr_b16 v[158:159], v10 offset:35872
  v_mfma_f32_16x16x32_bf16 v[212:215], v[116:119], v[108:111], v[212:215]
  ds_read_b64_tr_b16 v[160:161], v11 offset:35840
  ds_read_b64_tr_b16 v[162:163], v12 offset:35840
  v_mfma_f32_16x16x32_bf16 v[216:219], v[120:123], v[104:107], v[216:219]
  v_mov_b64 v[68:69], 0
  v_mov_b64 v[70:71], 0
  v_mov_b64 v[72:73], 0
  v_mov_b64 v[74:75], 0
  v_mov_b64 v[76:77], 0
  v_mov_b64 v[78:79], 0
  v_mov_b64 v[80:81], 0
  v_mov_b64 v[82:83], 0
  s_getreg_b32 s68, hwreg(HW_REG_IB_STS, 0, 4)
  s_or_b32 s68, s68, s48
  s_cbranch_scc1 L_nf3
  s_call_b64 s[52:53], L_flag1
L_nf3:
  s_waitcnt lgkmcnt(0)
  s_barrier
  s_getreg_b32 s68, hwreg(HW_REG_IB_STS, 0, 4)
  s_or_b32 s68, s68, s48
  s_cbranch_scc1 L_mf4
  s_call_b64 s[52:53], L_flag1
L_mf4:
  ds_read_b128 v[84:87], v8 offset:32768
  v_mfma_f32_16x16x32_bf16 v[200:203], v[132:135], v[124:127], v[200:203]
  ds_read_b128 v[88:91], v32 offset:32768
  ds_read_b64_tr_b16 v[92:93], v9 offset:40960
  v_mfma_f32_16x16x32_bf16 v[204:207], v[132:135], v[128:131], v[204:207]
  ds_read_b64_tr_b16 v[94:95], v10 offset:40960
  v_mfma_f32_16x16x32_bf16 v[208:211], v[136:139], v[124:127], v[208:211]
  ds_read_b64_tr_b16 v[96:97], v9 offset:40992
  ds_read_b64_tr_b16 v[98:99], v10 offset:40992
  v_mfma_f32_16x16x32_bf16 v[212:215], v[136:139], v[128:131], v[212:215]
  ds_read_b64_tr_b16 v[100:101], v11 offset:40960
  ds_read_b64_tr_b16 v[102:103], v12 offset:40960
  v_mfma_f32_16x16x32_bf16 v[216:219], v[140:143], v[124:127], v[216:219]
  ds_read_b128 v[104:107], v7 offset:32768
  v_mfma_f32_16x16x32_bf16 v[200:203], v[152:155], v[144:147], v[200:203]
  ds_read_b128 v[108:111], v33 offset:32768
  ds_read_b64_tr_b16 v[112:113], v9 offset:46080
  v_mfma_f32_16x16x32_bf16 v[204:207], v[152:155], v[148:151], v[204:207]
  ds_read_b64_tr_b16 v[114:115], v10 offset:46080
  v_mfma_f32_16x16x32_bf16 v[208:211], v[156:159], v[144:147], v[208:211]
  ds_read_b64_tr_b16 v[116:117], v9 offset:46112
  ds_read_b64_tr_b16 v[118:119], v10 offset:46112
  v_mfma_f32_16x16x32_bf16 v[212:215], v[156:159], v[148:151], v[212:215]
  ds_read_b64_tr_b16 v[120:121], v11 offset:46080
  ds_read_b64_tr_b16 v[122:123], v12 offset:46080
  v_mfma_f32_16x16x32_bf16 v[216:219], v[160:163], v[144:147], v[216:219]
  s_mov_b32 s34, 5242880
  s_mov_b32 s35, 0x20000
  s_mul_i32 s66, s3, 40
  s_add_u32 s66, s66, 107520
  s_mul_i32 s67, s3, 3072
  s_add_u32 s67, s67, tab_a-L_pc
  s_add_u32 s12, s42, s67
  s_addc_u32 s13, s43, 0
  v_and_b32 v21, 31, v0
  v_cmp_gt_u32 vcc, 16, v21
  v_lshrrev_b32 v22, 5, v0
  v_mov_b32 v23, 0x180
  v_cndmask_b32 v23, 64, v23, vcc
  s_getreg_b32 s68, hwreg(HW_REG_IB_STS, 0, 4)
  s_or_b32 s68, s68, s48
  s_cbranch_scc1 L_nf4
  s_call_b64 s[52:53], L_flag1
L_nf4:
  s_waitcnt lgkmcnt(0)
  s_barrier
  ds_read_b128 v[124:127], v8 offset:40960
  v_mfma_f32_16x16x32_bf16 v[200:203], v[92:95], v[84:87], v[200:203]
  ds_read_b128 v[128:131], v32 offset:40960
  ds_read_b64_tr_b16 v[132:133], v9 offset:0
  v_mfma_f32_16x16x32_bf16 v[204:207], v[92:95], v[88:91], v[204:207]
  ds_read_b64_tr_b16 v[134:135], v10 offset:0
  v_mfma_f32_16x16x32_bf16 v[208:211], v[96:99], v[84:87], v[208:211]
  ds_read_b64_tr_b16 v[136:137], v9 offset:32
  ds_read_b64_tr_b16 v[138:139], v10 offset:32
  v_mfma_f32_16x16x32_bf16 v[212:215], v[96:99], v[88:91], v[212:215]
  ds_read_b64_tr_b16 v[140:141], v11 offset:0
  ds_read_b64_tr_b16 v[142:143], v12 offset:0
  v_mfma_f32_16x16x32_bf16 v[216:219], v[100:103], v[84:87], v[216:219]
  ds_read_b128 v[144:147], v7 offset:40960
  v_mfma_f32_16x16x32_bf16 v[200:203], v[112:115], v[104:107], v[200:203]
  ds_read_b128 v[148:151], v33 offset:40960
  ds_read_b64_tr_b16 v[152:153], v9 offset:5120
  v_mfma_f32_16x16x32_bf16 v[204:207], v[112:115], v[108:111], v[204:207]
  ds_read_b64_tr_b16 v[154:155], v10 offset:5120
  v_mfma_f32_16x16x32_bf16 v[208:211], v[116:119], v[104:107], v[208:211]
  ds_read_b64_tr_b16 v[156:157], v9 offset:5152
  ds_read_b64_tr_b16 v[158:159], v10 offset:5152
  v_mfma_f32_16x16x32_bf16 v[212:215], v[116:119], v[108:111], v[212:215]
  ds_read_b64_tr_b16 v[160:161], v11 offset:5120
  ds_read_b64_tr_b16 v[162:163], v12 offset:5120
  v_mfma_f32_16x16x32_bf16 v[216:219], v[120:123], v[104:107], v[216:219]
  v_mul_u32_u24 v23, v22, v23
  v_lshl_add_u32 v1, v21, 4, v23
  v_mul_u32_u24 v21, 168, v21
  v_add_u32 v197, s66, v21
  v_lshl_add_u32 v196, v22, 4, v197
  v_mov_b32 v3, v2
  s_mul_i32 s49, s4, 81920
  s_add_u32 s49, s49, 1048576
  s_lshl_b32 s7, s5, 2
  s_add_u32 s7, s7, s3
  s_lshl_b32 s50, s7, 8
  s_lshl_b32 s7, s7, 10
  s_add_u32 s50, s50, s49
  s_add_u32 s49, s49, s7
  s_add_u32 s50, s50, 32768
  s_add_u32 s51, s49, 40960
  s_add_u32 s54, s50, 40960
  s_cmp_lg_u32 s48, 0
  s_cbranch_scc1 L_nf5
  s_call_b64 s[52:53], L_flag1
L_nf5:
  s_waitcnt lgkmcnt(0)
  s_barrier
  v_mov_b32 v18, 158720
  ds_read_b32 v16, v18
  ds_read_b128 v[84:87], v8 offset:49152
  v_mfma_f32_16x16x32_bf16 v[200:203], v[132:135], v[124:127], v[200:203]
  ds_read_b128 v[88:91], v32 offset:49152
  ds_read_b64_tr_b16 v[92:93], v9 offset:10240
  v_mfma_f32_16x16x32_bf16 v[204:207], v[132:135], v[128:131], v[204:207]
  ds_read_b64_tr_b16 v[94:95], v10 offset:10240
  v_mfma_f32_16x16x32_bf16 v[208:211], v[136:139], v[124:127], v[208:211]
  ds_read_b64_tr_b16 v[96:97], v9 offset:10272
  ds_read_b64_tr_b16 v[98:99], v10 offset:10272
  v_mfma_f32_16x16x32_bf16 v[212:215], v[136:139], v[128:131], v[212:215]
  ds_read_b64_tr_b16 v[100:101], v11 offset:10240
  ds_read_b64_tr_b16 v[102:103], v12 offset:10240
  v_mfma_f32_16x16x32_bf16 v[216:219], v[140:143], v[124:127], v[216:219]
  ds_read_b128 v[104:107], v7 offset:49152
  v_mfma_f32_16x16x32_bf16 v[200:203], v[152:155], v[144:147], v[200:203]
  ds_read_b128 v[108:111], v33 offset:49152
  ds_read_b64_tr_b16 v[112:113], v9 offset:15360
  v_mfma_f32_16x16x32_bf16 v[204:207], v[152:155], v[148:151], v[204:207]
  ds_read_b64_tr_b16 v[114:115], v10 offset:15360
  v_mfma_f32_16x16x32_bf16 v[208:211], v[156:159], v[144:147], v[208:211]
  ds_read_b64_tr_b16 v[116:117], v9 offset:15392
  ds_read_b64_tr_b16 v[118:119], v10 offset:15392
  v_mfma_f32_16x16x32_bf16 v[212:215], v[156:159], v[148:151], v[212:215]
  ds_read_b64_tr_b16 v[120:121], v11 offset:15360
  ds_read_b64_tr_b16 v[122:123], v12 offset:15360
  v_mfma_f32_16x16x32_bf16 v[216:219], v[160:163], v[144:147], v[216:219]
  s_waitcnt lgkmcnt(0)
  s_barrier
  v_readfirstlane_b32 s44, v16
  ds_read_b128 v[124:127], v8 offset:57344
  v_mfma_f32_16x16x32_bf16 v[200:203], v[92:95], v[84:87], v[200:203]
  ds_read_b128 v[128:131], v32 offset:57344
  ds_read_b64_tr_b16 v[132:133], v9 offset:20480
  v_mfma_f32_16x16x32_bf16 v[204:207], v[92:95], v[88:91], v[204:207]
  ds_read_b64_tr_b16 v[134:135], v10 offset:20480
  v_mfma_f32_16x16x32_bf16 v[208:211], v[96:99], v[84:87], v[208:211]
  ds_read_b64_tr_b16 v[136:137], v9 offset:20512
  ds_read_b64_tr_b16 v[138:139], v10 offset:20512
  v_mfma_f32_16x16x32_bf16 v[212:215], v[96:99], v[88:91], v[212:215]
  ds_read_b64_tr_b16 v[140:141], v11 offset:20480
  ds_read_b64_tr_b16 v[142:143], v12 offset:20480
  v_mfma_f32_16x16x32_bf16 v[216:219], v[100:103], v[84:87], v[216:219]
  ds_read_b128 v[144:147], v7 offset:57344
  v_mfma_f32_16x16x32_bf16 v[200:203], v[112:115], v[104:107], v[200:203]
  ds_read_b128 v[148:151], v33 offset:57344
  ds_read_b64_tr_b16 v[152:153], v9 offset:25600
  v_mfma_f32_16x16x32_bf16 v[204:207], v[112:115], v[108:111], v[204:207]
  ds_read_b64_tr_b16 v[154:155], v10 offset:25600
  v_mfma_f32_16x16x32_bf16 v[208:211], v[116:119], v[104:107], v[208:211]
  ds_read_b64_tr_b16 v[156:157], v9 offset:25632
  ds_read_b64_tr_b16 v[158:159], v10 offset:25632
  v_mfma_f32_16x16x32_bf16 v[212:215], v[116:119], v[108:111], v[212:215]
  ds_read_b64_tr_b16 v[160:161], v11 offset:25600
  ds_read_b64_tr_b16 v[162:163], v12 offset:25600
  v_mfma_f32_16x16x32_bf16 v[216:219], v[120:123], v[104:107], v[216:219]
  v_add_u32 v8, 0x10000, v8
  v_add_u32 v7, 0x10000, v7
  v_add_u32 v32, 0x10000, v32
  v_add_u32 v33, 0x10000, v33
  s_waitcnt lgkmcnt(0)
  s_barrier
  ds_read_b128 v[84:87], v8 offset:0
  v_mfma_f32_16x16x32_bf16 v[200:203], v[132:135], v[124:127], v[200:203]
  ds_read_b128 v[88:91], v32 offset:0
  ds_read_b64_tr_b16 v[92:93], v9 offset:30720
  v_mfma_f32_16x16x32_bf16 v[204:207], v[132:135], v[128:131], v[204:207]
  ds_read_b64_tr_b16 v[94:95], v10 offset:30720
  v_mfma_f32_16x16x32_bf16 v[208:211], v[136:139], v[124:127], v[208:211]
  ds_read_b64_tr_b16 v[96:97], v9 offset:30752
  ds_read_b64_tr_b16 v[98:99], v10 offset:30752
  v_mfma_f32_16x16x32_bf16 v[212:215], v[136:139], v[128:131], v[212:215]
  ds_read_b64_tr_b16 v[100:101], v11 offset:30720
  ds_read_b64_tr_b16 v[102:103], v12 offset:30720
  v_mfma_f32_16x16x32_bf16 v[216:219], v[140:143], v[124:127], v[216:219]
  ds_read_b128 v[104:107], v7 offset:0
  v_mfma_f32_16x16x32_bf16 v[200:203], v[152:155], v[144:147], v[200:203]
  ds_read_b128 v[108:111], v33 offset:0
  ds_read_b64_tr_b16 v[112:113], v9 offset:35840
  v_mfma_f32_16x16x32_bf16 v[204:207], v[152:155], v[148:151], v[204:207]
  ds_read_b64_tr_b16 v[114:115], v10 offset:35840
  v_mfma_f32_16x16x32_bf16 v[208:211], v[156:159], v[144:147], v[208:211]
  ds_read_b64_tr_b16 v[116:117], v9 offset:35872
  ds_read_b64_tr_b16 v[118:119], v10 offset:35872
  v_mfma_f32_16x16x32_bf16 v[212:215], v[156:159], v[148:151], v[212:215]
  ds_read_b64_tr_b16 v[120:121], v11 offset:35840
  ds_read_b64_tr_b16 v[122:123], v12 offset:35840
  v_mfma_f32_16x16x32_bf16 v[216:219], v[160:163], v[144:147], v[216:219]
  s_waitcnt lgkmcnt(0)
  v_mfma_f32_16x16x32_bf16 v[200:203], v[92:95], v[84:87], v[200:203]
  v_mfma_f32_16x16x32_bf16 v[204:207], v[92:95], v[88:91], v[204:207]
  v_mfma_f32_16x16x32_bf16 v[208:211], v[96:99], v[84:87], v[208:211]
  v_mfma_f32_16x16x32_bf16 v[212:215], v[96:99], v[88:91], v[212:215]
  v_mfma_f32_16x16x32_bf16 v[216:219], v[100:103], v[84:87], v[216:219]
  v_mfma_f32_16x16x32_bf16 v[200:203], v[112:115], v[104:107], v[200:203]
  v_mfma_f32_16x16x32_bf16 v[204:207], v[112:115], v[108:111], v[204:207]
  v_mfma_f32_16x16x32_bf16 v[208:211], v[116:119], v[104:107], v[208:211]
  v_mfma_f32_16x16x32_bf16 v[212:215], v[116:119], v[108:111], v[212:215]
  v_mfma_f32_16x16x32_bf16 v[216:219], v[120:123], v[104:107], v[216:219]
  s_barrier
  ds_read_b128 v[124:127], v8 offset:8192
  ds_read_b128 v[128:131], v32 offset:8192
  ds_read_b64_tr_b16 v[132:133], v9 offset:40960
  ds_read_b64_tr_b16 v[134:135], v10 offset:40960
  ds_read_b64_tr_b16 v[136:137], v9 offset:40992
  ds_read_b64_tr_b16 v[138:139], v10 offset:40992
  ds_read_b64_tr_b16 v[140:141], v11 offset:40960
  ds_read_b64_tr_b16 v[142:143], v12 offset:40960
  ds_read_b128 v[144:147], v7 offset:8192
  ds_read_b128 v[148:151], v33 offset:8192
  ds_read_b64_tr_b16 v[152:153], v9 offset:46080
  ds_read_b64_tr_b16 v[154:155], v10 offset:46080
  s_waitcnt lgkmcnt(8)
  v_mfma_f32_16x16x32_bf16 v[200:203], v[132:135], v[124:127], v[200:203]
  ds_read_b64_tr_b16 v[156:157], v9 offset:46112
  v_mfma_f32_16x16x32_bf16 v[204:207], v[132:135], v[128:131], v[204:207]
  ds_read_b64_tr_b16 v[158:159], v10 offset:46112
  s_waitcnt lgkmcnt(8)
  v_mfma_f32_16x16x32_bf16 v[208:211], v[136:139], v[124:127], v[208:211]
  ds_read_b64_tr_b16 v[160:161], v11 offset:46080
  v_mfma_f32_16x16x32_bf16 v[212:215], v[136:139], v[128:131], v[212:215]
  ds_read_b64_tr_b16 v[162:163], v12 offset:46080
  s_waitcnt lgkmcnt(8)
  v_mfma_f32_16x16x32_bf16 v[216:219], v[140:143], v[124:127], v[216:219]
  s_waitcnt lgkmcnt(4)
  v_mfma_f32_16x16x32_bf16 v[200:203], v[152:155], v[144:147], v[200:203]
  v_mfma_f32_16x16x32_bf16 v[204:207], v[152:155], v[148:151], v[204:207]
  s_waitcnt lgkmcnt(2)
  v_mfma_f32_16x16x32_bf16 v[208:211], v[156:159], v[144:147], v[208:211]
  v_mfma_f32_16x16x32_bf16 v[212:215], v[156:159], v[148:151], v[212:215]
  s_waitcnt lgkmcnt(0)
  v_mfma_f32_16x16x32_bf16 v[216:219], v[160:163], v[144:147], v[216:219]
  v_mov_b32 v16, 0xdddddddd
  s_nop 2
  v_cvt_pk_bf16_f32 v200, v200, v201
  v_cvt_pk_bf16_f32 v201, v202, v203
  ds_write_b64 v34, v[200:201] offset:0
  v_cvt_pk_bf16_f32 v204, v204, v205
  v_cvt_pk_bf16_f32 v205, v206, v207
  ds_write_b64 v13, v[204:205] offset:0
  v_cvt_pk_bf16_f32 v208, v208, v209
  v_cvt_pk_bf16_f32 v209, v210, v211
  ds_write_b64 v34, v[208:209] offset:32
  v_cvt_pk_bf16_f32 v212, v212, v213
  v_cvt_pk_bf16_f32 v213, v214, v215
  ds_write_b64 v13, v[212:213] offset:32
  v_cvt_pk_bf16_f32 v216, v216, v217
  v_cvt_pk_bf16_f32 v217, v218, v219
  ds_write_b64 v35, v[216:217] offset:0
  s_setprio 2
  s_waitcnt lgkmcnt(0)
  s_barrier
  ds_read_b64 v[4:5], v196 offset:0
  ds_read_b64 v[6:7], v196 offset:8
  ds_read_b64 v[8:9], v197 offset:32
  ds_read_b128 v[148:151], v3 offset:0
  ds_read_b128 v[152:155], v3 offset:1024
  ds_read_b128 v[156:159], v3 offset:4096
  s_waitcnt lgkmcnt(2)
  v_mfma_f32_32x32x16_bf16 v[84:99], v[148:151], v[4:7], 0
  s_waitcnt lgkmcnt(1)
  v_mfma_f32_32x32x16_bf16 v[100:115], v[152:155], v[4:7], 0
  ds_read_b64 v[10:11], v196 offset:5376
  ds_read_b64 v[12:13], v196 offset:5384
  ds_read_b64 v[14:15], v197 offset:5408
  s_mov_b64 exec, s[64:65]
  ds_read_b128 v[164:167], v1 offset:5120
  ds_read_b128 v[168:171], v1 offset:5760
  ds_read_b128 v[172:175], v1 offset:6400
  ds_read_b128 v[176:179], v1 offset:7040
  s_mov_b64 exec, -1
  s_waitcnt lgkmcnt(4)
  v_mfma_f32_32x32x4_2b_bf16 v[84:115], v[156:157], v[8:9], v[84:115]
  s_mov_b32 s55, 8
  s_mov_b32 s61, 0
  global_load_dwordx4 v[248:251], v2, s[12:13]
  global_load_dwordx4 v[252:255], v2, s[12:13] offset:1024
  global_load_dwordx4 v[244:247], v2, s[12:13] offset:2048
  s_nop 10
  v_mfma_f32_32x32x16_bf16 v[116:131], v[148:151], v[10:13], 0
  s_nop 2
  v_max3_f32 v224, v84, v85, v86
  v_max3_f32 v225, v87, v88, v89
  v_max3_f32 v224, v224, v90, v91
  v_mfma_f32_32x32x16_bf16 v[132:147], v[152:155], v[10:13], 0
  v_max3_f32 v225, v225, v92, v93
  v_max3_f32 v224, v224, v94, v95
  v_max3_f32 v225, v225, v96, v97
  v_max3_f32 v224, v224, v98, v99
  v_max3_f32 v225, v225, v100, v101
  v_max3_f32 v224, v224, v102, v103
  v_max3_f32 v225, v225, v104, v105
  v_max3_f32 v224, v224, v106, v107
  v_max3_f32 v225, v225, v108, v109
  v_max3_f32 v224, v224, v110, v111
  v_mfma_f32_32x32x4_2b_bf16 v[116:147], v[156:157], v[14:15], v[116:147]
  v_max3_f32 v225, v225, v112, v113
  v_max3_f32 v224, v224, v114, v115
  v_max_f32 v224, v224, v225
  v_mov_b32 v225, v224
  s_nop 1
  v_permlane32_swap_b32 v224, v225
  v_max_f32 v224, v224, v225
  v_sub_f32 v20, 0xc2cc0000, v224
  v_sub_f32 v21, 0xc2cc0000, v224
  v_mov_b64 v[22:23], v[20:21]
  v_mov_b64 v[24:25], v[20:21]
  v_mov_b64 v[26:27], v[20:21]
  v_mov_b64 v[28:29], v[20:21]
  v_mov_b64 v[30:31], v[20:21]
  v_mov_b64 v[32:33], v[20:21]
  v_mov_b64 v[34:35], v[20:21]
  v_pk_add_f32 v[84:85], v[84:85], v[20:21]
  v_pk_add_f32 v[86:87], v[86:87], v[20:21]
  v_pk_add_f32 v[88:89], v[88:89], v[20:21]
  v_pk_add_f32 v[90:91], v[90:91], v[20:21]
  v_pk_add_f32 v[92:93], v[92:93], v[20:21]
  v_pk_add_f32 v[94:95], v[94:95], v[20:21]
  v_pk_add_f32 v[96:97], v[96:97], v[20:21]
  v_pk_add_f32 v[98:99], v[98:99], v[20:21]
  v_pk_add_f32 v[100:101], v[100:101], v[20:21]
  v_pk_add_f32 v[102:103], v[102:103], v[20:21]
  v_pk_add_f32 v[104:105], v[104:105], v[20:21]
  v_pk_add_f32 v[106:107], v[106:107], v[20:21]
  v_pk_add_f32 v[108:109], v[108:109], v[20:21]
  v_pk_add_f32 v[110:111], v[110:111], v[20:21]
  v_max3_f32 v224, v116, v117, v118
  v_max3_f32 v225, v119, v120, v121
  v_max3_f32 v224, v224, v122, v123
  v_max3_f32 v225, v225, v124, v125
  v_max3_f32 v224, v224, v126, v127
  v_max3_f32 v225, v225, v128, v129
  v_max3_f32 v224, v224, v130, v131
  v_max3_f32 v225, v225, v132, v133
  v_max3_f32 v224, v224, v134, v135
  v_max3_f32 v225, v225, v136, v137
  v_max3_f32 v224, v224, v138, v139
  v_max3_f32 v225, v225, v140, v141
  v_max3_f32 v224, v224, v142, v143
  v_max3_f32 v225, v225, v144, v145
  v_max3_f32 v224, v224, v146, v147
  v_max_f32 v224, v224, v225
  v_mov_b32 v225, v224
  s_nop 1
  v_permlane32_swap_b32 v224, v225
  v_max_f32 v224, v224, v225
  v_sub_f32 v36, 0xc2cc0000, v224
  v_sub_f32 v37, 0xc2cc0000, v224
  v_mov_b64 v[38:39], v[36:37]
  v_mov_b64 v[40:41], v[36:37]
  v_mov_b64 v[42:43], v[36:37]
  v_mov_b64 v[44:45], v[36:37]
  v_mov_b64 v[46:47], v[36:37]
  v_mov_b64 v[48:49], v[36:37]
  v_mov_b64 v[50:51], v[36:37]
  v_pk_add_f32 v[112:113], v[112:113], v[20:21]
  v_pk_add_f32 v[114:115], v[114:115], v[20:21]
  v_mfma_f32_32x32x16_bf16 v[116:131], v[148:151], v[10:13], v[36:51]
  v_exp_f32 v84, v84
  v_exp_f32 v85, v85
  s_waitcnt lgkmcnt(0)
  .p2align 3
L_loop:
  ds_read_b128 v[148:151], v3 offset:2048
  v_exp_f32 v86, v86
  v_exp_f32 v87, v87
  v_exp_f32 v88, v88
  v_mfma_f32_32x32x16_bf16 v[132:147], v[152:155], v[10:13], v[36:51]
  ds_read_b128 v[152:155], v3 offset:3072
  v_exp_f32 v89, v89
  v_exp_f32 v90, v90
  v_exp_f32 v91, v91
  v_exp_f32 v92, v92
  v_exp_f32 v93, v93
  v_smfmac_f32_32x32x32_bf16 v[52:67], v[164:167], v[84:91], v16
  v_exp_f32 v94, v94
  v_exp_f32 v95, v95
  v_exp_f32 v96, v96
  v_mfma_f32_32x32x4_2b_bf16 v[116:147], v[156:157], v[14:15], v[116:147]
  v_exp_f32 v97, v97
  v_exp_f32 v98, v98
  v_exp_f32 v99, v99
  v_exp_f32 v100, v100
  v_exp_f32 v101, v101
  v_exp_f32 v102, v102
  v_exp_f32 v103, v103
  v_exp_f32 v104, v104
  v_smfmac_f32_32x32x32_bf16 v[52:67], v[168:171], v[92:99], v16
  v_exp_f32 v105, v105
  v_exp_f32 v106, v106
  v_exp_f32 v107, v107
  v_exp_f32 v108, v108
  v_exp_f32 v109, v109
  v_smfmac_f32_32x32x32_bf16 v[52:67], v[172:175], v[100:107], v16
  s_waitcnt lgkmcnt(0)
  v_exp_f32 v110, v110
  v_exp_f32 v111, v111
  v_exp_f32 v112, v112
  v_mfma_f32_32x32x16_bf16 v[84:99], v[148:151], v[4:7], v[20:35]
  v_exp_f32 v113, v113
  v_exp_f32 v114, v114
  v_exp_f32 v115, v115
  v_exp_f32 v116, v116
  v_exp_f32 v117, v117
  v_smfmac_f32_32x32x32_bf16 v[52:67], v[176:179], v[108:115], v16
  v_exp_f32 v118, v118
  v_exp_f32 v119, v119
  v_exp_f32 v120, v120
  v_mfma_f32_32x32x16_bf16 v[100:115], v[152:155], v[4:7], v[20:35]
  v_exp_f32 v121, v121
  v_exp_f32 v122, v122
  v_exp_f32 v123, v123
  v_exp_f32 v124, v124
  v_exp_f32 v125, v125
  v_smfmac_f32_32x32x32_bf16 v[68:83], v[164:167], v[116:123], v16
  s_mov_b64 exec, s[64:65]
  ds_read_b128 v[180:183], v1 offset:7680
  ds_read_b128 v[184:187], v1 offset:8320
  ds_read_b128 v[188:191], v1 offset:8960
  ds_read_b128 v[192:195], v1 offset:9600
  s_mov_b64 exec, -1
  v_exp_f32 v126, v126
  v_exp_f32 v127, v127
  v_exp_f32 v128, v128
  v_mfma_f32_32x32x4_2b_bf16 v[84:115], v[158:159], v[8:9], v[84:115]
  v_exp_f32 v129, v129
  v_exp_f32 v130, v130
  v_exp_f32 v131, v131
  v_exp_f32 v132, v132
  v_exp_f32 v133, v133
  v_exp_f32 v134, v134
  v_exp_f32 v135, v135
  v_exp_f32 v136, v136
  v_smfmac_f32_32x32x32_bf16 v[68:83], v[168:171], v[124:131], v16
  v_exp_f32 v137, v137
  v_exp_f32 v138, v138
  v_exp_f32 v139, v139
  v_exp_f32 v140, v140
  v_exp_f32 v141, v141
  v_smfmac_f32_32x32x32_bf16 v[68:83], v[172:175], v[132:139], v16
  v_exp_f32 v142, v142
  v_exp_f32 v143, v143
  v_exp_f32 v144, v144
  v_mfma_f32_32x32x16_bf16 v[116:131], v[148:151], v[10:13], v[36:51]
  s_waitcnt lgkmcnt(0)
  v_exp_f32 v145, v145
  v_exp_f32 v146, v146
  v_exp_f32 v147, v147
  v_exp_f32 v84, v84
  v_exp_f32 v85, v85
  v_smfmac_f32_32x32x32_bf16 v[68:83], v[176:179], v[140:147], v16
  ds_read_b128 v[148:151], v3 offset:10240
  v_exp_f32 v86, v86
  v_exp_f32 v87, v87
  v_exp_f32 v88, v88
  v_mfma_f32_32x32x16_bf16 v[132:147], v[152:155], v[10:13], v[36:51]
  ds_read_b128 v[152:155], v3 offset:11264
  v_exp_f32 v89, v89
  v_exp_f32 v90, v90
  v_exp_f32 v91, v91
  v_exp_f32 v92, v92
  v_exp_f32 v93, v93
  v_smfmac_f32_32x32x32_bf16 v[52:67], v[180:183], v[84:91], v16
  v_exp_f32 v94, v94
  v_exp_f32 v95, v95
  v_exp_f32 v96, v96
  v_mfma_f32_32x32x4_2b_bf16 v[116:147], v[158:159], v[14:15], v[116:147]
  ds_read_b128 v[156:159], v3 offset:14336
  v_exp_f32 v97, v97
  v_exp_f32 v98, v98
  v_exp_f32 v99, v99
  v_exp_f32 v100, v100
  v_exp_f32 v101, v101
  v_exp_f32 v102, v102
  v_exp_f32 v103, v103
  v_exp_f32 v104, v104
  v_smfmac_f32_32x32x32_bf16 v[52:67], v[184:187], v[92:99], v16
  v_exp_f32 v105, v105
  v_exp_f32 v106, v106
  v_exp_f32 v107, v107
  v_exp_f32 v108, v108
  v_exp_f32 v109, v109
  v_smfmac_f32_32x32x32_bf16 v[52:67], v[188:191], v[100:107], v16
  s_waitcnt lgkmcnt(0)
  v_exp_f32 v110, v110
  v_exp_f32 v111, v111
  v_exp_f32 v112, v112
  v_mfma_f32_32x32x16_bf16 v[84:99], v[148:151], v[4:7], v[20:35]
  v_exp_f32 v113, v113
  v_exp_f32 v114, v114
  v_exp_f32 v115, v115
  v_exp_f32 v116, v116
  v_exp_f32 v117, v117
  v_smfmac_f32_32x32x32_bf16 v[52:67], v[192:195], v[108:115], v16
  v_exp_f32 v118, v118
  v_exp_f32 v119, v119
  v_exp_f32 v120, v120
  v_mfma_f32_32x32x16_bf16 v[100:115], v[152:155], v[4:7], v[20:35]
  v_exp_f32 v121, v121
  v_exp_f32 v122, v122
  v_exp_f32 v123, v123
  v_exp_f32 v124, v124
  v_exp_f32 v125, v125
  v_smfmac_f32_32x32x32_bf16 v[68:83], v[180:183], v[116:123], v16
  s_mov_b64 exec, s[64:65]
  ds_read_b128 v[164:167], v1 offset:15360
  ds_read_b128 v[168:171], v1 offset:16000
  ds_read_b128 v[172:175], v1 offset:16640
  ds_read_b128 v[176:179], v1 offset:17280
  s_mov_b64 exec, -1
  v_exp_f32 v126, v126
  v_exp_f32 v127, v127
  v_exp_f32 v128, v128
  v_mfma_f32_32x32x4_2b_bf16 v[84:115], v[156:157], v[8:9], v[84:115]
  v_exp_f32 v129, v129
  v_exp_f32 v130, v130
  v_exp_f32 v131, v131
  v_exp_f32 v132, v132
  v_exp_f32 v133, v133
  v_exp_f32 v134, v134
  v_exp_f32 v135, v135
  v_exp_f32 v136, v136
  v_smfmac_f32_32x32x32_bf16 v[68:83], v[184:187], v[124:131], v16
  v_exp_f32 v137, v137
  v_exp_f32 v138, v138
  v_exp_f32 v139, v139
  v_exp_f32 v140, v140
  v_exp_f32 v141, v141
  v_smfmac_f32_32x32x32_bf16 v[68:83], v[188:191], v[132:139], v16
  v_exp_f32 v142, v142
  v_exp_f32 v143, v143
  v_exp_f32 v144, v144
  v_mfma_f32_32x32x16_bf16 v[116:131], v[148:151], v[10:13], v[36:51]
  s_waitcnt lgkmcnt(0)
  v_exp_f32 v145, v145
  v_exp_f32 v146, v146
  v_exp_f32 v147, v147
  v_exp_f32 v84, v84
  v_exp_f32 v85, v85
  v_smfmac_f32_32x32x32_bf16 v[68:83], v[192:195], v[140:147], v16
  ds_read_b128 v[148:151], v3 offset:12288
  v_exp_f32 v86, v86
  v_exp_f32 v87, v87
  v_exp_f32 v88, v88
  v_mfma_f32_32x32x16_bf16 v[132:147], v[152:155], v[10:13], v[36:51]
  ds_read_b128 v[152:155], v3 offset:13312
  v_exp_f32 v89, v89
  v_exp_f32 v90, v90
  v_exp_f32 v91, v91
  v_exp_f32 v92, v92
  v_exp_f32 v93, v93
  v_smfmac_f32_32x32x32_bf16 v[52:67], v[164:167], v[84:91], v16
  v_exp_f32 v94, v94
  v_exp_f32 v95, v95
  v_exp_f32 v96, v96
  v_mfma_f32_32x32x4_2b_bf16 v[116:147], v[156:157], v[14:15], v[116:147]
  v_exp_f32 v97, v97
  v_exp_f32 v98, v98
  v_exp_f32 v99, v99
  v_exp_f32 v100, v100
  v_exp_f32 v101, v101
  v_exp_f32 v102, v102
  v_exp_f32 v103, v103
  v_exp_f32 v104, v104
  v_smfmac_f32_32x32x32_bf16 v[52:67], v[168:171], v[92:99], v16
  v_exp_f32 v105, v105
  v_exp_f32 v106, v106
  v_exp_f32 v107, v107
  v_exp_f32 v108, v108
  v_exp_f32 v109, v109
  v_smfmac_f32_32x32x32_bf16 v[52:67], v[172:175], v[100:107], v16
  s_waitcnt lgkmcnt(0)
  v_exp_f32 v110, v110
  v_exp_f32 v111, v111
  v_exp_f32 v112, v112
  v_mfma_f32_32x32x16_bf16 v[84:99], v[148:151], v[4:7], v[20:35]
  v_exp_f32 v113, v113
  v_exp_f32 v114, v114
  v_exp_f32 v115, v115
  v_exp_f32 v116, v116
  v_exp_f32 v117, v117
  v_smfmac_f32_32x32x32_bf16 v[52:67], v[176:179], v[108:115], v16
  v_exp_f32 v118, v118
  v_exp_f32 v119, v119
  v_exp_f32 v120, v120
  v_mfma_f32_32x32x16_bf16 v[100:115], v[152:155], v[4:7], v[20:35]
  v_exp_f32 v121, v121
  v_exp_f32 v122, v122
  v_exp_f32 v123, v123
  v_exp_f32 v124, v124
  v_exp_f32 v125, v125
  v_smfmac_f32_32x32x32_bf16 v[68:83], v[164:167], v[116:123], v16
  s_mov_b64 exec, s[64:65]
  ds_read_b128 v[180:183], v1 offset:17920
  ds_read_b128 v[184:187], v1 offset:18560
  ds_read_b128 v[188:191], v1 offset:19200
  ds_read_b128 v[192:195], v1 offset:19840
  s_mov_b64 exec, -1
  v_exp_f32 v126, v126
  v_exp_f32 v127, v127
  v_exp_f32 v128, v128
  v_mfma_f32_32x32x4_2b_bf16 v[84:115], v[158:159], v[8:9], v[84:115]
  v_exp_f32 v129, v129
  v_exp_f32 v130, v130
  v_exp_f32 v131, v131
  v_exp_f32 v132, v132
  v_exp_f32 v133, v133
  v_exp_f32 v134, v134
  v_exp_f32 v135, v135
  v_exp_f32 v136, v136
  v_smfmac_f32_32x32x32_bf16 v[68:83], v[168:171], v[124:131], v16
  v_exp_f32 v137, v137
  v_exp_f32 v138, v138
  v_exp_f32 v139, v139
  v_exp_f32 v140, v140
  v_exp_f32 v141, v141
  v_smfmac_f32_32x32x32_bf16 v[68:83], v[172:175], v[132:139], v16
  v_exp_f32 v142, v142
  v_exp_f32 v143, v143
  v_exp_f32 v144, v144
  v_mfma_f32_32x32x16_bf16 v[116:131], v[148:151], v[10:13], v[36:51]
  s_waitcnt lgkmcnt(0)
  v_exp_f32 v145, v145
  v_exp_f32 v146, v146
  v_exp_f32 v147, v147
  v_exp_f32 v84, v84
  v_exp_f32 v85, v85
  v_smfmac_f32_32x32x32_bf16 v[68:83], v[176:179], v[140:147], v16
  s_barrier
  ds_read_b128 v[148:151], v3 offset:20480
  v_exp_f32 v86, v86
  v_exp_f32 v87, v87
  v_exp_f32 v88, v88
  v_mfma_f32_32x32x16_bf16 v[132:147], v[152:155], v[10:13], v[36:51]
  ds_read_b128 v[152:155], v3 offset:21504
  v_exp_f32 v89, v89
  v_exp_f32 v90, v90
  v_exp_f32 v91, v91
  v_exp_f32 v92, v92
  v_exp_f32 v93, v93
  v_smfmac_f32_32x32x32_bf16 v[52:67], v[180:183], v[84:91], v16
  v_exp_f32 v94, v94
  v_exp_f32 v95, v95
  v_exp_f32 v96, v96
  v_mfma_f32_32x32x4_2b_bf16 v[116:147], v[158:159], v[14:15], v[116:147]
  ds_read_b128 v[156:159], v3 offset:24576
  v_exp_f32 v97, v97
  v_exp_f32 v98, v98
  v_exp_f32 v99, v99
  v_exp_f32 v100, v100
  v_exp_f32 v101, v101
  v_exp_f32 v102, v102
  v_exp_f32 v103, v103
  v_exp_f32 v104, v104
  v_smfmac_f32_32x32x32_bf16 v[52:67], v[184:187], v[92:99], v16
  v_exp_f32 v105, v105
  v_exp_f32 v106, v106
  v_exp_f32 v107, v107
  v_exp_f32 v108, v108
  v_exp_f32 v109, v109
  v_smfmac_f32_32x32x32_bf16 v[52:67], v[188:191], v[100:107], v16
  s_waitcnt lgkmcnt(0)
  v_exp_f32 v110, v110
  v_exp_f32 v111, v111
  v_exp_f32 v112, v112
  v_mfma_f32_32x32x16_bf16 v[84:99], v[148:151], v[4:7], v[20:35]
  v_exp_f32 v113, v113
  v_exp_f32 v114, v114
  v_exp_f32 v115, v115
  v_exp_f32 v116, v116
  v_exp_f32 v117, v117
  v_smfmac_f32_32x32x32_bf16 v[52:67], v[192:195], v[108:115], v16
  v_exp_f32 v118, v118
  v_exp_f32 v119, v119
  v_exp_f32 v120, v120
  v_mfma_f32_32x32x16_bf16 v[100:115], v[152:155], v[4:7], v[20:35]
  v_exp_f32 v121, v121
  v_exp_f32 v122, v122
  v_exp_f32 v123, v123
  v_exp_f32 v124, v124
  v_exp_f32 v125, v125
  v_smfmac_f32_32x32x32_bf16 v[68:83], v[180:183], v[116:123], v16
  s_mov_b64 exec, s[64:65]
  ds_read_b128 v[164:167], v1 offset:25600
  ds_read_b128 v[168:171], v1 offset:26240
  ds_read_b128 v[172:175], v1 offset:26880
  ds_read_b128 v[176:179], v1 offset:27520
  s_mov_b64 exec, -1
  v_exp_f32 v126, v126
  v_exp_f32 v127, v127
  v_exp_f32 v128, v128
  v_mfma_f32_32x32x4_2b_bf16 v[84:115], v[156:157], v[8:9], v[84:115]
  v_exp_f32 v129, v129
  v_exp_f32 v130, v130
  v_exp_f32 v131, v131
  v_exp_f32 v132, v132
  v_exp_f32 v133, v133
  v_exp_f32 v134, v134
  v_exp_f32 v135, v135
  v_exp_f32 v136, v136
  v_smfmac_f32_32x32x32_bf16 v[68:83], v[184:187], v[124:131], v16
  s_sub_u32 s55, s55, 1
  v_add_u32 v3, 20480, v3
  v_add_u32 v1, 20480, v1
  v_exp_f32 v137, v137
  v_exp_f32 v138, v138
  v_exp_f32 v139, v139
  v_exp_f32 v140, v140
  v_exp_f32 v141, v141
  v_smfmac_f32_32x32x32_bf16 v[68:83], v[188:191], v[132:139], v16
  s_cmp_lg_u32 s55, 0
  v_exp_f32 v142, v142
  v_exp_f32 v143, v143
  v_exp_f32 v144, v144
  v_mfma_f32_32x32x16_bf16 v[116:131], v[148:151], v[10:13], v[36:51]
  s_waitcnt lgkmcnt(0)
  v_exp_f32 v145, v145
  v_exp_f32 v146, v146
  v_exp_f32 v147, v147
  v_exp_f32 v84, v84
  v_exp_f32 v85, v85
  v_smfmac_f32_32x32x32_bf16 v[68:83], v[192:195], v[140:147], v16
  s_cbranch_scc1 L_loop
L_check:
  v_rcp_f32 v224, v64
  s_waitcnt vmcnt(0)
  v_pk_mul_f32 v[20:21], v[52:53], v[224:225] op_sel_hi:[1,0]
  v_pk_mul_f32 v[22:23], v[54:55], v[224:225] op_sel_hi:[1,0]
  v_pk_mul_f32 v[24:25], v[56:57], v[224:225] op_sel_hi:[1,0]
  v_pk_mul_f32 v[26:27], v[58:59], v[224:225] op_sel_hi:[1,0]
  v_cvt_pk_bf16_f32 v230, v20, v21
  v_cvt_pk_bf16_f32 v231, v22, v23
  v_cvt_pk_bf16_f32 v232, v24, v25
  v_cvt_pk_bf16_f32 v233, v26, v27
  buffer_store_dwordx4 v[230:233], v2, s[20:23], s49 offen sc1
  v_rcp_f32 v228, v80
  v_pk_mul_f32 v[28:29], v[60:61], v[224:225] op_sel_hi:[1,0]
  v_pk_mul_f32 v[30:31], v[62:63], v[224:225] op_sel_hi:[1,0]
  v_cvt_pk_bf16_f32 v234, v28, v29
  v_cvt_pk_bf16_f32 v235, v30, v31
  v_pk_mul_f32 v[44:45], v[76:77], v[228:229] op_sel_hi:[1,0]
  v_pk_mul_f32 v[46:47], v[78:79], v[228:229] op_sel_hi:[1,0]
  v_cvt_pk_bf16_f32 v240, v44, v45
  v_cvt_pk_bf16_f32 v241, v46, v47
  v_pk_mul_f32 v[36:37], v[68:69], v[228:229] op_sel_hi:[1,0]
  v_pk_mul_f32 v[38:39], v[70:71], v[228:229] op_sel_hi:[1,0]
  v_pk_mul_f32 v[40:41], v[72:73], v[228:229] op_sel_hi:[1,0]
  v_pk_mul_f32 v[42:43], v[74:75], v[228:229] op_sel_hi:[1,0]
  v_cvt_pk_bf16_f32 v236, v36, v37
  v_cvt_pk_bf16_f32 v237, v38, v39
  v_cvt_pk_bf16_f32 v238, v40, v41
  v_cvt_pk_bf16_f32 v239, v42, v43
  buffer_store_dwordx4 v[236:239], v2, s[20:23], s51 offen sc1
  v_permlane32_swap_b32 v234, v240
  v_permlane32_swap_b32 v235, v241
  buffer_store_dwordx2 v[234:235], v250, s[20:23], s50 offen sc1
  v_add_u32 v3, 122880, v2
  ds_read_b128 v[84:87], v3 offset:0
  ds_read_b128 v[92:95], v3 offset:2048
  ds_read_b128 v[88:91], v3 offset:1024
  ds_read_b128 v[96:99], v3 offset:3072
  ds_read_b128 v[136:139], v3 offset:13312
  ds_read_b128 v[140:143], v3 offset:14336
  s_mov_b32 s6, 0x7f800000
  s_mov_b32 s7, 0x6800000
  v_max3_f32 v226, |v52|, |v53|, |v54|
  v_max3_f32 v226, v226, |v55|, |v56|
  v_max3_f32 v226, v226, |v57|, |v58|
  v_max_f32 v226, v226, |v59|
  v_max3_f32 v227, |v68|, |v69|, |v70|
  v_max3_f32 v227, v227, |v71|, |v72|
  v_max3_f32 v227, v227, |v73|, |v74|
  v_max_f32 v227, v227, |v75|
  v_pk_add_f32 v[228:229], v[52:53], v[54:55]
  v_pk_add_f32 v[228:229], v[228:229], v[56:57]
  v_pk_add_f32 v[228:229], v[228:229], v[58:59]
  v_pk_add_f32 v[228:229], v[228:229], v[60:61]
  v_pk_add_f32 v[228:229], v[228:229], v[62:63]
  v_pk_add_f32 v[228:229], v[228:229], v[68:69]
  v_pk_add_f32 v[228:229], v[228:229], v[70:71]
  v_pk_add_f32 v[228:229], v[228:229], v[72:73]
  v_pk_add_f32 v[228:229], v[228:229], v[74:75]
  v_pk_add_f32 v[228:229], v[228:229], v[76:77]
  v_pk_add_f32 v[228:229], v[228:229], v[78:79]
  v_cmp_gt_f32 vcc, 0x76800000, v64
  v_add_f32 v228, v228, v229
  v_min_f32 v226, v226, v227
  s_mov_b64 s[68:69], vcc
  v_cmp_gt_f32 vcc, 0x76800000, v80
  v_cmp_gt_f32 s[66:67], s6, |v228|
  v_cmp_lt_f32 s[6:7], s7, v226
  s_and_b64 vcc, vcc, s[68:69]
  s_and_b64 vcc, vcc, s[66:67]
  s_and_b64 vcc, vcc, s[6:7]
  s_cmp_eq_u64 vcc, -1
  s_waitcnt lgkmcnt(0)
  s_cbranch_scc0 L_slow
L_store:
  s_barrier
  ds_read_b64_tr_b16 v[4:5], v248 offset:0
  ds_read_b64_tr_b16 v[6:7], v248 offset:160
  ds_read_b64_tr_b16 v[8:9], v248 offset:640
  ds_read_b64_tr_b16 v[10:11], v248 offset:800
  ds_read_b64_tr_b16 v[12:13], v248 offset:1288
  ds_read_b64_tr_b16 v[14:15], v248 offset:1448
  ds_read_b64_tr_b16 v[16:17], v248 offset:1928
  ds_read_b64_tr_b16 v[18:19], v248 offset:2088
  s_lshl_b32 m0, s3, 10
  s_mul_i32 s68, s4, 81920
  s_add_u32 s68, s68, 1048576
  s_add_u32 s8, s20, s68
  s_addc_u32 s9, s21, 0
  s_mov_b32 s10, 81920
  v_xor_b32 v250, 16, v249
  s_waitcnt lgkmcnt(6)
  v_mfma_f32_32x32x16_bf16 v[20:35], v[4:7], v[84:87], 0
  v_mfma_f32_32x32x16_bf16 v[36:51], v[4:7], v[92:95], 0
  s_waitcnt lgkmcnt(0)
  v_mfma_f32_32x32x16_bf16 v[20:35], v[8:11], v[88:91], v[20:35]
  ds_read_b64_tr_b16 v[148:149], v248 offset:2576
  ds_read_b64_tr_b16 v[150:151], v248 offset:2736
  ds_read_b64_tr_b16 v[152:153], v248 offset:3216
  v_mfma_f32_32x32x16_bf16 v[36:51], v[8:11], v[96:99], v[36:51]
  ds_read_b64_tr_b16 v[154:155], v248 offset:3376
  ds_read_b64_tr_b16 v[156:157], v248 offset:3864
  ds_read_b64_tr_b16 v[158:159], v248 offset:4024
  v_mfma_f32_32x32x16_bf16 v[20:35], v[12:15], v[136:139], v[20:35]
  ds_read_b64_tr_b16 v[160:161], v248 offset:4504
  ds_read_b64_tr_b16 v[162:163], v248 offset:4664
  ds_read_b128 v[100:103], v3 offset:4096
  v_mfma_f32_32x32x16_bf16 v[36:51], v[12:15], v[84:87], v[36:51]
  ds_read_b128 v[104:107], v3 offset:5120
  ds_read_b128 v[108:111], v3 offset:6144
  ds_read_b128 v[112:115], v3 offset:7168
  v_mfma_f32_32x32x16_bf16 v[20:35], v[16:19], v[140:143], v[20:35]
  ds_read_b128 v[116:119], v3 offset:8192
  ds_read_b128 v[120:123], v3 offset:9216
  ds_read_b128 v[124:127], v3 offset:10240
  v_mfma_f32_32x32x16_bf16 v[36:51], v[16:19], v[88:91], v[36:51]
  ds_read_b128 v[128:131], v3 offset:11264
  ds_read_b128 v[132:135], v3 offset:12288
  s_waitcnt lgkmcnt(9)
  v_mfma_f32_32x32x16_bf16 v[52:67], v[148:151], v[84:87], 0
  ds_read_b128 v[164:167], v247 offset:0
  ds_read_b128 v[168:171], v247 offset:1024
  v_mfma_f32_32x32x16_bf16 v[68:83], v[148:151], v[92:95], 0
  ds_read_b128 v[172:175], v247 offset:2048
  ds_read_b128 v[176:179], v247 offset:3072
  v_mfma_f32_32x32x16_bf16 v[52:67], v[152:155], v[88:91], v[52:67]
  ds_read_b128 v[180:183], v247 offset:4096
  ds_read_b128 v[184:187], v247 offset:5120
  s_waitcnt vmcnt(0)
  s_barrier
  s_mov_b64 exec, 0xffff
  buffer_load_dword v1, v251, s[20:23], s49 offen sc1
  s_mov_b64 exec, 15
  buffer_load_dword v1, v251, s[20:23], s50 offen sc1
  s_mov_b64 exec, -1
  s_waitcnt lgkmcnt(6)
  v_mul_f32 v144, v36, v112
  v_mul_f32 v145, v20, v112
  v_mul_f32 v146, v37, v113
  v_mul_f32 v147, v21, v113
  v_fma_f32 v20, v20, v100, -v144
  v_fma_f32 v36, v36, v100, v145
  v_mfma_f32_32x32x16_bf16 v[68:83], v[152:155], v[96:99], v[68:83]
  ds_read_b128 v[188:191], v247 offset:6144
  ds_read_b128 v[192:195], v247 offset:7168
  v_fma_f32 v21, v21, v101, -v146
  v_fma_f32 v37, v37, v101, v147
  v_cvt_pk_bf16_f32 v4, v20, v21
  v_cvt_pk_bf16_f32 v6, v36, v37
  v_mul_f32 v144, v38, v114
  v_mul_f32 v145, v22, v114
  v_mfma_f32_32x32x16_bf16 v[52:67], v[156:159], v[136:139], v[52:67]
  ds_read_b128 v[196:199], v247 offset:8192
  ds_read_b128 v[200:203], v247 offset:9216
  v_mul_f32 v146, v39, v115
  v_mul_f32 v147, v23, v115
  v_fma_f32 v22, v22, v102, -v144
  v_fma_f32 v38, v38, v102, v145
  v_fma_f32 v23, v23, v103, -v146
  v_fma_f32 v39, v39, v103, v147
  v_mfma_f32_32x32x16_bf16 v[68:83], v[156:159], v[84:87], v[68:83]
  ds_read_b128 v[204:207], v247 offset:10240
  ds_read_b128 v[208:211], v247 offset:11264
  v_cvt_pk_bf16_f32 v5, v22, v23
  v_cvt_pk_bf16_f32 v7, v38, v39
  v_mul_f32 v144, v40, v116
  v_mul_f32 v145, v24, v116
  v_mul_f32 v146, v41, v117
  v_mul_f32 v147, v25, v117
  v_mfma_f32_32x32x16_bf16 v[52:67], v[160:163], v[140:143], v[52:67]
  ds_read_b128 v[212:215], v247 offset:12288
  ds_read_b128 v[216:219], v247 offset:13312
  v_fma_f32 v24, v24, v104, -v144
  v_fma_f32 v40, v40, v104, v145
  v_fma_f32 v25, v25, v105, -v146
  v_fma_f32 v41, v41, v105, v147
  v_cvt_pk_bf16_f32 v8, v24, v25
  v_cvt_pk_bf16_f32 v10, v40, v41
  v_mfma_f32_32x32x16_bf16 v[68:83], v[160:163], v[88:91], v[68:83]
  ds_read_b128 v[220:223], v247 offset:14336
  ds_read_b128 v[224:227], v247 offset:15360
  v_pk_mul_f32 v[144:145], v[42:43], v[118:119]
  v_pk_mul_f32 v[146:147], v[26:27], v[118:119]
  v_pk_fma_f32 v[26:27], v[26:27], v[106:107], v[144:145] neg_lo:[0,0,1] neg_hi:[0,0,1]
  v_pk_fma_f32 v[42:43], v[42:43], v[106:107], v[146:147]
  v_cvt_pk_bf16_f32 v9, v26, v27
  v_cvt_pk_bf16_f32 v11, v42, v43
  v_pk_mul_f32 v[144:145], v[44:45], v[120:121]
  v_pk_mul_f32 v[146:147], v[28:29], v[120:121]
  v_pk_fma_f32 v[28:29], v[28:29], v[108:109], v[144:145] neg_lo:[0,0,1] neg_hi:[0,0,1]
  v_pk_fma_f32 v[44:45], v[44:45], v[108:109], v[146:147]
  v_cvt_pk_bf16_f32 v12, v28, v29
  v_cvt_pk_bf16_f32 v14, v44, v45
  v_pk_mul_f32 v[144:145], v[46:47], v[122:123]
  v_pk_mul_f32 v[146:147], v[30:31], v[122:123]
  v_pk_fma_f32 v[30:31], v[30:31], v[110:111], v[144:145] neg_lo:[0,0,1] neg_hi:[0,0,1]
  v_pk_fma_f32 v[46:47], v[46:47], v[110:111], v[146:147]
  v_cvt_pk_bf16_f32 v13, v30, v31
  v_cvt_pk_bf16_f32 v15, v46, v47
  s_nop 1
  v_mfma_f32_32x32x16_bf16 v[20:35], v[4:7], v[124:127], 0
  v_mul_f32 v144, v68, v112
  v_mul_f32 v145, v52, v112
  v_mul_f32 v146, v69, v113
  v_mul_f32 v147, v53, v113
  v_fma_f32 v52, v52, v100, -v144
  v_fma_f32 v68, v68, v100, v145
  v_fma_f32 v53, v53, v101, -v146
  v_mfma_f32_32x32x16_bf16 v[20:35], v[8:11], v[128:131], v[20:35]
  v_fma_f32 v69, v69, v101, v147
  v_cvt_pk_bf16_f32 v148, v52, v53
  v_cvt_pk_bf16_f32 v150, v68, v69
  v_mul_f32 v144, v70, v114
  v_mul_f32 v145, v54, v114
  v_mul_f32 v146, v71, v115
  v_mul_f32 v147, v55, v115
  v_mfma_f32_32x32x16_bf16 v[20:35], v[12:15], v[132:135], v[20:35]
  v_fma_f32 v54, v54, v102, -v144
  v_fma_f32 v70, v70, v102, v145
  v_fma_f32 v55, v55, v103, -v146
  v_fma_f32 v71, v71, v103, v147
  v_cvt_pk_bf16_f32 v149, v54, v55
  v_cvt_pk_bf16_f32 v151, v70, v71
  v_pk_mul_f32 v[144:145], v[72:73], v[116:117]
  v_pk_mul_f32 v[146:147], v[56:57], v[116:117]
  v_pk_fma_f32 v[56:57], v[56:57], v[104:105], v[144:145] neg_lo:[0,0,1] neg_hi:[0,0,1]
  v_pk_fma_f32 v[72:73], v[72:73], v[104:105], v[146:147]
  v_cvt_pk_bf16_f32 v152, v56, v57
  v_cvt_pk_bf16_f32 v154, v72, v73
  v_pk_mul_f32 v[144:145], v[74:75], v[118:119]
  v_pk_mul_f32 v[146:147], v[58:59], v[118:119]
  v_pk_fma_f32 v[58:59], v[58:59], v[106:107], v[144:145] neg_lo:[0,0,1] neg_hi:[0,0,1]
  v_pk_fma_f32 v[74:75], v[74:75], v[106:107], v[146:147]
  v_cvt_pk_bf16_f32 v153, v58, v59
  v_cvt_pk_bf16_f32 v155, v74, v75
  v_pk_mul_f32 v[144:145], v[76:77], v[120:121]
  v_pk_mul_f32 v[146:147], v[60:61], v[120:121]
  v_pk_fma_f32 v[60:61], v[60:61], v[108:109], v[144:145] neg_lo:[0,0,1] neg_hi:[0,0,1]
  v_pk_fma_f32 v[76:77], v[76:77], v[108:109], v[146:147]
  v_cvt_pk_bf16_f32 v156, v60, v61
  v_cvt_pk_bf16_f32 v158, v76, v77
  v_pk_mul_f32 v[144:145], v[78:79], v[122:123]
  v_pk_mul_f32 v[146:147], v[62:63], v[122:123]
  v_pk_fma_f32 v[62:63], v[62:63], v[110:111], v[144:145] neg_lo:[0,0,1] neg_hi:[0,0,1]
  v_pk_fma_f32 v[78:79], v[78:79], v[110:111], v[146:147]
  v_cvt_pk_bf16_f32 v157, v62, v63
  v_cvt_pk_bf16_f32 v159, v78, v79
  ds_read_b128 v[228:231], v247 offset:16384
  ds_read_b128 v[232:235], v247 offset:17408
  v_mfma_f32_32x32x16_bf16 v[52:67], v[148:151], v[124:127], 0
  v_cvt_pk_bf16_f32 v36, v20, v21
  v_cvt_pk_bf16_f32 v37, v22, v23
  v_cvt_pk_bf16_f32 v38, v24, v25
  v_cvt_pk_bf16_f32 v39, v26, v27
  v_mfma_f32_32x32x16_bf16 v[52:67], v[152:155], v[128:131], v[52:67]
  v_cvt_pk_bf16_f32 v40, v28, v29
  v_cvt_pk_bf16_f32 v41, v30, v31
  v_cvt_pk_bf16_f32 v42, v32, v33
  v_cvt_pk_bf16_f32 v43, v34, v35
  v_mfma_f32_32x32x16_bf16 v[52:67], v[156:159], v[132:135], v[52:67]
  s_mov_b64 exec, s[64:65]
  ds_write_b128 v249, v[36:39] offset:0
  ds_write_b128 v250, v[40:43] offset:0
  s_mov_b64 exec, -1
  ds_read_b128 v[236:239], v247 offset:18432
  ds_read_b128 v[240:243], v247 offset:19456
  s_nop 5
  v_cvt_pk_bf16_f32 v68, v52, v53
  v_cvt_pk_bf16_f32 v69, v54, v55
  v_cvt_pk_bf16_f32 v70, v56, v57
  v_cvt_pk_bf16_f32 v71, v58, v59
  v_cvt_pk_bf16_f32 v72, v60, v61
  v_cvt_pk_bf16_f32 v73, v62, v63
  v_cvt_pk_bf16_f32 v74, v64, v65
  v_cvt_pk_bf16_f32 v75, v66, v67
  s_mov_b64 exec, s[64:65]
  ds_write_b128 v249, v[68:71] offset:1280
  ds_write_b128 v250, v[72:75] offset:1280
  s_mov_b64 exec, -1
  s_waitcnt lgkmcnt(0)
  s_barrier
  buffer_load_dwordx4 v2, s[8:11], m0 offen sc1 lds
  s_add_u32 m0, m0, 40960
  s_nop 0
  buffer_load_dwordx4 v2, s[8:11], m0 offen sc1 lds
  s_sub_u32 m0, m0, 36864
  s_nop 0
  buffer_load_dwordx4 v2, s[8:11], m0 offen sc1 lds
  s_add_u32 m0, m0, 40960
  s_nop 0
  buffer_load_dwordx4 v2, s[8:11], m0 offen sc1 lds
  s_sub_u32 m0, m0, 36864
  s_nop 0
  buffer_load_dwordx4 v2, s[8:11], m0 offen sc1 lds
  s_add_u32 m0, m0, 40960
  s_nop 0
  buffer_load_dwordx4 v2, s[8:11], m0 offen sc1 lds
  s_sub_u32 m0, m0, 36864
  s_nop 0
  buffer_load_dwordx4 v2, s[8:11], m0 offen sc1 lds
  s_add_u32 m0, m0, 40960
  s_nop 0
  buffer_load_dwordx4 v2, s[8:11], m0 offen sc1 lds
  s_sub_u32 m0, m0, 36864
  s_nop 0
  s_waitcnt vmcnt(6)
  s_barrier
  ds_read_b128 v[84:87], v244 offset:0
  ds_read_b128 v[88:91], v244 offset:2048
  buffer_load_dwordx4 v2, s[8:11], m0 offen sc1 lds
  s_add_u32 m0, m0, 40960
  s_nop 0
  buffer_load_dwordx4 v2, s[8:11], m0 offen sc1 lds
  s_sub_u32 m0, m0, 36864
  s_nop 0
  s_waitcnt vmcnt(6)
  s_barrier
  ds_read_b128 v[92:95], v244 offset:4096
  ds_read_b128 v[96:99], v244 offset:6144
  s_waitcnt lgkmcnt(3)
  v_mfma_f32_16x16x32_bf16 v[116:119], v[164:167], v[84:87], 0
  s_waitcnt lgkmcnt(2)
  v_mfma_f32_16x16x32_bf16 v[116:119], v[168:171], v[88:91], v[116:119]
  buffer_load_dwordx4 v2, s[8:11], m0 offen sc1 lds
  s_add_u32 m0, m0, 40960
  s_nop 0
  buffer_load_dwordx4 v2, s[8:11], m0 offen sc1 lds
  s_sub_u32 m0, m0, 36864
  s_nop 0
  s_waitcnt vmcnt(6)
  s_barrier
  ds_read_b128 v[100:103], v244 offset:8192
  ds_read_b128 v[104:107], v244 offset:10240
  s_waitcnt lgkmcnt(3)
  v_mfma_f32_16x16x32_bf16 v[116:119], v[172:175], v[92:95], v[116:119]
  s_waitcnt lgkmcnt(2)
  v_mfma_f32_16x16x32_bf16 v[116:119], v[176:179], v[96:99], v[116:119]
  buffer_load_dwordx4 v2, s[8:11], m0 offen sc1 lds
  s_add_u32 m0, m0, 40960
  s_nop 0
  buffer_load_dwordx4 v2, s[8:11], m0 offen sc1 lds
  s_sub_u32 m0, m0, 36864
  s_nop 0
  s_waitcnt vmcnt(6)
  s_barrier
  ds_read_b128 v[108:111], v244 offset:12288
  ds_read_b128 v[112:115], v244 offset:14336
  s_waitcnt lgkmcnt(3)
  v_mfma_f32_16x16x32_bf16 v[116:119], v[180:183], v[100:103], v[116:119]
  s_waitcnt lgkmcnt(2)
  v_mfma_f32_16x16x32_bf16 v[116:119], v[184:187], v[104:107], v[116:119]
  buffer_load_dwordx4 v2, s[8:11], m0 offen sc1 lds
  s_add_u32 m0, m0, 40960
  s_nop 0
  buffer_load_dwordx4 v2, s[8:11], m0 offen sc1 lds
  s_sub_u32 m0, m0, 36864
  s_nop 0
  s_waitcnt vmcnt(6)
  s_barrier
  ds_read_b128 v[84:87], v244 offset:16384
  ds_read_b128 v[88:91], v244 offset:18432
  s_waitcnt lgkmcnt(3)
  v_mfma_f32_16x16x32_bf16 v[116:119], v[188:191], v[108:111], v[116:119]
  s_waitcnt lgkmcnt(2)
  v_mfma_f32_16x16x32_bf16 v[116:119], v[192:195], v[112:115], v[116:119]
  buffer_load_dwordx4 v2, s[8:11], m0 offen sc1 lds
  s_add_u32 m0, m0, 40960
  s_nop 0
  buffer_load_dwordx4 v2, s[8:11], m0 offen sc1 lds
  s_sub_u32 m0, m0, 36864
  s_nop 0
  s_waitcnt vmcnt(6)
  s_barrier
  ds_read_b128 v[92:95], v244 offset:20480
  ds_read_b128 v[96:99], v244 offset:22528
  s_waitcnt lgkmcnt(3)
  v_mfma_f32_16x16x32_bf16 v[116:119], v[196:199], v[84:87], v[116:119]
  s_waitcnt lgkmcnt(2)
  v_mfma_f32_16x16x32_bf16 v[116:119], v[200:203], v[88:91], v[116:119]
  buffer_load_dwordx4 v2, s[8:11], m0 offen sc1 lds
  s_add_u32 m0, m0, 40960
  s_nop 0
  buffer_load_dwordx4 v2, s[8:11], m0 offen sc1 lds
  s_sub_u32 m0, m0, 36864
  s_nop 0
  s_waitcnt vmcnt(6)
  s_barrier
  s_waitcnt vmcnt(4)
  s_barrier
  ds_read_b128 v[100:103], v244 offset:24576
  ds_read_b128 v[104:107], v244 offset:26624
  ds_read_b128 v[108:111], v244 offset:28672
  ds_read_b128 v[112:115], v244 offset:30720
  s_waitcnt lgkmcnt(5)
  v_mfma_f32_16x16x32_bf16 v[116:119], v[204:207], v[92:95], v[116:119]
  s_waitcnt lgkmcnt(4)
  v_mfma_f32_16x16x32_bf16 v[116:119], v[208:211], v[96:99], v[116:119]
  s_waitcnt vmcnt(0)
  s_barrier
  ds_read_b64 v[84:85], v245 offset:0
  ds_read_b64 v[86:87], v245 offset:1024
  ds_read_b64 v[88:89], v245 offset:2048
  ds_read_b64 v[90:91], v245 offset:3072
  ds_read_b64 v[92:93], v245 offset:4096
  ds_read_b64 v[94:95], v245 offset:5120
  ds_read_b64 v[96:97], v245 offset:6144
  ds_read_b64 v[98:99], v245 offset:7168
  s_waitcnt lgkmcnt(11)
  v_mfma_f32_16x16x32_bf16 v[116:119], v[212:215], v[100:103], v[116:119]
  s_waitcnt lgkmcnt(10)
  v_mfma_f32_16x16x32_bf16 v[116:119], v[216:219], v[104:107], v[116:119]
  s_waitcnt lgkmcnt(9)
  v_mfma_f32_16x16x32_bf16 v[116:119], v[220:223], v[108:111], v[116:119]
  s_waitcnt lgkmcnt(8)
  v_mfma_f32_16x16x32_bf16 v[116:119], v[224:227], v[112:115], v[116:119]
  s_waitcnt lgkmcnt(6)
  v_mfma_f32_16x16x32_bf16 v[116:119], v[228:231], v[84:87], v[116:119]
  s_waitcnt lgkmcnt(4)
  v_mfma_f32_16x16x32_bf16 v[116:119], v[232:235], v[88:91], v[116:119]
  s_waitcnt lgkmcnt(2)
  v_mfma_f32_16x16x32_bf16 v[116:119], v[236:239], v[92:95], v[116:119]
  s_waitcnt lgkmcnt(0)
  v_mfma_f32_16x16x32_bf16 v[116:119], v[240:243], v[96:99], v[116:119]
  s_nop 7
  v_cvt_pk_bf16_f32 v116, v116, v117
  v_cvt_pk_bf16_f32 v117, v118, v119
  ds_write_b64 v246, v[116:117]
  s_branch L_fin
L_flag1:
  s_mov_b32 s62, 0
L_non:
  s_waitcnt vmcnt(0)
  v_readfirstlane_b32 s44, v16
  s_add_u32 s62, s62, 1
  s_cmp_gt_u32 s62, 200000
  s_cbranch_scc1 L_gotnon
  s_cmp_lg_u32 s44, 0
  s_cbranch_scc1 L_gotnon
  global_load_dword v16, v17, s[40:41] sc1
  s_branch L_non
L_gotnon:
  s_lshl_b32 s68, s4, 3
  s_add_u32 s68, s68, s5
  s_mul_i32 s68, s68, 8
  s_add_u32 s68, s68, s3
  s_lshl_b32 s68, s68, 2
  s_add_u32 s68, s68, 262136
  v_mov_b32 v18, 158720
  s_mov_b64 exec, 1
  buffer_store_dword v16, v17, s[20:23], s68 offen sc1
  s_mov_b64 exec, s[36:37]
  buffer_load_dword v198, v15, s[20:23], s38 offen sc1
  s_mov_b64 exec, -1
  ds_write_b32 v18, v16
  s_mov_b32 s48, 8
  s_setpc_b64 s[52:53]
L_loader:
  s_lshl_b32 s47, s3, 1
  s_sub_u32 s47, s47, 8
  s_mov_b32 s39, 0x20000
  s_cmp_ge_u32 s47, 5
  s_cbranch_scc1 L_sx0
  s_lshl_b32 s6, s47, 6
  v_add_u32 v21, s6, v0
  v_mul_u32_u24 v23, 0x667, v21
  v_lshrrev_b32 v23, 14, v23
  s_mov_b32 s38, 819200
  v_mul_u32_u24 v24, 10, v23
  s_mov_b32 s17, 81920
  v_sub_u32 v24, v21, v24
  s_lshl_b32 s19, s47, 10
  v_lshrrev_b32 v25, 3, v23
  s_add_u32 s19, s19, 107520
  v_xor_b32 v26, v25, v23
  s_mov_b32 s30, 5120
  v_and_b32 v26, 1, v26
  s_mov_b32 s31, 10240
  v_lshl_add_u32 v25, v25, 1, v26
  s_mov_b32 s34, 51200
  v_bfe_u32 v26, v23, 1, 2
  s_mul_i32 s6, s5, 160
  v_lshl_add_u32 v25, v25, 2, v26
  v_mul_u32_u24 v25, 0x500, v25
  v_lshl_add_u32 v24, v24, 4, s6
  v_add_u32 v5, v24, v25
  v_add_u32 v6, 40960, v5
  s_branch L_se0
L_sx0:
  s_add_u32 s6, s47, s46
  s_and_b32 s6, s6, 3
  s_lshr_b32 s7, s5, 2
  s_lshl_b32 s6, s6, s7
  s_lshl_b32 s19, s6, 10
  s_add_u32 s19, s19, 25600
  s_lshl_b32 s30, s65, 10
  s_and_b32 s47, s6, 1
  s_lshl_b32 s47, s47, 6
  v_xor_b32 v21, s47, v3
  s_lshl_b32 s7, s7, 6
  v_xor_b32 v22, s7, v21
  s_lshl_b32 s7, s4, 3
  s_add_u32 s6, s6, s7
  s_mul_i32 s7, s6, 10240
  v_add_u32 v5, s7, v21
  s_add_u32 s6, s6, s65
  s_mul_i32 s7, s6, 10240
  v_add_u32 v6, s7, v22
  s_mov_b32 s38, 2621440
  s_mov_b32 s17, 128
  s_mov_b32 s31, 8192
  s_mov_b32 s34, 0
L_se0:
  s_lshl_b32 s6, s45, 1
  s_mul_i32 s16, s6, s17
  s_mul_i32 s18, s17, 10
  s_lshl_b32 s47, s3, 1
  s_sub_u32 s47, s47, 7
  s_mov_b32 s15, 0x20000
  s_cmp_ge_u32 s47, 5
  s_cbranch_scc1 L_sx1
  s_lshl_b32 s6, s47, 6
  v_add_u32 v21, s6, v0
  v_mul_u32_u24 v23, 0x667, v21
  v_lshrrev_b32 v23, 14, v23
  s_mov_b32 s14, 819200
  v_mul_u32_u24 v24, 10, v23
  s_mov_b32 s27, 81920
  v_sub_u32 v24, v21, v24
  s_lshl_b32 s44, s47, 10
  v_lshrrev_b32 v25, 3, v23
  s_add_u32 s44, s44, 107520
  v_xor_b32 v26, v25, v23
  s_mov_b32 s64, 5120
  v_and_b32 v26, 1, v26
  s_mov_b32 s66, 10240
  v_lshl_add_u32 v25, v25, 1, v26
  s_mov_b32 s67, 51200
  v_bfe_u32 v26, v23, 1, 2
  s_mul_i32 s6, s5, 160
  v_lshl_add_u32 v25, v25, 2, v26
  v_mul_u32_u24 v25, 0x500, v25
  v_lshl_add_u32 v24, v24, 4, s6
  v_add_u32 v7, v24, v25
  v_add_u32 v8, 40960, v7
  s_branch L_se1
L_sx1:
  s_add_u32 s6, s47, s46
  s_and_b32 s6, s6, 3
  s_lshr_b32 s7, s5, 2
  s_lshl_b32 s6, s6, s7
  s_lshl_b32 s44, s6, 10
  s_add_u32 s44, s44, 25600
  s_lshl_b32 s64, s65, 10
  s_and_b32 s47, s6, 1
  s_lshl_b32 s47, s47, 6
  v_xor_b32 v21, s47, v3
  s_lshl_b32 s7, s7, 6
  v_xor_b32 v22, s7, v21
  s_lshl_b32 s7, s4, 3
  s_add_u32 s6, s6, s7
  s_mul_i32 s7, s6, 10240
  v_add_u32 v7, s7, v21
  s_add_u32 s6, s6, s65
  s_mul_i32 s7, s6, 10240
  v_add_u32 v8, s7, v22
  s_mov_b32 s14, 2621440
  s_mov_b32 s27, 128
  s_mov_b32 s66, 8192
  s_mov_b32 s67, 0
L_se1:
  s_lshl_b32 s6, s45, 1
  s_mul_i32 s26, s6, s27
  s_mul_i32 s35, s27, 10
  s_and_b32 s6, s3, 3
  s_lshl_b32 s6, s6, 6
  v_add_u32 v21, s6, v0
  v_mul_u32_u24 v48, 32, v0
  s_and_b32 s6, s2, 7
  s_mul_i32 s6, s6, 1024
  v_and_b32 v47, 1023, v48
  v_add_u32 v47, s6, v47
  s_add_u32 s6, s6, 1024
  v_add_u32 v48, s6, v48
  v_and_b32 v48, 8191, v48
  v_mul_u32_u24 v49, 32, v21
  v_and_b32 v20, 1, v0
  v_mul_u32_u24 v20, 40896, v20
  v_lshl_add_u32 v20, v0, 6, v20
  s_waitcnt lgkmcnt(0)
  s_cmp_ge_u32 s3, 7
  s_cselect_b32 s36, s48, s50
  s_cselect_b32 s37, s49, s51
  s_cmp_ge_u32 s3, 6
  s_cselect_b32 s12, s48, s50
  s_cselect_b32 s13, s49, s51
  s_mov_b32 s28, s56
  s_mov_b32 s29, s57
  s_mov_b32 s32, s58
  s_mov_b32 s33, s59
  s_mov_b32 s40, s60
  s_mov_b32 s41, s61
  s_mov_b32 s20, s62
  s_mov_b32 s21, s63
  s_mov_b32 m0, s19
  s_add_u32 s19, s19, s31
  buffer_load_dwordx4 v5, s[36:39], s16 offen  lds
  s_add_u32 m0, m0, s30
  s_add_u32 s6, s16, s17
  buffer_load_dwordx4 v6, s[36:39], s16 offen  lds
  s_cmp_eq_u32 s6, s18
  s_cselect_b32 s16, 0, s6
  s_mov_b32 m0, s44
  s_add_u32 s44, s44, s66
  buffer_load_dwordx4 v7, s[12:15], s26 offen  lds
  s_add_u32 m0, m0, s64
  s_add_u32 s6, s26, s27
  buffer_load_dwordx4 v8, s[12:15], s26 offen  lds
  s_cmp_eq_u32 s6, s35
  s_cselect_b32 s26, 0, s6
  s_mov_b32 m0, s19
  s_add_u32 s19, s19, s31
  buffer_load_dwordx4 v5, s[36:39], s16 offen  lds
  s_add_u32 m0, m0, s30
  s_add_u32 s6, s16, s17
  buffer_load_dwordx4 v6, s[36:39], s16 offen  lds
  s_cmp_eq_u32 s6, s18
  s_cselect_b32 s16, 0, s6
  s_mov_b32 m0, s44
  s_add_u32 s44, s44, s66
  buffer_load_dwordx4 v7, s[12:15], s26 offen  lds
  s_add_u32 m0, m0, s64
  s_add_u32 s6, s26, s27
  buffer_load_dwordx4 v8, s[12:15], s26 offen  lds
  s_cmp_eq_u32 s6, s35
  s_cselect_b32 s26, 0, s6
  s_barrier
  s_mov_b32 m0, s19
  s_add_u32 s19, s19, s31
  buffer_load_dwordx4 v5, s[36:39], s16 offen  lds
  s_add_u32 m0, m0, s30
  s_add_u32 s6, s16, s17
  buffer_load_dwordx4 v6, s[36:39], s16 offen  lds
  s_cmp_eq_u32 s6, s18
  s_cselect_b32 s16, 0, s6
  s_mov_b32 m0, s44
  s_add_u32 s44, s44, s66
  buffer_load_dwordx4 v7, s[12:15], s26 offen  lds
  s_add_u32 m0, m0, s64
  s_add_u32 s6, s26, s27
  buffer_load_dwordx4 v8, s[12:15], s26 offen  lds
  s_cmp_eq_u32 s6, s35
  s_cselect_b32 s26, 0, s6
  s_mov_b32 s68, 262144
  v_mov_b32 v18, 158720
  s_and_b32 s6, s3, 3
  s_lshl_b32 s63, s6, 10
  s_and_b32 s6, s2, 7
  s_mul_i32 s6, s6, 20480
  s_add_u32 s47, s6, s63
  s_mov_b32 s46, 0
  s_waitcnt vmcnt(8)
  s_barrier
  s_mov_b32 m0, s19
  s_add_u32 s19, s19, s31
  buffer_load_dwordx4 v5, s[36:39], s16 offen  lds
  s_add_u32 m0, m0, s30
  s_add_u32 s6, s16, s17
  buffer_load_dwordx4 v6, s[36:39], s16 offen  lds
  s_cmp_eq_u32 s6, s18
  s_cselect_b32 s16, 0, s6
  s_mov_b32 m0, s44
  s_add_u32 s44, s44, s66
  buffer_load_dwordx4 v7, s[12:15], s26 offen  lds
  s_add_u32 m0, m0, s64
  s_add_u32 s6, s26, s27
  buffer_load_dwordx4 v8, s[12:15], s26 offen  lds
  s_cmp_eq_u32 s6, s35
  s_cselect_b32 s26, 0, s6
  s_waitcnt vmcnt(8)
  s_barrier
  s_mov_b32 m0, s19
  s_add_u32 s19, s19, s31
  buffer_load_dwordx4 v5, s[36:39], s16 offen  lds
  s_add_u32 m0, m0, s30
  s_add_u32 s6, s16, s17
  buffer_load_dwordx4 v6, s[36:39], s16 offen  lds
  s_cmp_eq_u32 s6, s18
  s_cselect_b32 s16, 0, s6
  s_mov_b32 m0, s44
  s_add_u32 s44, s44, s66
  buffer_load_dwordx4 v7, s[12:15], s26 offen  lds
  s_add_u32 m0, m0, s64
  s_add_u32 s6, s26, s27
  buffer_load_dwordx4 v8, s[12:15], s26 offen  lds
  s_cmp_eq_u32 s6, s35
  s_cselect_b32 s26, 0, s6
  s_waitcnt vmcnt(8)
  s_barrier
  s_sub_u32 s19, s19, s34
  s_mov_b32 m0, s19
  s_add_u32 s19, s19, s31
  buffer_load_dwordx4 v5, s[36:39], s16 offen  lds
  s_add_u32 m0, m0, s30
  s_add_u32 s6, s16, s17
  buffer_load_dwordx4 v6, s[36:39], s16 offen  lds
  s_cmp_eq_u32 s6, s18
  s_cselect_b32 s16, 0, s6
  s_sub_u32 s44, s44, s67
  s_mov_b32 m0, s44
  s_add_u32 s44, s44, s66
  buffer_load_dwordx4 v7, s[12:15], s26 offen  lds
  s_add_u32 m0, m0, s64
  s_add_u32 s6, s26, s27
  buffer_load_dwordx4 v8, s[12:15], s26 offen  lds
  s_cmp_eq_u32 s6, s35
  s_cselect_b32 s26, 0, s6
  s_waitcnt vmcnt(8)
  s_barrier
  s_mov_b32 m0, s19
  s_add_u32 s19, s19, s31
  buffer_load_dwordx4 v5, s[36:39], s16 offen  lds
  s_add_u32 m0, m0, s30
  s_add_u32 s6, s16, s17
  buffer_load_dwordx4 v6, s[36:39], s16 offen  lds
  s_cmp_eq_u32 s6, s18
  s_cselect_b32 s16, 0, s6
  s_mov_b32 m0, s44
  s_add_u32 s44, s44, s66
  buffer_load_dwordx4 v7, s[12:15], s26 offen  lds
  s_add_u32 m0, m0, s64
  s_add_u32 s6, s26, s27
  buffer_load_dwordx4 v8, s[12:15], s26 offen  lds
  s_cmp_eq_u32 s6, s35
  s_cselect_b32 s26, 0, s6
  s_waitcnt vmcnt(8)
  s_barrier
  s_mov_b32 m0, s19
  s_add_u32 s19, s19, s31
  buffer_load_dwordx4 v5, s[36:39], s16 offen  lds
  s_add_u32 m0, m0, s30
  s_add_u32 s6, s16, s17
  buffer_load_dwordx4 v6, s[36:39], s16 offen  lds
  s_cmp_eq_u32 s6, s18
  s_cselect_b32 s16, 0, s6
  s_mov_b32 m0, s44
  s_add_u32 s44, s44, s66
  buffer_load_dwordx4 v7, s[12:15], s26 offen  lds
  s_add_u32 m0, m0, s64
  s_add_u32 s6, s26, s27
  buffer_load_dwordx4 v8, s[12:15], s26 offen  lds
  s_cmp_eq_u32 s6, s35
  s_cselect_b32 s26, 0, s6
  s_waitcnt vmcnt(8)
  s_barrier
  s_mov_b32 m0, s19
  s_add_u32 s19, s19, s31
  buffer_load_dwordx4 v5, s[36:39], s16 offen  lds
  s_add_u32 m0, m0, s30
  s_add_u32 s6, s16, s17
  buffer_load_dwordx4 v6, s[36:39], s16 offen  lds
  s_cmp_eq_u32 s6, s18
  s_cselect_b32 s16, 0, s6
  s_mov_b32 m0, s44
  s_add_u32 s44, s44, s66
  buffer_load_dwordx4 v7, s[12:15], s26 offen  lds
  s_add_u32 m0, m0, s64
  s_add_u32 s6, s26, s27
  buffer_load_dwordx4 v8, s[12:15], s26 offen  lds
  s_cmp_eq_u32 s6, s35
  s_cselect_b32 s26, 0, s6
  s_waitcnt vmcnt(8)
  s_barrier
  ds_read_b32 v16, v18
  s_mov_b32 m0, s19
  s_add_u32 s19, s19, s31
  buffer_load_dwordx4 v5, s[36:39], s16 offen  lds
  s_add_u32 m0, m0, s30
  s_add_u32 s6, s16, s17
  buffer_load_dwordx4 v6, s[36:39], s16 offen  lds
  s_cmp_eq_u32 s6, s18
  s_cselect_b32 s16, 0, s6
  s_mov_b32 m0, s44
  s_add_u32 s44, s44, s66
  buffer_load_dwordx4 v7, s[12:15], s26 offen  lds
  s_add_u32 m0, m0, s64
  s_add_u32 s6, s26, s27
  buffer_load_dwordx4 v8, s[12:15], s26 offen  lds
  s_cmp_eq_u32 s6, s35
  s_cselect_b32 s26, 0, s6
  s_waitcnt vmcnt(8)
  s_barrier
  buffer_load_dwordx2 v[50:51], v47, s[20:23], s68 offen sc1
  s_mov_b32 m0, s63
  s_waitcnt lgkmcnt(0)
  v_readfirstlane_b32 s44, v16
  v_readfirstlane_b32 s45, v16
  s_and_b32 s57, s2, 7
  s_lshl_b32 s57, s57, 3
  s_bfe_u32 s6, s2, 0x30003
  s_add_u32 s57, s57, s6
  s_lshr_b32 s58, s2, 6
  s_lshr_b32 s60, s58, 1
  s_sub_u32 s6, 128, s57
  s_cmp_eq_u32 s57, 0
  s_cselect_b32 s6, 64, s6
  s_cselect_b32 s66, 0, 512
  s_mul_i32 s7, s66, 3
  s_cmp_eq_u32 s60, 0
  s_cselect_b32 s59, s57, s6
  s_cselect_b32 s66, s7, s66
  s_and_b32 s6, s58, 1
  s_lshl_b32 s6, s6, 10
  s_add_u32 s59, s59, s6
  v_lshrrev_b32 v23, 5, v0
  v_cmp_eq_u32 vcc, s60, v23
  v_bfe_u32 v21, v0, 1, 3
  v_lshl_add_u32 v21, v21, 7, s59
  v_and_b32 v22, 1, v0
  v_lshlrev_b32 v22, 9, v22
  v_mad_u32_u24 v22, v23, s66, v22
  v_bfe_u32 v24, v0, 4, 1
  v_mad_u32_u24 v22, v24, v21, v22
  v_cvt_f32_u32 v21, v21
  v_cvt_f32_u32 v22, v22
  v_mul_f32 v21, 0x3a800000, v21
  v_mul_f32 v22, 0x3a000000, v22
  s_cmp_eq_u32 s57, 0
  s_cselect_b64 vcc, vcc, -1
  s_waitcnt vmcnt(5)
  s_barrier
  s_and_b32 s6, s2, 7
  s_lshl_b32 s6, s6, 1
  s_bfe_u32 s7, s2, 0x10003
  s_add_u32 s6, s6, s7
  s_lshr_b32 s7, s2, 4
  s_lshl_b32 s56, s7, 4
  s_add_u32 s56, s56, s6
  s_mul_i32 s6, s6, 1280
  s_mul_i32 s7, s7, 80
  s_add_u32 s69, s6, s7
  s_and_b32 s55, s3, 3
  s_lshl_b32 s56, s56, 2
  s_add_u32 s56, s56, s55
  s_mul_i32 s56, s56, 2560
  s_add_u32 s56, s56, 4194304
  s_mov_b32 s26, 2621440
  s_mov_b32 s27, 0x20000
  s_mov_b32 s30, 819200
  s_mov_b32 s31, 0x20000
  s_mov_b32 s34, 5242880
  s_mov_b32 s35, 0x20000
  s_mul_i32 s6, s55, 17408
  s_add_u32 s6, s6, tab_h-L_pc+4096
  s_add_u32 s12, s42, s6
  s_addc_u32 s13, s43, 0
  s_add_u32 s14, s12, 8192
  s_addc_u32 s15, s13, 0
  s_add_u32 s52, s12, 16384
  s_addc_u32 s53, s13, 0
  s_waitcnt vmcnt(0)
  v_cmp_ne_u64 s[6:7], s[44:45], v[50:51]
  s_cmp_eq_u64 s[6:7], 0
  s_cbranch_scc0 L_late
  buffer_load_dwordx4 v2, s[20:23], s47 offen sc1 lds
  s_add_u32 m0, m0, 4096
  s_add_u32 s47, s47, 4096
  s_sub_u32 s7, s47, 163840
  s_min_u32 s47, s47, s7
  buffer_load_dwordx4 v2, s[20:23], s47 offen sc1 lds
  s_add_u32 m0, m0, 4096
  s_add_u32 s47, s47, 4096
  s_sub_u32 s7, s47, 163840
  s_min_u32 s47, s47, s7
  s_barrier
  buffer_load_dwordx4 v2, s[20:23], s47 offen sc1 lds
  s_add_u32 m0, m0, 4096
  s_add_u32 s47, s47, 4096
  s_sub_u32 s7, s47, 163840
  s_min_u32 s47, s47, s7
  buffer_load_dwordx4 v2, s[20:23], s47 offen sc1 lds
  s_add_u32 m0, m0, 4096
  s_add_u32 s47, s47, 4096
  s_sub_u32 s7, s47, 163840
  s_min_u32 s47, s47, s7
  buffer_load_dwordx4 v2, s[20:23], s47 offen sc1 lds
  s_add_u32 m0, m0, 4096
  s_add_u32 s47, s47, 4096
  s_sub_u32 s7, s47, 163840
  s_min_u32 s47, s47, s7
  s_branch L_kvgo
L_late:
  buffer_load_dwordx2 v[50:51], v47, s[20:23], s68 offen sc1
  s_barrier
  s_mov_b32 s62, 0
  s_waitcnt vmcnt(0)
L_pk:
  v_cmp_ne_u64 s[6:7], s[44:45], v[50:51]
  s_add_u32 s62, s62, 1
  s_cmp_gt_u32 s62, 200000
  s_cbranch_scc1 L_pkok
  s_cmp_eq_u64 s[6:7], 0
  s_cbranch_scc1 L_pkok
  buffer_load_dwordx2 v[50:51], v47, s[20:23], s68 offen sc1
  s_waitcnt vmcnt(0)
  s_branch L_pk
L_pkok:
  buffer_load_dwordx4 v2, s[20:23], s47 offen sc1 lds
  s_add_u32 m0, m0, 4096
  s_add_u32 s47, s47, 4096
  s_sub_u32 s7, s47, 163840
  s_min_u32 s47, s47, s7
  buffer_load_dwordx4 v2, s[20:23], s47 offen sc1 lds
  s_add_u32 m0, m0, 4096
  s_add_u32 s47, s47, 4096
  s_sub_u32 s7, s47, 163840
  s_min_u32 s47, s47, s7
  buffer_load_dwordx4 v2, s[20:23], s47 offen sc1 lds
  s_add_u32 m0, m0, 4096
  s_add_u32 s47, s47, 4096
  s_sub_u32 s7, s47, 163840
  s_min_u32 s47, s47, s7
  buffer_load_dwordx4 v2, s[20:23], s47 offen sc1 lds
  s_add_u32 m0, m0, 4096
  s_add_u32 s47, s47, 4096
  s_sub_u32 s7, s47, 163840
  s_min_u32 s47, s47, s7
  buffer_load_dwordx4 v2, s[20:23], s47 offen sc1 lds
  s_add_u32 m0, m0, 4096
  s_add_u32 s47, s47, 4096
  s_sub_u32 s7, s47, 163840
  s_min_u32 s47, s47, s7
L_kvgo:
  v_cos_f32 v25, v22
  v_add_f32 v22, v22, v21
  v_cos_f32 v26, v22
  v_add_f32 v22, v22, v21
  v_cvt_pk_bf16_f32 v24, v25, v26
  v_cndmask_b32 v252, 0, v24, vcc
  v_cos_f32 v25, v22
  v_add_f32 v22, v22, v21
  v_cos_f32 v26, v22
  v_add_f32 v22, v22, v21
  v_cvt_pk_bf16_f32 v24, v25, v26
  v_cndmask_b32 v253, 0, v24, vcc
  v_cos_f32 v25, v22
  v_add_f32 v22, v22, v21
  v_cos_f32 v26, v22
  v_add_f32 v22, v22, v21
  v_cvt_pk_bf16_f32 v24, v25, v26
  v_cndmask_b32 v254, 0, v24, vcc
  v_cos_f32 v25, v22
  v_add_f32 v22, v22, v21
  v_cos_f32 v26, v22
  v_add_f32 v22, v22, v21
  v_cvt_pk_bf16_f32 v24, v25, v26
  v_cndmask_b32 v255, 0, v24, vcc
  s_waitcnt vmcnt(0)
  s_barrier
  buffer_load_dwordx2 v[50:51], v48, s[20:23], s68 offen sc1
  s_setprio 3
  s_mov_b32 s62, 0
  s_waitcnt vmcnt(0)
L_pa:
  v_cmp_ne_u64 s[6:7], s[44:45], v[50:51]
  s_add_u32 s62, s62, 1
  s_cmp_gt_u32 s62, 200000
  s_cbranch_scc1 L_paok
  s_cmp_eq_u64 s[6:7], 0
  s_cbranch_scc1 L_paok
  buffer_load_dwordx2 v[50:51], v48, s[20:23], s68 offen sc1
  s_waitcnt vmcnt(0)
  s_branch L_pa
L_paok:
  buffer_load_dwordx4 v2, s[20:23], s47 offen sc1 lds
  s_add_u32 m0, m0, 4096
  s_add_u32 s47, s47, 4096
  s_sub_u32 s7, s47, 163840
  s_min_u32 s47, s47, s7
  buffer_load_dwordx4 v2, s[20:23], s47 offen sc1 lds
  s_add_u32 m0, m0, 4096
  s_add_u32 s47, s47, 4096
  s_sub_u32 s7, s47, 163840
  s_min_u32 s47, s47, s7
  buffer_load_dwordx4 v2, s[20:23], s47 offen sc1 lds
  s_add_u32 m0, m0, 4096
  s_add_u32 s47, s47, 4096
  s_sub_u32 s7, s47, 163840
  s_min_u32 s47, s47, s7
  buffer_load_dwordx4 v2, s[20:23], s47 offen sc1 lds
  s_add_u32 m0, m0, 4096
  s_add_u32 s47, s47, 4096
  s_sub_u32 s7, s47, 163840
  s_min_u32 s47, s47, s7
  buffer_load_dwordx4 v2, s[20:23], s47 offen sc1 lds
  s_add_u32 m0, m0, 4096
  s_add_u32 s47, s47, 4096
  s_sub_u32 s7, s47, 163840
  s_min_u32 s47, s47, s7
  buffer_load_dwordx2 v[50:51], v49, s[20:23], s68 offen sc1
  global_load_dwordx4 v[24:27], v2, s[14:15] offset:-3072
  global_load_dwordx4 v[28:31], v2, s[14:15] offset:-2048
  global_load_dwordx4 v[32:35], v2, s[14:15] offset:-1024
  global_load_dwordx4 v[36:39], v2, s[14:15] offset:0
  global_load_dwordx4 v[40:43], v2, s[14:15] offset:1024
  buffer_load_dwordx4 v2, s[20:23], s47 offen sc1 lds
  s_add_u32 m0, m0, 4096
  s_add_u32 s47, s47, 4096
  s_sub_u32 s7, s47, 163840
  s_min_u32 s47, s47, s7
  buffer_load_dwordx4 v2, s[20:23], s47 offen sc1 lds
  s_add_u32 m0, m0, 4096
  s_add_u32 s47, s47, 4096
  s_sub_u32 s7, s47, 163840
  s_min_u32 s47, s47, s7
  buffer_load_dwordx4 v2, s[20:23], s47 offen sc1 lds
  s_add_u32 m0, m0, 4096
  s_add_u32 s47, s47, 4096
  s_sub_u32 s7, s47, 163840
  s_min_u32 s47, s47, s7
  buffer_load_dwordx4 v2, s[20:23], s47 offen sc1 lds
  s_add_u32 m0, m0, 4096
  s_add_u32 s47, s47, 4096
  s_sub_u32 s7, s47, 163840
  s_min_u32 s47, s47, s7
  buffer_load_dwordx4 v2, s[20:23], s47 offen sc1 lds
  s_add_u32 m0, m0, 4096
  s_add_u32 s47, s47, 4096
  s_sub_u32 s7, s47, 163840
  s_min_u32 s47, s47, s7
  s_mov_b32 s62, 0
  s_waitcnt vmcnt(5)
L_pb:
  v_cmp_ne_u64 s[6:7], s[44:45], v[50:51]
  s_add_u32 s62, s62, 1
  s_cmp_gt_u32 s62, 200000
  s_cbranch_scc1 L_pbok
  s_cmp_eq_u64 s[6:7], 0
  s_cbranch_scc1 L_pbok
  buffer_load_dwordx2 v[50:51], v49, s[20:23], s68 offen sc1
  s_waitcnt vmcnt(0)
  s_branch L_pb
L_pbok:
  s_setprio 0
  s_barrier
  buffer_load_dwordx4 v2, s[20:23], s47 offen sc1 lds
  s_add_u32 m0, m0, 4096
  s_add_u32 s47, s47, 4096
  s_sub_u32 s7, s47, 163840
  s_min_u32 s47, s47, s7
  buffer_load_dwordx4 v2, s[20:23], s47 offen sc1 lds
  s_add_u32 m0, m0, 4096
  s_add_u32 s47, s47, 4096
  s_sub_u32 s7, s47, 163840
  s_min_u32 s47, s47, s7
  buffer_load_dwordx4 v2, s[20:23], s47 offen sc1 lds
  s_add_u32 m0, m0, 4096
  s_add_u32 s47, s47, 4096
  s_sub_u32 s7, s47, 163840
  s_min_u32 s47, s47, s7
  buffer_load_dwordx4 v2, s[20:23], s47 offen sc1 lds
  s_add_u32 m0, m0, 4096
  s_add_u32 s47, s47, 4096
  s_sub_u32 s7, s47, 163840
  s_min_u32 s47, s47, s7
  buffer_load_dwordx4 v2, s[20:23], s47 offen sc1 lds
  s_add_u32 m0, m0, 4096
  s_add_u32 s47, s47, 4096
  s_sub_u32 s7, s47, 163840
  s_min_u32 s47, s47, s7
  s_mov_b32 s68, m0
  s_lshl_b32 m0, s55, 10
  s_nop 0
  buffer_load_dwordx4 v24, s[24:27], s69 offen  lds
  s_add_u32 m0, m0, 4096
  s_cmp_ge_u32 s55, 2
  buffer_load_dwordx4 v25, s[24:27], s69 offen  lds
  s_cbranch_scc1 L_f2
  s_add_u32 m0, m0, 4096
  s_nop 0
  buffer_load_dwordx4 v26, s[24:27], s69 offen  lds
L_f2:
  s_mov_b32 m0, s68
  global_load_dwordx4 v[92:95], v2, s[12:13] offset:-4096
  global_load_dwordx4 v[96:99], v2, s[12:13] offset:-3072
  global_load_dwordx4 v[100:103], v2, s[12:13] offset:-2048
  global_load_dwordx4 v[104:107], v2, s[12:13] offset:-1024
  global_load_dwordx4 v[108:111], v2, s[12:13] offset:0
  global_load_dwordx4 v[112:115], v2, s[12:13] offset:1024
  global_load_dwordx4 v[116:119], v2, s[12:13] offset:2048
  global_load_dwordx4 v[120:123], v2, s[12:13] offset:3072
  global_load_dwordx4 v[124:127], v2, s[14:15] offset:-4096
  s_waitcnt vmcnt(0)
  s_barrier
  buffer_load_dwordx4 v2, s[20:23], s47 offen sc1 lds
  s_add_u32 m0, m0, 4096
  s_add_u32 s47, s47, 4096
  s_sub_u32 s7, s47, 163840
  s_min_u32 s47, s47, s7
  buffer_load_dwordx4 v2, s[20:23], s47 offen sc1 lds
  s_add_u32 m0, m0, 4096
  s_add_u32 s47, s47, 4096
  s_sub_u32 s7, s47, 163840
  s_min_u32 s47, s47, s7
  buffer_load_dwordx4 v2, s[20:23], s47 offen sc1 lds
  s_add_u32 m0, m0, 4096
  s_add_u32 s47, s47, 4096
  s_sub_u32 s7, s47, 163840
  s_min_u32 s47, s47, s7
  buffer_load_dwordx4 v2, s[20:23], s47 offen sc1 lds
  s_add_u32 m0, m0, 4096
  s_add_u32 s47, s47, 4096
  s_sub_u32 s7, s47, 163840
  s_min_u32 s47, s47, s7
  buffer_load_dwordx4 v2, s[20:23], s47 offen sc1 lds
  s_add_u32 m0, m0, 4096
  s_add_u32 s47, s47, 4096
  s_sub_u32 s7, s47, 163840
  s_min_u32 s47, s47, s7
  buffer_load_dwordx4 v2, s[20:23], s47 offen sc1 lds
  s_add_u32 m0, m0, 4096
  s_add_u32 s47, s47, 4096
  s_sub_u32 s7, s47, 163840
  s_min_u32 s47, s47, s7
  buffer_load_dwordx4 v2, s[20:23], s47 offen sc1 lds
  s_add_u32 m0, m0, 4096
  s_add_u32 s47, s47, 4096
  s_sub_u32 s7, s47, 163840
  s_min_u32 s47, s47, s7
  buffer_load_dwordx4 v2, s[20:23], s47 offen sc1 lds
  s_add_u32 m0, m0, 4096
  s_add_u32 s47, s47, 4096
  s_sub_u32 s7, s47, 163840
  s_min_u32 s47, s47, s7
  buffer_load_dwordx4 v2, s[20:23], s47 offen sc1 lds
  s_add_u32 m0, m0, 4096
  s_add_u32 s47, s47, 4096
  s_sub_u32 s7, s47, 163840
  s_min_u32 s47, s47, s7
  buffer_load_dwordx4 v2, s[20:23], s47 offen sc1 lds
  s_add_u32 m0, m0, 4096
  s_add_u32 s47, s47, 4096
  s_sub_u32 s7, s47, 163840
  s_min_u32 s47, s47, s7
  buffer_load_dwordx4 v2, s[20:23], s47 offen sc1 lds
  s_add_u32 m0, m0, 4096
  s_add_u32 s47, s47, 4096
  s_sub_u32 s7, s47, 163840
  s_min_u32 s47, s47, s7
  buffer_load_dwordx4 v2, s[20:23], s47 offen sc1 lds
  s_add_u32 m0, m0, 4096
  s_add_u32 s47, s47, 4096
  s_sub_u32 s7, s47, 163840
  s_min_u32 s47, s47, s7
  buffer_load_dwordx4 v2, s[20:23], s47 offen sc1 lds
  s_add_u32 m0, m0, 4096
  s_add_u32 s47, s47, 4096
  s_sub_u32 s7, s47, 163840
  s_min_u32 s47, s47, s7
  buffer_load_dwordx4 v2, s[20:23], s47 offen sc1 lds
  s_add_u32 m0, m0, 4096
  s_add_u32 s47, s47, 4096
  s_sub_u32 s7, s47, 163840
  s_min_u32 s47, s47, s7
  buffer_load_dwordx4 v2, s[20:23], s47 offen sc1 lds
  s_add_u32 m0, m0, 4096
  s_add_u32 s47, s47, 4096
  s_sub_u32 s7, s47, 163840
  s_min_u32 s47, s47, s7
  buffer_load_dwordx4 v2, s[20:23], s47 offen sc1 lds
  s_add_u32 m0, m0, 4096
  s_add_u32 s47, s47, 4096
  s_sub_u32 s7, s47, 163840
  s_min_u32 s47, s47, s7
  buffer_load_dwordx4 v2, s[20:23], s47 offen sc1 lds
  s_add_u32 m0, m0, 4096
  s_add_u32 s47, s47, 4096
  s_sub_u32 s7, s47, 163840
  s_min_u32 s47, s47, s7
  buffer_load_dwordx4 v2, s[20:23], s47 offen sc1 lds
  s_add_u32 m0, m0, 4096
  s_add_u32 s47, s47, 4096
  s_sub_u32 s7, s47, 163840
  s_min_u32 s47, s47, s7
  buffer_load_dwordx4 v2, s[20:23], s47 offen sc1 lds
  s_add_u32 m0, m0, 4096
  s_add_u32 s47, s47, 4096
  s_sub_u32 s7, s47, 163840
  s_min_u32 s47, s47, s7
  buffer_load_dwordx4 v2, s[20:23], s47 offen sc1 lds
  s_add_u32 m0, m0, 4096
  s_add_u32 s47, s47, 4096
  s_sub_u32 s7, s47, 163840
  s_min_u32 s47, s47, s7
  s_lshr_b32 s6, s2, 3
  s_lshl_b32 s6, s6, 2
  s_add_u32 s6, s6, s55
  s_mul_i32 s6, s6, 6400
  v_lshlrev_b32 v1, 7, v0
  s_mov_b32 exec_hi, 0x3ffff
  buffer_load_dword v1, v1, s[28:31], s6 offen
  s_mov_b32 exec_hi, -1
  ds_read_b64_tr_b16 v[128:129], v124 offset:0
  ds_read_b64_tr_b16 v[130:131], v124 offset:80
  ds_read_b64_tr_b16 v[132:133], v124 offset:32
  ds_read_b64_tr_b16 v[134:135], v124 offset:112
  ds_read_b64_tr_b16 v[136:137], v125 offset:0
  ds_read_b64_tr_b16 v[138:139], v125 offset:80
  ds_read_b64_tr_b16 v[140:141], v124 offset:2560
  ds_read_b64_tr_b16 v[142:143], v124 offset:2640
  ds_read_b64_tr_b16 v[144:145], v124 offset:2592
  ds_read_b64_tr_b16 v[146:147], v124 offset:2672
  ds_read_b64_tr_b16 v[148:149], v125 offset:2560
  ds_read_b64_tr_b16 v[150:151], v125 offset:2640
  ds_read_b64_tr_b16 v[152:153], v124 offset:5120
  ds_read_b64_tr_b16 v[154:155], v124 offset:5200
  ds_read_b64_tr_b16 v[156:157], v124 offset:5152
  ds_read_b64_tr_b16 v[158:159], v124 offset:5232
  ds_read_b64_tr_b16 v[160:161], v125 offset:5120
  ds_read_b64_tr_b16 v[162:163], v125 offset:5200
  ds_read_b64_tr_b16 v[164:165], v124 offset:7680
  ds_read_b64_tr_b16 v[166:167], v124 offset:7760
  ds_read_b64_tr_b16 v[168:169], v124 offset:7712
  ds_read_b64_tr_b16 v[170:171], v124 offset:7792
  ds_read_b64_tr_b16 v[172:173], v125 offset:7680
  ds_read_b64_tr_b16 v[174:175], v125 offset:7760
  s_waitcnt lgkmcnt(0)
  v_mfma_f32_16x16x32_bf16 v[176:179], v[128:131], v[92:95], 0
  v_mfma_f32_16x16x32_bf16 v[180:183], v[132:135], v[92:95], 0
  v_mfma_f32_16x16x32_bf16 v[184:187], v[136:139], v[92:95], 0
  v_mfma_f32_16x16x32_bf16 v[188:191], v[128:131], v[108:111], 0
  v_mfma_f32_16x16x32_bf16 v[192:195], v[132:135], v[108:111], 0
  v_mfma_f32_16x16x32_bf16 v[196:199], v[136:139], v[108:111], 0
  v_mfma_f32_16x16x32_bf16 v[176:179], v[140:143], v[96:99], v[176:179]
  v_mfma_f32_16x16x32_bf16 v[180:183], v[144:147], v[96:99], v[180:183]
  v_mfma_f32_16x16x32_bf16 v[184:187], v[148:151], v[96:99], v[184:187]
  v_mfma_f32_16x16x32_bf16 v[188:191], v[140:143], v[112:115], v[188:191]
  v_mfma_f32_16x16x32_bf16 v[192:195], v[144:147], v[112:115], v[192:195]
  v_mfma_f32_16x16x32_bf16 v[196:199], v[148:151], v[112:115], v[196:199]
  s_barrier
  v_mfma_f32_16x16x32_bf16 v[176:179], v[152:155], v[100:103], v[176:179]
  v_mfma_f32_16x16x32_bf16 v[180:183], v[156:159], v[100:103], v[180:183]
  v_mfma_f32_16x16x32_bf16 v[184:187], v[160:163], v[100:103], v[184:187]
  v_mfma_f32_16x16x32_bf16 v[188:191], v[152:155], v[116:119], v[188:191]
  v_mfma_f32_16x16x32_bf16 v[192:195], v[156:159], v[116:119], v[192:195]
  v_mfma_f32_16x16x32_bf16 v[196:199], v[160:163], v[116:119], v[196:199]
  v_mfma_f32_16x16x32_bf16 v[176:179], v[164:167], v[104:107], v[176:179]
  v_mfma_f32_16x16x32_bf16 v[180:183], v[168:171], v[104:107], v[180:183]
  v_mfma_f32_16x16x32_bf16 v[184:187], v[172:175], v[104:107], v[184:187]
  v_mfma_f32_16x16x32_bf16 v[188:191], v[164:167], v[120:123], v[188:191]
  v_mfma_f32_16x16x32_bf16 v[192:195], v[168:171], v[120:123], v[192:195]
  v_mfma_f32_16x16x32_bf16 v[196:199], v[172:175], v[120:123], v[196:199]
  s_nop 2
  v_cvt_pk_bf16_f32 v176, v176, v177
  v_cvt_pk_bf16_f32 v177, v178, v179
  ds_write_b64 v126, v[176:177] offset:0
  v_cvt_pk_bf16_f32 v180, v180, v181
  v_cvt_pk_bf16_f32 v181, v182, v183
  ds_write_b64 v126, v[180:181] offset:32
  v_cvt_pk_bf16_f32 v184, v184, v185
  v_cvt_pk_bf16_f32 v185, v186, v187
  v_cvt_pk_bf16_f32 v188, v188, v189
  v_cvt_pk_bf16_f32 v189, v190, v191
  ds_write_b64 v126, v[188:189] offset:1280
  v_cvt_pk_bf16_f32 v192, v192, v193
  v_cvt_pk_bf16_f32 v193, v194, v195
  ds_write_b64 v126, v[192:193] offset:1312
  v_cvt_pk_bf16_f32 v196, v196, v197
  v_cvt_pk_bf16_f32 v197, v198, v199
  s_mov_b32 exec_hi, 0
  ds_write_b64 v126, v[184:185] offset:64
  ds_write_b64 v126, v[196:197] offset:1344
  s_mov_b32 exec_hi, -1
  ds_read_b128 v[128:131], v127 offset:0
  ds_read_b128 v[132:135], v127 offset:1024
  ds_read_b128 v[136:139], v127 offset:2048
  s_waitcnt lgkmcnt(0)
  buffer_store_dwordx4 v[128:131], v2, s[20:23], s56 offen offset:0 sc1
  buffer_store_dwordx4 v[132:135], v2, s[20:23], s56 offen offset:1024 sc1
  s_mov_b32 exec_hi, 0
  buffer_store_dwordx4 v[136:139], v2, s[20:23], s56 offen offset:2048 sc1
  s_mov_b32 exec_hi, -1
  global_load_dwordx4 v[4:7], v2, s[14:15] offset:2048
  global_load_dwordx4 v[8:11], v2, s[14:15] offset:3072
  global_load_dwordx4 v[12:15], v2, s[52:53] offset:-4096
  s_mul_i32 s6, s2, 32
  s_add_u32 s6, s6, 327680
  v_mov_b32 v3, s44
  s_lshl_b32 m0, s55, 10
  s_mul_i32 s68, s5, 160
  s_waitcnt vmcnt(6)
  s_barrier
  buffer_load_dwordx4 v28, s[28:31], s68 offen  lds
  s_add_u32 m0, m0, 4096
  s_nop 0
  buffer_load_dwordx4 v29, s[28:31], s68 offen  lds
  s_add_u32 m0, m0, 4096
  s_nop 0
  buffer_load_dwordx4 v30, s[28:31], s68 offen  lds
  s_add_u32 m0, m0, 4096
  s_nop 0
  buffer_load_dwordx4 v31, s[28:31], s68 offen  lds
  s_add_u32 m0, m0, 4096
  s_nop 0
  buffer_load_dwordx4 v32, s[28:31], s68 offen  lds
  s_add_u32 m0, m0, 4096
  s_add_u32 s68, s68, 163840
  buffer_load_dwordx4 v28, s[28:31], s68 offen  lds
  s_add_u32 m0, m0, 4096
  s_nop 0
  buffer_load_dwordx4 v29, s[28:31], s68 offen  lds
  s_add_u32 m0, m0, 4096
  s_nop 0
  buffer_load_dwordx4 v30, s[28:31], s68 offen  lds
  s_add_u32 m0, m0, 4096
  s_nop 0
  buffer_load_dwordx4 v31, s[28:31], s68 offen  lds
  s_add_u32 m0, m0, 4096
  s_nop 0
  buffer_load_dwordx4 v32, s[28:31], s68 offen  lds
  s_add_u32 m0, m0, 4096
  s_add_u32 s68, s68, 163840
  buffer_load_dwordx4 v28, s[28:31], s68 offen  lds
  s_add_u32 m0, m0, 4096
  s_nop 0
  buffer_load_dwordx4 v29, s[28:31], s68 offen  lds
  s_add_u32 m0, m0, 4096
  s_nop 0
  buffer_load_dwordx4 v30, s[28:31], s68 offen  lds
  s_add_u32 m0, m0, 4096
  s_nop 0
  s_cmp_eq_u32 s3, 7
  s_waitcnt vmcnt(13)
  s_barrier
  s_cbranch_scc0 L_nofl2
  s_mov_b64 exec, 1
  buffer_store_dword v3, v2, s[20:23], s6 offen sc1
  s_mov_b64 exec, -1
L_nofl2:
  buffer_load_dwordx4 v31, s[28:31], s68 offen  lds
  s_add_u32 m0, m0, 4096
  s_nop 0
  buffer_load_dwordx4 v32, s[28:31], s68 offen  lds
  s_add_u32 m0, m0, 4096
  s_add_u32 s68, s68, 163840
  buffer_load_dwordx4 v28, s[28:31], s68 offen  lds
  s_add_u32 m0, m0, 4096
  s_nop 0
  buffer_load_dwordx4 v29, s[28:31], s68 offen  lds
  s_add_u32 m0, m0, 4096
  s_nop 0
  buffer_load_dwordx4 v30, s[28:31], s68 offen  lds
  s_add_u32 m0, m0, 4096
  s_nop 0
  buffer_load_dwordx4 v31, s[28:31], s68 offen  lds
  s_add_u32 m0, m0, 4096
  s_nop 0
  buffer_load_dwordx4 v32, s[28:31], s68 offen  lds
  s_add_u32 m0, m0, 4096
  s_add_u32 s68, s68, 163840
  buffer_load_dwordx4 v28, s[28:31], s68 offen  lds
  s_add_u32 m0, m0, 4096
  s_nop 0
  buffer_load_dwordx4 v29, s[28:31], s68 offen  lds
  s_add_u32 m0, m0, 4096
  s_nop 0
  buffer_load_dwordx4 v30, s[28:31], s68 offen  lds
  s_add_u32 m0, m0, 4096
  s_nop 0
  buffer_load_dwordx4 v31, s[28:31], s68 offen  lds
  s_add_u32 m0, m0, 4096
  s_nop 0
  buffer_load_dwordx4 v32, s[28:31], s68 offen  lds
  s_add_u32 m0, m0, 4096
  s_add_u32 s68, s68, 163840
  s_add_u32 s66, s42, tab_hid-L_pc
  s_addc_u32 s67, s43, 0
  s_lshl_b32 s6, s55, 10
  v_add_u32 v1, s6, v2
  s_mov_b32 s68, 327680
  s_waitcnt vmcnt(0)
  s_barrier
  s_lshl_b32 s6, s5, 7
  s_lshl_b32 s7, s4, 10
  s_add_u32 s6, s6, s7
  s_add_u32 s6, s6, 393216
  s_mov_b64 exec, 1
  buffer_load_dword v18, v2, s[20:23], s6 offen sc1
  s_mov_b64 exec, -1
  ds_read_b64_tr_b16 v[44:45], v40 offset:0
  ds_read_b64_tr_b16 v[46:47], v41 offset:0
  ds_read_b64_tr_b16 v[48:49], v40 offset:6400
  ds_read_b64_tr_b16 v[50:51], v41 offset:6400
  ds_read_b64_tr_b16 v[52:53], v40 offset:12800
  ds_read_b64_tr_b16 v[54:55], v41 offset:12800
  ds_read_b64_tr_b16 v[56:57], v40 offset:19200
  ds_read_b64_tr_b16 v[58:59], v41 offset:19200
  ds_read_b64_tr_b16 v[60:61], v42 offset:0
  ds_read_b64_tr_b16 v[62:63], v43 offset:0
  ds_read_b64_tr_b16 v[92:93], v4 offset:0
  ds_read_b64_tr_b16 v[94:95], v4 offset:1280
  ds_read_b64_tr_b16 v[96:97], v5 offset:0
  ds_read_b64_tr_b16 v[98:99], v5 offset:1280
  ds_read_b64_tr_b16 v[100:101], v4 offset:6400
  ds_read_b64_tr_b16 v[102:103], v4 offset:7680
  s_waitcnt lgkmcnt(6)
  ds_write_b128 v14, v[44:47] offset:0
  ds_write_b128 v14, v[48:51] offset:1024
  ds_write_b128 v14, v[52:55] offset:2048
  ds_write_b128 v14, v[56:59] offset:3072
  ds_write_b128 v15, v[60:63] offset:0
  ds_read_b64_tr_b16 v[104:105], v5 offset:6400
  ds_read_b64_tr_b16 v[106:107], v5 offset:7680
  ds_read_b64_tr_b16 v[108:109], v4 offset:12800
  ds_read_b64_tr_b16 v[110:111], v4 offset:14080
  ds_read_b64_tr_b16 v[112:113], v5 offset:12800
  ds_read_b64_tr_b16 v[114:115], v5 offset:14080
  ds_read_b64_tr_b16 v[116:117], v4 offset:19200
  ds_read_b64_tr_b16 v[118:119], v4 offset:20480
  ds_read_b64_tr_b16 v[120:121], v5 offset:19200
  ds_read_b64_tr_b16 v[122:123], v5 offset:20480
  ds_read_b64_tr_b16 v[124:125], v4 offset:25600
  ds_read_b64_tr_b16 v[126:127], v4 offset:26880
  ds_read_b64_tr_b16 v[128:129], v5 offset:25600
  ds_read_b64_tr_b16 v[130:131], v5 offset:26880
  ds_read_b64_tr_b16 v[132:133], v4 offset:32000
  ds_read_b64_tr_b16 v[134:135], v4 offset:33280
  ds_read_b64_tr_b16 v[136:137], v5 offset:32000
  ds_read_b64_tr_b16 v[138:139], v5 offset:33280
  ds_read_b64_tr_b16 v[140:141], v4 offset:38400
  ds_read_b64_tr_b16 v[142:143], v4 offset:39680
  ds_read_b64_tr_b16 v[144:145], v5 offset:38400
  ds_read_b64_tr_b16 v[146:147], v5 offset:39680
  ds_read_b64_tr_b16 v[148:149], v4 offset:44800
  ds_read_b64_tr_b16 v[150:151], v4 offset:46080
  ds_read_b64_tr_b16 v[152:153], v5 offset:44800
  ds_read_b64_tr_b16 v[154:155], v5 offset:46080
  ds_read_b64_tr_b16 v[220:221], v6 offset:0
  ds_read_b64_tr_b16 v[222:223], v6 offset:6400
  ds_read_b64_tr_b16 v[224:225], v6 offset:12800
  ds_read_b64_tr_b16 v[226:227], v6 offset:19200
  ds_read_b64_tr_b16 v[228:229], v6 offset:25600
  ds_read_b64_tr_b16 v[230:231], v6 offset:32000
  ds_read_b64_tr_b16 v[232:233], v6 offset:38400
  ds_read_b64_tr_b16 v[234:235], v6 offset:44800
  v_add_u32 v4, 51200, v4
  v_add_u32 v5, 51200, v5
  v_add_u32 v6, 51200, v6
  ds_read_b64_tr_b16 v[156:157], v4 offset:0
  ds_read_b64_tr_b16 v[158:159], v4 offset:1280
  ds_read_b64_tr_b16 v[160:161], v5 offset:0
  ds_read_b64_tr_b16 v[162:163], v5 offset:1280
  ds_read_b64_tr_b16 v[164:165], v4 offset:6400
  ds_read_b64_tr_b16 v[166:167], v4 offset:7680
  ds_read_b64_tr_b16 v[168:169], v5 offset:6400
  ds_read_b64_tr_b16 v[170:171], v5 offset:7680
  ds_read_b64_tr_b16 v[172:173], v4 offset:12800
  ds_read_b64_tr_b16 v[174:175], v4 offset:14080
  ds_read_b64_tr_b16 v[176:177], v5 offset:12800
  ds_read_b64_tr_b16 v[178:179], v5 offset:14080
  ds_read_b64_tr_b16 v[180:181], v4 offset:19200
  ds_read_b64_tr_b16 v[182:183], v4 offset:20480
  ds_read_b64_tr_b16 v[184:185], v5 offset:19200
  ds_read_b64_tr_b16 v[186:187], v5 offset:20480
  ds_read_b64_tr_b16 v[188:189], v4 offset:25600
  ds_read_b64_tr_b16 v[190:191], v4 offset:26880
  ds_read_b64_tr_b16 v[192:193], v5 offset:25600
  ds_read_b64_tr_b16 v[194:195], v5 offset:26880
  ds_read_b64_tr_b16 v[196:197], v4 offset:32000
  ds_read_b64_tr_b16 v[198:199], v4 offset:33280
  ds_read_b64_tr_b16 v[200:201], v5 offset:32000
  ds_read_b64_tr_b16 v[202:203], v5 offset:33280
  ds_read_b64_tr_b16 v[204:205], v4 offset:38400
  ds_read_b64_tr_b16 v[206:207], v4 offset:39680
  ds_read_b64_tr_b16 v[208:209], v5 offset:38400
  ds_read_b64_tr_b16 v[210:211], v5 offset:39680
  ds_read_b64_tr_b16 v[212:213], v4 offset:44800
  ds_read_b64_tr_b16 v[214:215], v4 offset:46080
  ds_read_b64_tr_b16 v[216:217], v5 offset:44800
  ds_read_b64_tr_b16 v[218:219], v5 offset:46080
  ds_read_b64_tr_b16 v[236:237], v6 offset:0
  ds_read_b64_tr_b16 v[238:239], v6 offset:6400
  ds_read_b64_tr_b16 v[240:241], v6 offset:12800
  ds_read_b64_tr_b16 v[242:243], v6 offset:19200
  ds_read_b64_tr_b16 v[244:245], v6 offset:25600
  ds_read_b64_tr_b16 v[246:247], v6 offset:32000
  ds_read_b64_tr_b16 v[248:249], v6 offset:38400
  ds_read_b64_tr_b16 v[250:251], v6 offset:44800
  buffer_load_dword v3, v27, s[20:23], s68 offen sc1
  s_mov_b32 s62, 0
L_pu:
  s_waitcnt vmcnt(0)
  v_cmp_ne_u32 vcc, s44, v3
  s_add_u32 s62, s62, 1
  s_cmp_gt_u32 s62, 200000
  s_cbranch_scc1 L_puok
  s_cbranch_vccz L_puok
  buffer_load_dword v3, v27, s[20:23], s68 offen sc1
  s_branch L_pu
L_puok:
  s_lshl_b32 m0, s55, 10
  s_mul_i32 s68, s57, 160
  s_add_u32 s68, s68, 4194304
  s_waitcnt lgkmcnt(0)
  s_barrier
  buffer_load_dwordx4 v33, s[20:23], s68 offen sc1 lds
  s_add_u32 m0, m0, 4096
  s_nop 0
  buffer_load_dwordx4 v34, s[20:23], s68 offen sc1 lds
  s_add_u32 m0, m0, 4096
  s_nop 0
  buffer_load_dwordx4 v35, s[20:23], s68 offen sc1 lds
  s_add_u32 m0, m0, 4096
  s_nop 0
  buffer_load_dwordx4 v36, s[20:23], s68 offen sc1 lds
  s_add_u32 m0, m0, 4096
  s_nop 0
  buffer_load_dwordx4 v37, s[20:23], s68 offen sc1 lds
  s_add_u32 m0, m0, 4096
  s_add_u32 s68, s68, 1310720
  buffer_load_dwordx4 v33, s[20:23], s68 offen sc1 lds
  s_add_u32 m0, m0, 4096
  s_nop 0
  buffer_load_dwordx4 v34, s[20:23], s68 offen sc1 lds
  s_add_u32 m0, m0, 4096
  s_nop 0
  buffer_load_dwordx4 v35, s[20:23], s68 offen sc1 lds
  s_add_u32 m0, m0, 4096
  s_nop 0
  buffer_load_dwordx4 v36, s[20:23], s68 offen sc1 lds
  s_add_u32 m0, m0, 4096
  s_nop 0
  buffer_load_dwordx4 v37, s[20:23], s68 offen sc1 lds
  s_add_u32 m0, m0, 4096
  s_add_u32 s68, s68, 1310720
  s_add_u32 m0, m0, 81920
  s_nop 0
  global_load_lds_dwordx4 v1, s[66:67]
  s_add_u32 m0, m0, 4096
  s_add_u32 s66, s66, 4096
  s_addc_u32 s67, s67, 0
  global_load_lds_dwordx4 v1, s[66:67]
  s_add_u32 m0, m0, 4096
  s_add_u32 s66, s66, 4096
  s_addc_u32 s67, s67, 0
  global_load_lds_dwordx4 v1, s[66:67]
  s_add_u32 m0, m0, 4096
  s_add_u32 s66, s66, 4096
  s_addc_u32 s67, s67, 0
  s_cmp_eq_u32 s55, 3
  s_cbranch_scc1 L_nt3
  global_load_lds_dwordx4 v1, s[66:67]
L_nt3:
  s_lshl_b32 s68, s4, 10
  s_add_u32 s68, s68, 393216
  s_waitcnt vmcnt(0)
  s_barrier
  ds_read_b64_tr_b16 v[44:45], v38 offset:0
  ds_read_b64_tr_b16 v[46:47], v38 offset:1280
  ds_read_b64_tr_b16 v[48:49], v38 offset:32
  ds_read_b64_tr_b16 v[50:51], v38 offset:1312
  ds_read_b64_tr_b16 v[52:53], v39 offset:64
  ds_read_b64_tr_b16 v[54:55], v39 offset:1344
  ds_read_b64_tr_b16 v[56:57], v38 offset:2576
  ds_read_b64_tr_b16 v[58:59], v38 offset:3856
  ds_read_b64_tr_b16 v[60:61], v38 offset:2608
  ds_read_b64_tr_b16 v[62:63], v38 offset:3888
  s_waitcnt lgkmcnt(8)
  v_mfma_f32_16x16x32_bf16 v[64:67], v[44:47], v[252:255], 0
  ds_read_b64_tr_b16 v[44:45], v38 offset:5120
  ds_read_b64_tr_b16 v[46:47], v38 offset:6400
  s_waitcnt lgkmcnt(8)
  v_mfma_f32_16x16x32_bf16 v[68:71], v[48:51], v[252:255], 0
  ds_read_b64_tr_b16 v[48:49], v38 offset:5152
  ds_read_b64_tr_b16 v[50:51], v38 offset:6432
  s_waitcnt lgkmcnt(8)
  v_mfma_f32_16x16x32_bf16 v[72:75], v[52:55], v[252:255], 0
  ds_read_b64_tr_b16 v[52:53], v39 offset:5184
  ds_read_b64_tr_b16 v[54:55], v39 offset:6464
  s_waitcnt lgkmcnt(8)
  v_mfma_f32_16x16x32_bf16 v[76:79], v[56:59], v[252:255], 0
  ds_read_b64_tr_b16 v[56:57], v38 offset:7696
  ds_read_b64_tr_b16 v[58:59], v38 offset:8976
  s_waitcnt lgkmcnt(8)
  v_mfma_f32_16x16x32_bf16 v[80:83], v[60:63], v[252:255], 0
  ds_read_b64_tr_b16 v[60:61], v38 offset:7728
  ds_read_b64_tr_b16 v[62:63], v38 offset:9008
  v_cvt_pk_bf16_f32 v64, v64, v65
  v_cvt_pk_bf16_f32 v65, v66, v67
  ds_write_b64 v7, v[64:65] offset:0
  v_cvt_pk_bf16_f32 v68, v68, v69
  v_cvt_pk_bf16_f32 v69, v70, v71
  ds_write_b64 v7, v[68:69] offset:32
  v_cvt_pk_bf16_f32 v72, v72, v73
  v_cvt_pk_bf16_f32 v73, v74, v75
  ds_write_b64 v7, v[72:73] offset:64
  v_cvt_pk_bf16_f32 v76, v76, v77
  v_cvt_pk_bf16_f32 v77, v78, v79
  ds_write_b64 v7, v[76:77] offset:96
  v_cvt_pk_bf16_f32 v80, v80, v81
  v_cvt_pk_bf16_f32 v81, v82, v83
  ds_write_b64 v7, v[80:81] offset:128
  s_waitcnt lgkmcnt(13)
  v_mfma_f32_16x16x32_bf16 v[64:67], v[44:47], v[252:255], 0
  s_waitcnt lgkmcnt(11)
  v_mfma_f32_16x16x32_bf16 v[68:71], v[48:51], v[252:255], 0
  s_waitcnt lgkmcnt(9)
  v_mfma_f32_16x16x32_bf16 v[72:75], v[52:55], v[252:255], 0
  s_waitcnt lgkmcnt(7)
  v_mfma_f32_16x16x32_bf16 v[76:79], v[56:59], v[252:255], 0
  s_waitcnt lgkmcnt(5)
  v_mfma_f32_16x16x32_bf16 v[80:83], v[60:63], v[252:255], 0
  s_nop 0
  v_cvt_pk_bf16_f32 v64, v64, v65
  v_cvt_pk_bf16_f32 v65, v66, v67
  ds_write_b64 v7, v[64:65] offset:160
  v_cvt_pk_bf16_f32 v68, v68, v69
  v_cvt_pk_bf16_f32 v69, v70, v71
  ds_write_b64 v7, v[68:69] offset:192
  v_cvt_pk_bf16_f32 v72, v72, v73
  v_cvt_pk_bf16_f32 v73, v74, v75
  ds_write_b64 v7, v[72:73] offset:224
  v_cvt_pk_bf16_f32 v76, v76, v77
  v_cvt_pk_bf16_f32 v77, v78, v79
  ds_write_b64 v7, v[76:77] offset:256
  v_cvt_pk_bf16_f32 v80, v80, v81
  v_cvt_pk_bf16_f32 v81, v82, v83
  ds_write_b64 v7, v[80:81] offset:288
  s_waitcnt lgkmcnt(0)
  s_barrier
  s_setprio 1
  v_mov_b32 v16, s44
  v_mov_b32 v1, s44
  s_lshl_b32 s6, s5, 7
  s_add_u32 s6, s6, s68
  s_cmp_eq_u32 s3, 4
  s_barrier
  s_cbranch_scc0 L_npo
  s_mov_b64 exec, 0xff
  buffer_store_dwordx4 v[16:19], v2, s[20:23], s6 offen sc1
  s_mov_b64 exec, -1
L_npo:
  s_lshl_b32 s66, s55, 8
  s_add_u32 s66, s66, s59
  s_mul_i32 s66, s66, 2560
  s_add_u32 s67, s66, 327680
  v_bfe_u32 v4, v0, 3, 2
  v_xor_b32 v4, v4, v0
  s_mul_i32 s7, s55, 2560
  s_add_u32 s7, s7, 81920
  v_lshl_add_u32 v4, v4, 4, s7
  v_bfe_u32 v6, v0, 4, 1
  v_bfe_u32 v5, v0, 3, 1
  v_xor_b32 v5, v5, v0
  v_and_b32 v5, 15, v5
  v_lshl_add_u32 v5, v5, 4, s7
  s_movk_i32 s7, 1280
  v_mad_u32_u24 v5, v6, s7, v5
  v_mul_u32_u24 v6, 327424, v6
  v_add_u32 v6, v6, v2
  s_cmp_eq_u32 s3, 4
  s_cbranch_scc0 L_np2
  s_waitcnt vmcnt(0)
  buffer_load_dword v3, v11, s[20:23], s68 offen sc1
L_np2:
  s_cbranch_scc0 L_pook
  s_mov_b32 s62, 0
L_po:
  s_waitcnt vmcnt(0)
  v_cmp_ne_u32 vcc, s44, v3
  s_add_u32 s62, s62, 1
  s_cmp_gt_u32 s62, 200000
  s_cbranch_scc1 L_pook
  s_cbranch_vccz L_pook
  buffer_load_dword v3, v11, s[20:23], s68 offen sc1
  s_branch L_po
L_pook:
  s_barrier
  ds_read_b128 v[72:75], v4
  ds_read_b128 v[76:79], v4 offset:1280
  ds_read_b128 v[80:83], v5 offset:1024
  s_barrier
  ds_read_b128 v[44:47], v8 offset:0
  ds_read_b128 v[48:51], v8 offset:1024
  ds_read_b128 v[52:55], v8 offset:2048
  ds_read_b128 v[56:59], v8 offset:3072
  s_waitcnt lgkmcnt(3)
  v_mfma_f32_32x32x16_bf16 v[24:39], v[92:95], v[44:47], 0
  s_waitcnt lgkmcnt(2)
  v_mfma_f32_32x32x16_bf16 v[24:39], v[96:99], v[48:51], v[24:39]
  s_barrier
  ds_read_b128 v[60:63], v8 offset:4096
  ds_read_b128 v[64:67], v8 offset:5120
  s_waitcnt lgkmcnt(3)
  v_mfma_f32_32x32x16_bf16 v[24:39], v[100:103], v[52:55], v[24:39]
  ds_read_b128 v[68:71], v8 offset:6144
  ds_read_b128 v[44:47], v8 offset:7168
  s_waitcnt lgkmcnt(4)
  v_mfma_f32_32x32x16_bf16 v[24:39], v[104:107], v[56:59], v[24:39]
  s_waitcnt lgkmcnt(3)
  v_mfma_f32_32x32x16_bf16 v[24:39], v[108:111], v[60:63], v[24:39]
  s_waitcnt lgkmcnt(2)
  v_mfma_f32_32x32x16_bf16 v[24:39], v[112:115], v[64:67], v[24:39]
  s_barrier
  ds_read_b128 v[48:51], v8 offset:8192
  ds_read_b128 v[52:55], v8 offset:9216
  s_waitcnt lgkmcnt(3)
  v_mfma_f32_32x32x16_bf16 v[24:39], v[116:119], v[68:71], v[24:39]
  ds_read_b128 v[56:59], v8 offset:10240
  ds_read_b128 v[60:63], v8 offset:11264
  s_waitcnt lgkmcnt(4)
  v_mfma_f32_32x32x16_bf16 v[24:39], v[120:123], v[44:47], v[24:39]
  s_waitcnt lgkmcnt(3)
  v_mfma_f32_32x32x16_bf16 v[24:39], v[124:127], v[48:51], v[24:39]
  s_waitcnt lgkmcnt(2)
  v_mfma_f32_32x32x16_bf16 v[24:39], v[128:131], v[52:55], v[24:39]
  s_barrier
  ds_read_b128 v[64:67], v8 offset:12288
  ds_read_b128 v[68:71], v8 offset:13312
  s_waitcnt lgkmcnt(3)
  v_mfma_f32_32x32x16_bf16 v[24:39], v[132:135], v[56:59], v[24:39]
  ds_read_b128 v[44:47], v8 offset:14336
  ds_read_b128 v[48:51], v8 offset:15360
  s_waitcnt lgkmcnt(4)
  v_mfma_f32_32x32x16_bf16 v[24:39], v[136:139], v[60:63], v[24:39]
  s_waitcnt lgkmcnt(3)
  v_mfma_f32_32x32x16_bf16 v[24:39], v[140:143], v[64:67], v[24:39]
  s_waitcnt lgkmcnt(2)
  v_mfma_f32_32x32x16_bf16 v[24:39], v[144:147], v[68:71], v[24:39]
  s_barrier
  ds_read_b128 v[52:55], v8 offset:16384
  ds_read_b128 v[56:59], v8 offset:17408
  s_waitcnt lgkmcnt(3)
  v_mfma_f32_32x32x16_bf16 v[24:39], v[148:151], v[44:47], v[24:39]
  ds_read_b128 v[60:63], v8 offset:18432
  ds_read_b128 v[64:67], v8 offset:19456
  s_waitcnt lgkmcnt(4)
  v_mfma_f32_32x32x16_bf16 v[24:39], v[152:155], v[48:51], v[24:39]
  s_waitcnt lgkmcnt(3)
  v_mfma_f32_32x32x16_bf16 v[24:39], v[156:159], v[52:55], v[24:39]
  s_waitcnt lgkmcnt(2)
  v_mfma_f32_32x32x16_bf16 v[24:39], v[160:163], v[56:59], v[24:39]
  s_barrier
  ds_read_b128 v[68:71], v8 offset:20480
  ds_read_b128 v[44:47], v8 offset:21504
  s_waitcnt lgkmcnt(3)
  v_mfma_f32_32x32x16_bf16 v[24:39], v[164:167], v[60:63], v[24:39]
  ds_read_b128 v[48:51], v8 offset:22528
  ds_read_b128 v[52:55], v8 offset:23552
  s_waitcnt lgkmcnt(4)
  v_mfma_f32_32x32x16_bf16 v[24:39], v[168:171], v[64:67], v[24:39]
  s_waitcnt lgkmcnt(3)
  v_mfma_f32_32x32x16_bf16 v[24:39], v[172:175], v[68:71], v[24:39]
  s_waitcnt lgkmcnt(2)
  v_mfma_f32_32x32x16_bf16 v[24:39], v[176:179], v[44:47], v[24:39]
  s_barrier
  ds_read_b128 v[56:59], v8 offset:24576
  ds_read_b128 v[60:63], v8 offset:25600
  s_waitcnt lgkmcnt(3)
  v_mfma_f32_32x32x16_bf16 v[24:39], v[180:183], v[48:51], v[24:39]
  ds_read_b128 v[64:67], v8 offset:26624
  ds_read_b128 v[68:71], v8 offset:27648
  s_waitcnt lgkmcnt(4)
  v_mfma_f32_32x32x16_bf16 v[24:39], v[184:187], v[52:55], v[24:39]
  s_waitcnt lgkmcnt(3)
  v_mfma_f32_32x32x16_bf16 v[24:39], v[188:191], v[56:59], v[24:39]
  s_waitcnt lgkmcnt(2)
  v_mfma_f32_32x32x16_bf16 v[24:39], v[192:195], v[60:63], v[24:39]
  s_barrier
  ds_read_b128 v[44:47], v8 offset:28672
  ds_read_b128 v[48:51], v8 offset:29696
  s_waitcnt lgkmcnt(3)
  v_mfma_f32_32x32x16_bf16 v[24:39], v[196:199], v[64:67], v[24:39]
  ds_read_b128 v[52:55], v8 offset:30720
  ds_read_b128 v[56:59], v8 offset:31744
  s_waitcnt lgkmcnt(4)
  v_mfma_f32_32x32x16_bf16 v[24:39], v[200:203], v[68:71], v[24:39]
  buffer_store_dwordx4 v[72:75], v2, s[32:35], s66 offen sc1
  s_waitcnt lgkmcnt(3)
  v_mfma_f32_32x32x16_bf16 v[24:39], v[204:207], v[44:47], v[24:39]
  s_waitcnt lgkmcnt(2)
  v_mfma_f32_32x32x16_bf16 v[24:39], v[208:211], v[48:51], v[24:39]
  s_barrier
  ds_read_b64 v[60:61], v9 offset:0
  ds_read_b64 v[62:63], v9 offset:512
  ds_read_b64 v[64:65], v9 offset:1024
  ds_read_b64 v[66:67], v9 offset:1536
  s_waitcnt lgkmcnt(5)
  v_mfma_f32_32x32x16_bf16 v[24:39], v[212:215], v[52:55], v[24:39]
  buffer_store_dwordx4 v[76:79], v2, s[32:35], s67 offen sc1
  ds_read_b64 v[68:69], v9 offset:2048
  ds_read_b64 v[70:71], v9 offset:2560
  ds_read_b64 v[44:45], v9 offset:3072
  ds_read_b64 v[46:47], v9 offset:3584
  s_waitcnt lgkmcnt(8)
  v_mfma_f32_32x32x16_bf16 v[24:39], v[216:219], v[56:59], v[24:39]
  ds_read_b64 v[48:49], v9 offset:4096
  ds_read_b64 v[50:51], v9 offset:4608
  ds_read_b64 v[52:53], v9 offset:5120
  ds_read_b64 v[54:55], v9 offset:5632
  s_waitcnt lgkmcnt(10)
  v_mfma_f32_32x32x16_bf16 v[24:39], v[220:223], v[60:63], v[24:39]
  ds_read_b64 v[56:57], v9 offset:6144
  ds_read_b64 v[58:59], v9 offset:6656
  s_waitcnt lgkmcnt(10)
  v_mfma_f32_32x32x16_bf16 v[24:39], v[224:227], v[64:67], v[24:39]
  s_mov_b32 exec_hi, 0
  buffer_store_dwordx4 v[80:83], v6, s[32:35], s66 offen offset:1024 sc1
  s_mov_b32 exec_hi, -1
  ds_read_b64 v[60:61], v9 offset:7168
  ds_read_b64 v[62:63], v9 offset:7680
  s_waitcnt lgkmcnt(10)
  v_mfma_f32_32x32x16_bf16 v[24:39], v[228:231], v[68:71], v[24:39]
  s_waitcnt lgkmcnt(8)
  v_mfma_f32_32x32x16_bf16 v[24:39], v[232:235], v[44:47], v[24:39]
  s_waitcnt lgkmcnt(6)
  v_mfma_f32_32x32x16_bf16 v[24:39], v[236:239], v[48:51], v[24:39]
  s_waitcnt lgkmcnt(4)
  v_mfma_f32_32x32x16_bf16 v[24:39], v[240:243], v[52:55], v[24:39]
  s_waitcnt lgkmcnt(2)
  v_mfma_f32_32x32x16_bf16 v[24:39], v[244:247], v[56:59], v[24:39]
  s_waitcnt lgkmcnt(0)
  v_mfma_f32_32x32x16_bf16 v[24:39], v[248:251], v[60:63], v[24:39]
  v_mov_b64 v[252:253], v[12:13]
  s_nop 10
  v_cvt_pk_bf16_f32 v24, v24, v25
  v_cvt_pk_bf16_f32 v25, v26, v27
  ds_write_b64 v10, v[24:25] offset:0
  v_cvt_pk_bf16_f32 v28, v28, v29
  v_cvt_pk_bf16_f32 v29, v30, v31
  ds_write_b64 v10, v[28:29] offset:16
  v_cvt_pk_bf16_f32 v32, v32, v33
  v_cvt_pk_bf16_f32 v33, v34, v35
  ds_write_b64 v10, v[32:33] offset:32
  v_cvt_pk_bf16_f32 v36, v36, v37
  v_cvt_pk_bf16_f32 v37, v38, v39
  ds_write_b64 v10, v[36:37] offset:48
L_fin:
  s_mul_i32 s6, s4, 163840
  s_mul_i32 s7, s5, 160
  s_add_u32 s6, s6, s7
  s_add_u32 s6, s6, 1280
  s_cmp_ge_u32 s3, 2
  s_waitcnt lgkmcnt(0)
  s_barrier
  ds_read_b128 v[24:27], v252
  s_cbranch_scc1 L_one
  ds_read_b128 v[28:31], v254
  s_waitcnt lgkmcnt(0)
  buffer_store_dwordx4 v[28:31], v255, s[32:35], s6 offen nt
L_one:
  s_waitcnt lgkmcnt(0)
  buffer_store_dwordx4 v[24:27], v253, s[32:35], s6 offen nt
L_end:
  s_endpgm
L_slow:
  s_cmp_lg_u32 s61, 0
  s_cbranch_scc1 L_store
  v_subrev_u32 v1, 163840, v1
  s_mov_b32 s55, 0
L_blk:
  s_mov_b32 s61, 1
  v_mov_b32 v224, 0xff800000
  v_mov_b32 v20, 0
  v_mov_b32 v21, 0
  v_mov_b32 v22, 0
  v_mov_b32 v23, 0
  v_mov_b32 v24, 0
  v_mov_b32 v25, 0
  v_mov_b32 v26, 0
  v_mov_b32 v27, 0
  v_mov_b32 v28, 0
  v_mov_b32 v29, 0
  v_mov_b32 v30, 0
  v_mov_b32 v31, 0
  v_mov_b32 v32, 0
  v_mov_b32 v33, 0
  v_mov_b32 v34, 0
  v_mov_b32 v35, 0
  v_mov_b32 v52, 0
  v_mov_b32 v53, 0
  v_mov_b32 v54, 0
  v_mov_b32 v55, 0
  v_mov_b32 v56, 0
  v_mov_b32 v57, 0
  v_mov_b32 v58, 0
  v_mov_b32 v59, 0
  v_mov_b32 v60, 0
  v_mov_b32 v61, 0
  v_mov_b32 v62, 0
  v_mov_b32 v63, 0
  v_mov_b32 v64, 0
  v_mov_b32 v65, 0
  v_mov_b32 v66, 0
  v_mov_b32 v67, 0
L_pass:
  s_mov_b32 s62, 0
L_sl:
  s_lshr_b32 s66, s62, 1
  s_mul_i32 s66, s66, 10240
  s_and_b32 s6, s62, 1
  s_mul_i32 s7, s6, 2048
  s_add_u32 s7, s7, s66
  buffer_load_dwordx4 v[148:151], v2, s[20:23], s7 offen sc1
  buffer_load_dwordx4 v[152:155], v2, s[20:23], s7 offen offset:1024 sc1
  s_lshl_b32 s7, s6, 3
  s_add_u32 s7, s7, s66
  s_add_u32 s7, s7, 4096
  buffer_load_dwordx2 v[156:157], v2, s[20:23], s7 offen sc1
  s_mul_i32 s7, s6, 2560
  s_add_u32 s7, s7, s66
  s_add_u32 s7, s7, 5120
  s_mov_b64 exec, s[64:65]
  buffer_load_dwordx4 v[164:167], v1, s[20:23], s7 offen offset:0 sc1
  buffer_load_dwordx4 v[168:171], v1, s[20:23], s7 offen offset:640 sc1
  buffer_load_dwordx4 v[172:175], v1, s[20:23], s7 offen offset:1280 sc1
  buffer_load_dwordx4 v[176:179], v1, s[20:23], s7 offen offset:1920 sc1
  s_mov_b64 exec, -1
  s_waitcnt vmcnt(0)
  v_mfma_f32_32x32x16_bf16 v[84:99], v[148:151], v[4:7], v[20:35]
  v_mfma_f32_32x32x16_bf16 v[100:115], v[152:155], v[4:7], v[20:35]
  s_nop 9
  v_mfma_f32_32x32x4_2b_bf16 v[84:115], v[156:157], v[8:9], v[84:115]
  s_nop 15
  s_nop 3
  s_cmp_eq_u32 s61, 1
  s_cbranch_scc0 L_p2
  v_max3_f32 v224, v224, v84, v85
  v_max3_f32 v224, v224, v86, v87
  v_max3_f32 v224, v224, v88, v89
  v_max3_f32 v224, v224, v90, v91
  v_max3_f32 v224, v224, v92, v93
  v_max3_f32 v224, v224, v94, v95
  v_max3_f32 v224, v224, v96, v97
  v_max3_f32 v224, v224, v98, v99
  v_max3_f32 v224, v224, v100, v101
  v_max3_f32 v224, v224, v102, v103
  v_max3_f32 v224, v224, v104, v105
  v_max3_f32 v224, v224, v106, v107
  v_max3_f32 v224, v224, v108, v109
  v_max3_f32 v224, v224, v110, v111
  v_max3_f32 v224, v224, v112, v113
  v_max3_f32 v224, v224, v114, v115
  s_branch L_nx
L_p2:
  v_exp_f32 v84, v84
  v_exp_f32 v85, v85
  v_exp_f32 v86, v86
  v_exp_f32 v87, v87
  v_exp_f32 v88, v88
  v_exp_f32 v89, v89
  v_exp_f32 v90, v90
  v_exp_f32 v91, v91
  v_exp_f32 v92, v92
  v_exp_f32 v93, v93
  v_exp_f32 v94, v94
  v_exp_f32 v95, v95
  v_exp_f32 v96, v96
  v_exp_f32 v97, v97
  v_exp_f32 v98, v98
  v_exp_f32 v99, v99
  v_exp_f32 v100, v100
  v_exp_f32 v101, v101
  v_exp_f32 v102, v102
  v_exp_f32 v103, v103
  v_exp_f32 v104, v104
  v_exp_f32 v105, v105
  v_exp_f32 v106, v106
  v_exp_f32 v107, v107
  v_exp_f32 v108, v108
  v_exp_f32 v109, v109
  v_exp_f32 v110, v110
  v_exp_f32 v111, v111
  v_exp_f32 v112, v112
  v_exp_f32 v113, v113
  v_exp_f32 v114, v114
  v_exp_f32 v115, v115
  s_nop 1
  v_smfmac_f32_32x32x32_bf16 v[52:67], v[164:167], v[84:91], v16
  v_smfmac_f32_32x32x32_bf16 v[52:67], v[168:171], v[92:99], v16
  v_smfmac_f32_32x32x32_bf16 v[52:67], v[172:175], v[100:107], v16
  v_smfmac_f32_32x32x32_bf16 v[52:67], v[176:179], v[108:115], v16
L_nx:
  s_add_u32 s62, s62, 1
  s_cmp_lt_u32 s62, 32
  s_cbranch_scc1 L_sl
  s_cmp_eq_u32 s61, 1
  s_cbranch_scc0 L_swap
  s_mov_b32 s61, 2
  v_mov_b32 v225, v224
  s_nop 1
  v_permlane32_swap_b32 v224, v225
  v_max_f32 v224, v224, v225
  v_sub_f32 v20, 0, v224
  v_sub_f32 v21, 0, v224
  v_sub_f32 v22, 0, v224
  v_sub_f32 v23, 0, v224
  v_sub_f32 v24, 0, v224
  v_sub_f32 v25, 0, v224
  v_sub_f32 v26, 0, v224
  v_sub_f32 v27, 0, v224
  v_sub_f32 v28, 0, v224
  v_sub_f32 v29, 0, v224
  v_sub_f32 v30, 0, v224
  v_sub_f32 v31, 0, v224
  v_sub_f32 v32, 0, v224
  v_sub_f32 v33, 0, v224
  v_sub_f32 v34, 0, v224
  v_sub_f32 v35, 0, v224
  s_branch L_pass
L_swap:
  s_nop 7
  v_swap_b32 v4, v10
  v_swap_b32 v5, v11
  v_swap_b32 v6, v12
  v_swap_b32 v7, v13
  v_swap_b32 v8, v14
  v_swap_b32 v9, v15
  v_swap_b32 v52, v68
  v_swap_b32 v53, v69
  v_swap_b32 v54, v70
  v_swap_b32 v55, v71
  v_swap_b32 v56, v72
  v_swap_b32 v57, v73
  v_swap_b32 v58, v74
  v_swap_b32 v59, v75
  v_swap_b32 v60, v76
  v_swap_b32 v61, v77
  v_swap_b32 v62, v78
  v_swap_b32 v63, v79
  v_swap_b32 v64, v80
  v_swap_b32 v65, v81
  v_swap_b32 v66, v82
  v_swap_b32 v67, v83
  s_add_u32 s55, s55, 1
  s_cmp_lt_u32 s55, 2
  s_cbranch_scc1 L_blk
  s_branch L_check
.p2align 8
.type tab_a,@object
tab_a:
.long 0x21c00,0x14000,0x0,0x0,0x21c08,0x14040,0x8,0xa000
.long 0x21c10,0x14090,0x10,0x80,0x21c18,0x140d0,0x18,0xa080
.long 0x21c28,0x14120,0x20,0x100,0x21c30,0x14160,0x28,0xa100
.long 0x21c38,0x141b0,0x30,0x180,0x21c40,0x141f0,0x38,0xa180
.long 0x21c50,0x14200,0x40,0x200,0x21c58,0x14240,0x48,0xa200
.long 0x21c60,0x14290,0x50,0x280,0x21c68,0x142d0,0x58,0xa280
.long 0x21c78,0x14320,0x60,0x300,0x21c80,0x14360,0x68,0xa300
.long 0x21c88,0x143b0,0x70,0x380,0x21c90,0x143f0,0x78,0xa380
.long 0x21c20,0x14400,0x80,0x0,0x21c20,0x14440,0x88,0xa000
.long 0x21c20,0x14490,0x90,0x80,0x21c20,0x144d0,0x98,0xa080
.long 0x21c48,0x144e0,0xa0,0x100,0x21c48,0x144e0,0xa8,0xa100
.long 0x21c48,0x144f0,0xb0,0x180,0x21c48,0x144f0,0xb8,0xa180
.long 0x21c70,0x144c0,0xc0,0x200,0x21c70,0x144c0,0xc8,0xa200
.long 0x21c70,0x144d0,0xd0,0x280,0x21c70,0x144d0,0xd8,0xa280
.long 0x21c98,0x144e0,0xe0,0x300,0x21c98,0x144e0,0xe8,0xa300
.long 0x21c98,0x144f0,0xf0,0x380,0x21c98,0x144f0,0xf8,0xa380
.long 0x21d40,0x14020,0xa000,0x0,0x21d48,0x14060,0xa008,0xa000
.long 0x21d50,0x140b0,0xa010,0x80,0x21d58,0x140f0,0xa018,0xa080
.long 0x21d68,0x14100,0xa020,0x100,0x21d70,0x14140,0xa028,0xa100
.long 0x21d78,0x14190,0xa030,0x180,0x21d80,0x141d0,0xa038,0xa180
.long 0x21d90,0x14220,0xa040,0x200,0x21d98,0x14260,0xa048,0xa200
.long 0x21da0,0x142b0,0xa050,0x280,0x21da8,0x142f0,0xa058,0xa280
.long 0x21db8,0x14300,0xa060,0x300,0x21dc0,0x14340,0xa068,0xa300
.long 0x21dc8,0x14390,0xa070,0x380,0x21dd0,0x143d0,0xa078,0xa380
.long 0x21d60,0x14420,0xa080,0x0,0x21d60,0x14460,0xa088,0xa000
.long 0x21d60,0x144b0,0xa090,0x80,0x21d60,0x144f0,0xa098,0xa080
.long 0x21d88,0x144c0,0xa0a0,0x100,0x21d88,0x144c0,0xa0a8,0xa100
.long 0x21d88,0x144d0,0xa0b0,0x180,0x21d88,0x144d0,0xa0b8,0xa180
.long 0x21db0,0x144e0,0xa0c0,0x200,0x21db0,0x144e0,0xa0c8,0xa200
.long 0x21db0,0x144f0,0xa0d0,0x280,0x21db0,0x144f0,0xa0d8,0xa280
.long 0x21dd8,0x144c0,0xa0e0,0x300,0x21dd8,0x144c0,0xa0e8,0xa300
.long 0x21dd8,0x144d0,0xa0f0,0x380,0x21dd8,0x144d0,0xa0f8,0xa380
.long 0x14000,0x0,0x16330,0x1fe20,0x14010,0x10,0x16340,0x1fe30
.long 0x14020,0x20,0x16350,0x1fe40,0x14030,0x30,0x16360,0x1fe50
.long 0x14040,0x40,0x16370,0x1fe60,0x14050,0x50,0x16380,0x1fe70
.long 0x14060,0x60,0x16390,0x1fe80,0x14070,0x70,0x163a0,0x1fe90
.long 0x14080,0x80,0x163c0,0x20800,0x14090,0x90,0x163d0,0x20810
.long 0x140b0,0xa00,0x163e0,0x20820,0x140c0,0xa10,0x163f0,0x20830
.long 0x140d0,0xa20,0x16400,0x20840,0x140e0,0xa30,0x16410,0x20850
.long 0x140f0,0xa40,0x16420,0x20860,0x14100,0xa50,0x16430,0x20870
.long 0x14110,0xa60,0x16440,0x20880,0x14120,0xa70,0x16450,0x20890
.long 0x14130,0xa80,0x16470,0x21200,0x14140,0xa90,0x16480,0x21210
.long 0x14160,0x1400,0x16490,0x21220,0x14170,0x1410,0x164a0,0x21230
.long 0x14180,0x1420,0x164b0,0x21240,0x14190,0x1430,0x164c0,0x21250
.long 0x141a0,0x1440,0x164d0,0x21260,0x141b0,0x1450,0x164e0,0x21270
.long 0x141c0,0x1460,0x164f0,0x21280,0x141d0,0x1470,0x16500,0x21290
.long 0x141e0,0x1480,0x16520,0x21c00,0x141f0,0x1490,0x16530,0x21c10
.long 0x14210,0x1e00,0x16540,0x21c20,0x14220,0x1e10,0x16550,0x21c30
.long 0x14230,0x1e20,0x16560,0x21c40,0x14240,0x1e30,0x16570,0x21c50
.long 0x14250,0x1e40,0x16580,0x21c60,0x14260,0x1e50,0x16590,0x21c70
.long 0x14270,0x1e60,0x165a0,0x21c80,0x14280,0x1e70,0x165b0,0x21c90
.long 0x14290,0x1e80,0x165d0,0x22600,0x142a0,0x1e90,0x165e0,0x22610
.long 0x142c0,0x2800,0x165f0,0x22620,0x142d0,0x2810,0x16600,0x22630
.long 0x142e0,0x2820,0x16610,0x22640,0x142f0,0x2830,0x16620,0x22650
.long 0x14300,0x2840,0x16630,0x22660,0x14310,0x2850,0x16640,0x22670
.long 0x14320,0x2860,0x16650,0x22680,0x14330,0x2870,0x16660,0x22690
.long 0x14340,0x2880,0x16680,0x23000,0x14350,0x2890,0x16690,0x23010
.long 0x14370,0x3200,0x166a0,0x23020,0x14380,0x3210,0x166b0,0x23030
.long 0x14390,0x3220,0x166c0,0x23040,0x143a0,0x3230,0x166d0,0x23050
.long 0x143b0,0x3240,0x166e0,0x23060,0x143c0,0x3250,0x166f0,0x23070
.long 0x143d0,0x3260,0x16700,0x23080,0x143e0,0x3270,0x16710,0x23090
.long 0x143f0,0x3280,0x16730,0x23a00,0x14400,0x3290,0x16740,0x23a10
.long 0x14420,0x3c00,0x16750,0x23a20,0x14430,0x3c10,0x16760,0x23a30
.long 0x14440,0x3c20,0x16770,0x23a40,0x14450,0x3c30,0x16780,0x23a50
.long 0x0,0x8000,0x14080,0x19000,0x10,0x8008,0x14130,0x19010
.long 0x20,0x8010,0x141e0,0x19020,0x30,0x8018,0x14290,0x19030
.long 0x40,0x8020,0x14340,0x19040,0x50,0x8028,0x143f0,0x19050
.long 0x60,0x8030,0x144a0,0x19060,0x70,0x8038,0x14550,0x19070
.long 0x80,0x8040,0x14600,0x19080,0x90,0x8048,0x146b0,0x19090
.long 0xa0,0x8050,0x14760,0x190a0,0xb0,0x8058,0x14810,0x190b0
.long 0xc0,0x8060,0x148c0,0x190c0,0xd0,0x8068,0x14970,0x190d0
.long 0xe0,0x8070,0x14a20,0x190e0,0xf0,0x8078,0x14ad0,0x190f0
.long 0x200,0x8100,0x14088,0x19100,0x210,0x8108,0x14138,0x19110
.long 0x220,0x8110,0x141e8,0x19120,0x230,0x8118,0x14298,0x19130
.long 0x240,0x8120,0x14348,0x19140,0x250,0x8128,0x143f8,0x19150
.long 0x260,0x8130,0x144a8,0x19160,0x270,0x8138,0x14558,0x19170
.long 0x280,0x8140,0x14608,0x19180,0x290,0x8148,0x146b8,0x19190
.long 0x2a0,0x8150,0x14768,0x191a0,0x2b0,0x8158,0x14818,0x191b0
.long 0x2c0,0x8160,0x148c8,0x191c0,0x2d0,0x8168,0x14978,0x191d0
.long 0x2e0,0x8170,0x14a28,0x191e0,0x2f0,0x8178,0x14ad8,0x191f0
.long 0x400,0x8200,0x14090,0x19200,0x410,0x8208,0x14140,0x19210
.long 0x420,0x8210,0x141f0,0x19220,0x430,0x8218,0x142a0,0x19230
.long 0x440,0x8220,0x14350,0x19240,0x450,0x8228,0x14400,0x19250
.long 0x460,0x8230,0x144b0,0x19260,0x470,0x8238,0x14560,0x19270
.long 0x480,0x8240,0x14610,0x19280,0x490,0x8248,0x146c0,0x19290
.long 0x4a0,0x8250,0x14770,0x192a0,0x4b0,0x8258,0x14820,0x192b0
.long 0x4c0,0x8260,0x148d0,0x192c0,0x4d0,0x8268,0x14980,0x192d0
.long 0x4e0,0x8270,0x14a30,0x192e0,0x4f0,0x8278,0x14ae0,0x192f0
.long 0x600,0x8300,0x14098,0x19300,0x610,0x8308,0x14148,0x19310
.long 0x620,0x8310,0x141f8,0x19320,0x630,0x8318,0x142a8,0x19330
.long 0x640,0x8320,0x14358,0x19340,0x650,0x8328,0x14408,0x19350
.long 0x660,0x8330,0x144b8,0x19360,0x670,0x8338,0x14568,0x19370
.long 0x680,0x8340,0x14618,0x19380,0x690,0x8348,0x146c8,0x19390
.long 0x6a0,0x8350,0x14778,0x193a0,0x6b0,0x8358,0x14828,0x193b0
.long 0x6c0,0x8360,0x148d8,0x193c0,0x6d0,0x8368,0x14988,0x193d0
.long 0x6e0,0x8370,0x14a38,0x193e0,0x6f0,0x8378,0x14ae8,0x193f0
.long 0x23020,0x14a00,0x0,0x0,0x23028,0x14a40,0x8,0xa000
.long 0x23030,0x14a90,0x10,0x80,0x23038,0x14ad0,0x18,0xa080
.long 0x23048,0x14b20,0x20,0x100,0x23050,0x14b60,0x28,0xa100
.long 0x23058,0x14bb0,0x30,0x180,0x23060,0x14bf0,0x38,0xa180
.long 0x23070,0x14c00,0x40,0x200,0x23078,0x14c40,0x48,0xa200
.long 0x23080,0x14c90,0x50,0x280,0x23088,0x14cd0,0x58,0xa280
.long 0x23098,0x14d20,0x60,0x300,0x230a0,0x14d60,0x68,0xa300
.long 0x230a8,0x14db0,0x70,0x380,0x230b0,0x14df0,0x78,0xa380
.long 0x23040,0x14e00,0x80,0x0,0x23040,0x14e40,0x88,0xa000
.long 0x23040,0x14e90,0x90,0x80,0x23040,0x14ed0,0x98,0xa080
.long 0x23068,0x14ee0,0xa0,0x100,0x23068,0x14ee0,0xa8,0xa100
.long 0x23068,0x14ef0,0xb0,0x180,0x23068,0x14ef0,0xb8,0xa180
.long 0x23090,0x14ec0,0xc0,0x200,0x23090,0x14ec0,0xc8,0xa200
.long 0x23090,0x14ed0,0xd0,0x280,0x23090,0x14ed0,0xd8,0xa280
.long 0x230b8,0x14ee0,0xe0,0x300,0x230b8,0x14ee0,0xe8,0xa300
.long 0x230b8,0x14ef0,0xf0,0x380,0x230b8,0x14ef0,0xf8,0xa380
.long 0x23160,0x14a20,0xa000,0x0,0x23168,0x14a60,0xa008,0xa000
.long 0x23170,0x14ab0,0xa010,0x80,0x23178,0x14af0,0xa018,0xa080
.long 0x23188,0x14b00,0xa020,0x100,0x23190,0x14b40,0xa028,0xa100
.long 0x23198,0x14b90,0xa030,0x180,0x231a0,0x14bd0,0xa038,0xa180
.long 0x231b0,0x14c20,0xa040,0x200,0x231b8,0x14c60,0xa048,0xa200
.long 0x231c0,0x14cb0,0xa050,0x280,0x231c8,0x14cf0,0xa058,0xa280
.long 0x231d8,0x14d00,0xa060,0x300,0x231e0,0x14d40,0xa068,0xa300
.long 0x231e8,0x14d90,0xa070,0x380,0x231f0,0x14dd0,0xa078,0xa380
.long 0x23180,0x14e20,0xa080,0x0,0x23180,0x14e60,0xa088,0xa000
.long 0x23180,0x14eb0,0xa090,0x80,0x23180,0x14ef0,0xa098,0xa080
.long 0x231a8,0x14ec0,0xa0a0,0x100,0x231a8,0x14ec0,0xa0a8,0xa100
.long 0x231a8,0x14ed0,0xa0b0,0x180,0x231a8,0x14ed0,0xa0b8,0xa180
.long 0x231d0,0x14ee0,0xa0c0,0x200,0x231d0,0x14ee0,0xa0c8,0xa200
.long 0x231d0,0x14ef0,0xa0d0,0x280,0x231d0,0x14ef0,0xa0d8,0xa280
.long 0x231f8,0x14ec0,0xa0e0,0x300,0x231f8,0x14ec0,0xa0e8,0xa300
.long 0x231f8,0x14ed0,0xa0f0,0x380,0x231f8,0x14ed0,0xa0f8,0xa380
.long 0x14460,0x3c40,0x16790,0x23a60,0x14470,0x3c50,0x167a0,0x23a70
.long 0x14480,0x3c60,0x167b0,0x23a80,0x14490,0x3c70,0x167c0,0x23a90
.long 0x144a0,0x3c80,0x167e0,0x24400,0x144b0,0x3c90,0x167f0,0x24410
.long 0x144d0,0x4600,0x16800,0x24420,0x144e0,0x4610,0x16810,0x24430
.long 0x144f0,0x4620,0x16820,0x24440,0x14500,0x4630,0x16830,0x24450
.long 0x14510,0x4640,0x16840,0x24460,0x14520,0x4650,0x16850,0x24470
.long 0x14530,0x4660,0x16860,0x24480,0x14540,0x4670,0x16870,0x24490
.long 0x14550,0x4680,0x16890,0x24e00,0x14560,0x4690,0x168a0,0x24e10
.long 0x14580,0x5000,0x168b0,0x24e20,0x14590,0x5010,0x168c0,0x24e30
.long 0x145a0,0x5020,0x168d0,0x24e40,0x145b0,0x5030,0x168e0,0x24e50
.long 0x145c0,0x5040,0x168f0,0x24e60,0x145d0,0x5050,0x16900,0x24e70
.long 0x145e0,0x5060,0x16910,0x24e80,0x145f0,0x5070,0x16920,0x24e90
.long 0x14600,0x5080,0x16940,0x25800,0x14610,0x5090,0x16950,0x25810
.long 0x14630,0x5a00,0x16960,0x25820,0x14640,0x5a10,0x16970,0x25830
.long 0x14650,0x5a20,0x16980,0x25840,0x14660,0x5a30,0x16990,0x25850
.long 0x14670,0x5a40,0x169a0,0x25860,0x14680,0x5a50,0x169b0,0x25870
.long 0x14690,0x5a60,0x169c0,0x25880,0x146a0,0x5a70,0x169d0,0x25890
.long 0x146b0,0x5a80,0x169f0,0x26200,0x146c0,0x5a90,0x16a00,0x26210
.long 0x146e0,0x6400,0x16a10,0x26220,0x146f0,0x6410,0x16a20,0x26230
.long 0x14700,0x6420,0x16a30,0x26240,0x14710,0x6430,0x16a40,0x26250
.long 0x14720,0x6440,0x16a50,0x26260,0x14730,0x6450,0x16a60,0x26270
.long 0x14740,0x6460,0x16a70,0x26280,0x14750,0x6470,0x16a80,0x26290
.long 0x14760,0x6480,0x16aa0,0x26c00,0x14770,0x6490,0x16ab0,0x26c10
.long 0x14790,0x6e00,0x16ac0,0x26c20,0x147a0,0x6e10,0x16ad0,0x26c30
.long 0x147b0,0x6e20,0x16ae0,0x26c40,0x147c0,0x6e30,0x16af0,0x26c50
.long 0x147d0,0x6e40,0x16b00,0x26c60,0x147e0,0x6e50,0x16b10,0x26c70
.long 0x147f0,0x6e60,0x16b20,0x26c80,0x14800,0x6e70,0x16b30,0x26c90
.long 0x14810,0x6e80,0x16b50,0x27600,0x14820,0x6e90,0x16b60,0x27610
.long 0x14840,0x7800,0x16b70,0x27620,0x14850,0x7810,0x16b80,0x27630
.long 0x14860,0x7820,0x16b90,0x27640,0x14870,0x7830,0x16ba0,0x27650
.long 0x14880,0x7840,0x16bb0,0x27660,0x14890,0x7850,0x16bc0,0x27670
.long 0x148a0,0x7860,0x16bd0,0x27680,0x148b0,0x7870,0x16be0,0x27690
.long 0x100,0x8080,0x14b80,0x19000,0x110,0x8088,0x14c30,0x19010
.long 0x120,0x8090,0x14ce0,0x19020,0x130,0x8098,0x14d90,0x19030
.long 0x140,0x80a0,0x14e40,0x19040,0x150,0x80a8,0x14ef0,0x19050
.long 0x160,0x80b0,0x14fa0,0x19060,0x170,0x80b8,0x15050,0x19070
.long 0x180,0x80c0,0x15100,0x19080,0x190,0x80c8,0x151b0,0x19090
.long 0x1a0,0x80d0,0x15260,0x190a0,0x1b0,0x80d8,0x15310,0x190b0
.long 0x1c0,0x80e0,0x153c0,0x190c0,0x1d0,0x80e8,0x15470,0x190d0
.long 0x1e0,0x80f0,0x15520,0x190e0,0x1f0,0x80f8,0x155d0,0x190f0
.long 0x300,0x8180,0x14b88,0x19100,0x310,0x8188,0x14c38,0x19110
.long 0x320,0x8190,0x14ce8,0x19120,0x330,0x8198,0x14d98,0x19130
.long 0x340,0x81a0,0x14e48,0x19140,0x350,0x81a8,0x14ef8,0x19150
.long 0x360,0x81b0,0x14fa8,0x19160,0x370,0x81b8,0x15058,0x19170
.long 0x380,0x81c0,0x15108,0x19180,0x390,0x81c8,0x151b8,0x19190
.long 0x3a0,0x81d0,0x15268,0x191a0,0x3b0,0x81d8,0x15318,0x191b0
.long 0x3c0,0x81e0,0x153c8,0x191c0,0x3d0,0x81e8,0x15478,0x191d0
.long 0x3e0,0x81f0,0x15528,0x191e0,0x3f0,0x81f8,0x155d8,0x191f0
.long 0x500,0x8280,0x14b90,0x19200,0x510,0x8288,0x14c40,0x19210
.long 0x520,0x8290,0x14cf0,0x19220,0x530,0x8298,0x14da0,0x19230
.long 0x540,0x82a0,0x14e50,0x19240,0x550,0x82a8,0x14f00,0x19250
.long 0x560,0x82b0,0x14fb0,0x19260,0x570,0x82b8,0x15060,0x19270
.long 0x580,0x82c0,0x15110,0x19280,0x590,0x82c8,0x151c0,0x19290
.long 0x5a0,0x82d0,0x15270,0x192a0,0x5b0,0x82d8,0x15320,0x192b0
.long 0x5c0,0x82e0,0x153d0,0x192c0,0x5d0,0x82e8,0x15480,0x192d0
.long 0x5e0,0x82f0,0x15530,0x192e0,0x5f0,0x82f8,0x155e0,0x192f0
.long 0x700,0x8380,0x14b98,0x19300,0x710,0x8388,0x14c48,0x19310
.long 0x720,0x8390,0x14cf8,0x19320,0x730,0x8398,0x14da8,0x19330
.long 0x740,0x83a0,0x14e58,0x19340,0x750,0x83a8,0x14f08,0x19350
.long 0x760,0x83b0,0x14fb8,0x19360,0x770,0x83b8,0x15068,0x19370
.long 0x780,0x83c0,0x15118,0x19380,0x790,0x83c8,0x151c8,0x19390
.long 0x7a0,0x83d0,0x15278,0x193a0,0x7b0,0x83d8,0x15328,0x193b0
.long 0x7c0,0x83e0,0x153d8,0x193c0,0x7d0,0x83e8,0x15488,0x193d0
.long 0x7e0,0x83f0,0x15538,0x193e0,0x7f0,0x83f8,0x155e8,0x193f0
.long 0x24440,0x15400,0x0,0x0,0x24448,0x15440,0x8,0xa000
.long 0x24450,0x15490,0x10,0x80,0x24458,0x154d0,0x18,0xa080
.long 0x24468,0x15520,0x20,0x100,0x24470,0x15560,0x28,0xa100
.long 0x24478,0x155b0,0x30,0x180,0x24480,0x155f0,0x38,0xa180
.long 0x24490,0x15600,0x40,0x200,0x24498,0x15640,0x48,0xa200
.long 0x244a0,0x15690,0x50,0x280,0x244a8,0x156d0,0x58,0xa280
.long 0x244b8,0x15720,0x60,0x300,0x244c0,0x15760,0x68,0xa300
.long 0x244c8,0x157b0,0x70,0x380,0x244d0,0x157f0,0x78,0xa380
.long 0x24460,0x15800,0x80,0x0,0x24460,0x15840,0x88,0xa000
.long 0x24460,0x15890,0x90,0x80,0x24460,0x158d0,0x98,0xa080
.long 0x24488,0x158e0,0xa0,0x100,0x24488,0x158e0,0xa8,0xa100
.long 0x24488,0x158f0,0xb0,0x180,0x24488,0x158f0,0xb8,0xa180
.long 0x244b0,0x158c0,0xc0,0x200,0x244b0,0x158c0,0xc8,0xa200
.long 0x244b0,0x158d0,0xd0,0x280,0x244b0,0x158d0,0xd8,0xa280
.long 0x244d8,0x158e0,0xe0,0x300,0x244d8,0x158e0,0xe8,0xa300
.long 0x244d8,0x158f0,0xf0,0x380,0x244d8,0x158f0,0xf8,0xa380
.long 0x24580,0x15420,0xa000,0x0,0x24588,0x15460,0xa008,0xa000
.long 0x24590,0x154b0,0xa010,0x80,0x24598,0x154f0,0xa018,0xa080
.long 0x245a8,0x15500,0xa020,0x100,0x245b0,0x15540,0xa028,0xa100
.long 0x245b8,0x15590,0xa030,0x180,0x245c0,0x155d0,0xa038,0xa180
.long 0x245d0,0x15620,0xa040,0x200,0x245d8,0x15660,0xa048,0xa200
.long 0x245e0,0x156b0,0xa050,0x280,0x245e8,0x156f0,0xa058,0xa280
.long 0x245f8,0x15700,0xa060,0x300,0x24600,0x15740,0xa068,0xa300
.long 0x24608,0x15790,0xa070,0x380,0x24610,0x157d0,0xa078,0xa380
.long 0x245a0,0x15820,0xa080,0x0,0x245a0,0x15860,0xa088,0xa000
.long 0x245a0,0x158b0,0xa090,0x80,0x245a0,0x158f0,0xa098,0xa080
.long 0x245c8,0x158c0,0xa0a0,0x100,0x245c8,0x158c0,0xa0a8,0xa100
.long 0x245c8,0x158d0,0xa0b0,0x180,0x245c8,0x158d0,0xa0b8,0xa180
.long 0x245f0,0x158e0,0xa0c0,0x200,0x245f0,0x158e0,0xa0c8,0xa200
.long 0x245f0,0x158f0,0xa0d0,0x280,0x245f0,0x158f0,0xa0d8,0xa280
.long 0x24618,0x158c0,0xa0e0,0x300,0x24618,0x158c0,0xa0e8,0xa300
.long 0x24618,0x158d0,0xa0f0,0x380,0x24618,0x158d0,0xa0f8,0xa380
.long 0x148c0,0x7880,0x16be0,0x27690,0x148d0,0x7890,0x16be0,0x27690
.long 0x148f0,0x8200,0x16be0,0x27690,0x14900,0x8210,0x16be0,0x27690
.long 0x14910,0x8220,0x16be0,0x27690,0x14920,0x8230,0x16be0,0x27690
.long 0x14930,0x8240,0x16be0,0x27690,0x14940,0x8250,0x16be0,0x27690
.long 0x14950,0x8260,0x16be0,0x27690,0x14960,0x8270,0x16be0,0x27690
.long 0x14970,0x8280,0x16be0,0x27690,0x14980,0x8290,0x16be0,0x27690
.long 0x149a0,0x8c00,0x16be0,0x27690,0x149b0,0x8c10,0x16be0,0x27690
.long 0x149c0,0x8c20,0x16be0,0x27690,0x149d0,0x8c30,0x16be0,0x27690
.long 0x149e0,0x8c40,0x16be0,0x27690,0x149f0,0x8c50,0x16be0,0x27690
.long 0x14a00,0x8c60,0x16be0,0x27690,0x14a10,0x8c70,0x16be0,0x27690
.long 0x14a20,0x8c80,0x16be0,0x27690,0x14a30,0x8c90,0x16be0,0x27690
.long 0x14a50,0x9600,0x16be0,0x27690,0x14a60,0x9610,0x16be0,0x27690
.long 0x14a70,0x9620,0x16be0,0x27690,0x14a80,0x9630,0x16be0,0x27690
.long 0x14a90,0x9640,0x16be0,0x27690,0x14aa0,0x9650,0x16be0,0x27690
.long 0x14ab0,0x9660,0x16be0,0x27690,0x14ac0,0x9670,0x16be0,0x27690
.long 0x14ad0,0x9680,0x16be0,0x27690,0x14ae0,0x9690,0x16be0,0x27690
.long 0x14b00,0xa000,0x16be0,0x27690,0x14b10,0xa010,0x16be0,0x27690
.long 0x14b20,0xa020,0x16be0,0x27690,0x14b30,0xa030,0x16be0,0x27690
.long 0x14b40,0xa040,0x16be0,0x27690,0x14b50,0xa050,0x16be0,0x27690
.long 0x14b60,0xa060,0x16be0,0x27690,0x14b70,0xa070,0x16be0,0x27690
.long 0x14b80,0xa080,0x16be0,0x27690,0x14b90,0xa090,0x16be0,0x27690
.long 0x14bb0,0xaa00,0x16be0,0x27690,0x14bc0,0xaa10,0x16be0,0x27690
.long 0x14bd0,0xaa20,0x16be0,0x27690,0x14be0,0xaa30,0x16be0,0x27690
.long 0x14bf0,0xaa40,0x16be0,0x27690,0x14c00,0xaa50,0x16be0,0x27690
.long 0x14c10,0xaa60,0x16be0,0x27690,0x14c20,0xaa70,0x16be0,0x27690
.long 0x14c30,0xaa80,0x16be0,0x27690,0x14c40,0xaa90,0x16be0,0x27690
.long 0x14c60,0xb400,0x16be0,0x27690,0x14c70,0xb410,0x16be0,0x27690
.long 0x14c80,0xb420,0x16be0,0x27690,0x14c90,0xb430,0x16be0,0x27690
.long 0x14ca0,0xb440,0x16be0,0x27690,0x14cb0,0xb450,0x16be0,0x27690
.long 0x14cc0,0xb460,0x16be0,0x27690,0x14cd0,0xb470,0x16be0,0x27690
.long 0x14ce0,0xb480,0x16be0,0x27690,0x14cf0,0xb490,0x16be0,0x27690
.long 0x14d10,0xbe00,0x16be0,0x27690,0x14d20,0xbe10,0x16be0,0x27690
.long 0xa000,0x12000,0x15680,0x19000,0xa010,0x12008,0x15730,0x19010
.long 0xa020,0x12010,0x157e0,0x19020,0xa030,0x12018,0x15890,0x19030
.long 0xa040,0x12020,0x15940,0x19040,0xa050,0x12028,0x159f0,0x19050
.long 0xa060,0x12030,0x15aa0,0x19060,0xa070,0x12038,0x15b50,0x19070
.long 0xa080,0x12040,0x15c00,0x19080,0xa090,0x12048,0x15cb0,0x19090
.long 0xa0a0,0x12050,0x15d60,0x190a0,0xa0b0,0x12058,0x15e10,0x190b0
.long 0xa0c0,0x12060,0x15ec0,0x190c0,0xa0d0,0x12068,0x15f70,0x190d0
.long 0xa0e0,0x12070,0x16020,0x190e0,0xa0f0,0x12078,0x160d0,0x190f0
.long 0xa200,0x12100,0x15688,0x19100,0xa210,0x12108,0x15738,0x19110
.long 0xa220,0x12110,0x157e8,0x19120,0xa230,0x12118,0x15898,0x19130
.long 0xa240,0x12120,0x15948,0x19140,0xa250,0x12128,0x159f8,0x19150
.long 0xa260,0x12130,0x15aa8,0x19160,0xa270,0x12138,0x15b58,0x19170
.long 0xa280,0x12140,0x15c08,0x19180,0xa290,0x12148,0x15cb8,0x19190
.long 0xa2a0,0x12150,0x15d68,0x191a0,0xa2b0,0x12158,0x15e18,0x191b0
.long 0xa2c0,0x12160,0x15ec8,0x191c0,0xa2d0,0x12168,0x15f78,0x191d0
.long 0xa2e0,0x12170,0x16028,0x191e0,0xa2f0,0x12178,0x160d8,0x191f0
.long 0xa400,0x12200,0x15690,0x19200,0xa410,0x12208,0x15740,0x19210
.long 0xa420,0x12210,0x157f0,0x19220,0xa430,0x12218,0x158a0,0x19230
.long 0xa440,0x12220,0x15950,0x19240,0xa450,0x12228,0x15a00,0x19250
.long 0xa460,0x12230,0x15ab0,0x19260,0xa470,0x12238,0x15b60,0x19270
.long 0xa480,0x12240,0x15c10,0x19280,0xa490,0x12248,0x15cc0,0x19290
.long 0xa4a0,0x12250,0x15d70,0x192a0,0xa4b0,0x12258,0x15e20,0x192b0
.long 0xa4c0,0x12260,0x15ed0,0x192c0,0xa4d0,0x12268,0x15f80,0x192d0
.long 0xa4e0,0x12270,0x16030,0x192e0,0xa4f0,0x12278,0x160e0,0x192f0
.long 0xa600,0x12300,0x15698,0x19300,0xa610,0x12308,0x15748,0x19310
.long 0xa620,0x12310,0x157f8,0x19320,0xa630,0x12318,0x158a8,0x19330
.long 0xa640,0x12320,0x15958,0x19340,0xa650,0x12328,0x15a08,0x19350
.long 0xa660,0x12330,0x15ab8,0x19360,0xa670,0x12338,0x15b68,0x19370
.long 0xa680,0x12340,0x15c18,0x19380,0xa690,0x12348,0x15cc8,0x19390
.long 0xa6a0,0x12350,0x15d78,0x193a0,0xa6b0,0x12358,0x15e28,0x193b0
.long 0xa6c0,0x12360,0x15ed8,0x193c0,0xa6d0,0x12368,0x15f88,0x193d0
.long 0xa6e0,0x12370,0x16038,0x193e0,0xa6f0,0x12378,0x160e8,0x193f0
.long 0x25860,0x15e00,0x0,0x0,0x25868,0x15e40,0x8,0xa000
.long 0x25870,0x15e90,0x10,0x80,0x25878,0x15ed0,0x18,0xa080
.long 0x25888,0x15f20,0x20,0x100,0x25890,0x15f60,0x28,0xa100
.long 0x25898,0x15fb0,0x30,0x180,0x258a0,0x15ff0,0x38,0xa180
.long 0x258b0,0x16000,0x40,0x200,0x258b8,0x16040,0x48,0xa200
.long 0x258c0,0x16090,0x50,0x280,0x258c8,0x160d0,0x58,0xa280
.long 0x258d8,0x16120,0x60,0x300,0x258e0,0x16160,0x68,0xa300
.long 0x258e8,0x161b0,0x70,0x380,0x258f0,0x161f0,0x78,0xa380
.long 0x25880,0x16200,0x80,0x0,0x25880,0x16240,0x88,0xa000
.long 0x25880,0x16290,0x90,0x80,0x25880,0x162d0,0x98,0xa080
.long 0x258a8,0x162e0,0xa0,0x100,0x258a8,0x162e0,0xa8,0xa100
.long 0x258a8,0x162f0,0xb0,0x180,0x258a8,0x162f0,0xb8,0xa180
.long 0x258d0,0x162c0,0xc0,0x200,0x258d0,0x162c0,0xc8,0xa200
.long 0x258d0,0x162d0,0xd0,0x280,0x258d0,0x162d0,0xd8,0xa280
.long 0x258f8,0x162e0,0xe0,0x300,0x258f8,0x162e0,0xe8,0xa300
.long 0x258f8,0x162f0,0xf0,0x380,0x258f8,0x162f0,0xf8,0xa380
.long 0x259a0,0x15e20,0xa000,0x0,0x259a8,0x15e60,0xa008,0xa000
.long 0x259b0,0x15eb0,0xa010,0x80,0x259b8,0x15ef0,0xa018,0xa080
.long 0x259c8,0x15f00,0xa020,0x100,0x259d0,0x15f40,0xa028,0xa100
.long 0x259d8,0x15f90,0xa030,0x180,0x259e0,0x15fd0,0xa038,0xa180
.long 0x259f0,0x16020,0xa040,0x200,0x259f8,0x16060,0xa048,0xa200
.long 0x25a00,0x160b0,0xa050,0x280,0x25a08,0x160f0,0xa058,0xa280
.long 0x25a18,0x16100,0xa060,0x300,0x25a20,0x16140,0xa068,0xa300
.long 0x25a28,0x16190,0xa070,0x380,0x25a30,0x161d0,0xa078,0xa380
.long 0x259c0,0x16220,0xa080,0x0,0x259c0,0x16260,0xa088,0xa000
.long 0x259c0,0x162b0,0xa090,0x80,0x259c0,0x162f0,0xa098,0xa080
.long 0x259e8,0x162c0,0xa0a0,0x100,0x259e8,0x162c0,0xa0a8,0xa100
.long 0x259e8,0x162d0,0xa0b0,0x180,0x259e8,0x162d0,0xa0b8,0xa180
.long 0x25a10,0x162e0,0xa0c0,0x200,0x25a10,0x162e0,0xa0c8,0xa200
.long 0x25a10,0x162f0,0xa0d0,0x280,0x25a10,0x162f0,0xa0d8,0xa280
.long 0x25a38,0x162c0,0xa0e0,0x300,0x25a38,0x162c0,0xa0e8,0xa300
.long 0x25a38,0x162d0,0xa0f0,0x380,0x25a38,0x162d0,0xa0f8,0xa380
.long 0x14d30,0xbe20,0x16be0,0x27690,0x14d40,0xbe30,0x16be0,0x27690
.long 0x14d50,0xbe40,0x16be0,0x27690,0x14d60,0xbe50,0x16be0,0x27690
.long 0x14d70,0xbe60,0x16be0,0x27690,0x14d80,0xbe70,0x16be0,0x27690
.long 0x14d90,0xbe80,0x16be0,0x27690,0x14da0,0xbe90,0x16be0,0x27690
.long 0x14dc0,0xc800,0x16be0,0x27690,0x14dd0,0xc810,0x16be0,0x27690
.long 0x14de0,0xc820,0x16be0,0x27690,0x14df0,0xc830,0x16be0,0x27690
.long 0x14e00,0xc840,0x16be0,0x27690,0x14e10,0xc850,0x16be0,0x27690
.long 0x14e20,0xc860,0x16be0,0x27690,0x14e30,0xc870,0x16be0,0x27690
.long 0x14e40,0xc880,0x16be0,0x27690,0x14e50,0xc890,0x16be0,0x27690
.long 0x14e70,0xd200,0x16be0,0x27690,0x14e80,0xd210,0x16be0,0x27690
.long 0x14e90,0xd220,0x16be0,0x27690,0x14ea0,0xd230,0x16be0,0x27690
.long 0x14eb0,0xd240,0x16be0,0x27690,0x14ec0,0xd250,0x16be0,0x27690
.long 0x14ed0,0xd260,0x16be0,0x27690,0x14ee0,0xd270,0x16be0,0x27690
.long 0x14ef0,0xd280,0x16be0,0x27690,0x14f00,0xd290,0x16be0,0x27690
.long 0x14f20,0xdc00,0x16be0,0x27690,0x14f30,0xdc10,0x16be0,0x27690
.long 0x14f40,0xdc20,0x16be0,0x27690,0x14f50,0xdc30,0x16be0,0x27690
.long 0x14f60,0xdc40,0x16be0,0x27690,0x14f70,0xdc50,0x16be0,0x27690
.long 0x14f80,0xdc60,0x16be0,0x27690,0x14f90,0xdc70,0x16be0,0x27690
.long 0x14fa0,0xdc80,0x16be0,0x27690,0x14fb0,0xdc90,0x16be0,0x27690
.long 0x14fd0,0xe600,0x16be0,0x27690,0x14fe0,0xe610,0x16be0,0x27690
.long 0x14ff0,0xe620,0x16be0,0x27690,0x15000,0xe630,0x16be0,0x27690
.long 0x15010,0xe640,0x16be0,0x27690,0x15020,0xe650,0x16be0,0x27690
.long 0x15030,0xe660,0x16be0,0x27690,0x15040,0xe670,0x16be0,0x27690
.long 0x15050,0xe680,0x16be0,0x27690,0x15060,0xe690,0x16be0,0x27690
.long 0x15080,0xf000,0x16be0,0x27690,0x15090,0xf010,0x16be0,0x27690
.long 0x150a0,0xf020,0x16be0,0x27690,0x150b0,0xf030,0x16be0,0x27690
.long 0x150c0,0xf040,0x16be0,0x27690,0x150d0,0xf050,0x16be0,0x27690
.long 0x150e0,0xf060,0x16be0,0x27690,0x150f0,0xf070,0x16be0,0x27690
.long 0x15100,0xf080,0x16be0,0x27690,0x15110,0xf090,0x16be0,0x27690
.long 0x15130,0xfa00,0x16be0,0x27690,0x15140,0xfa10,0x16be0,0x27690
.long 0x15150,0xfa20,0x16be0,0x27690,0x15160,0xfa30,0x16be0,0x27690
.long 0x15170,0xfa40,0x16be0,0x27690,0x15180,0xfa50,0x16be0,0x27690
.long 0xa100,0x12080,0x16180,0x19000,0xa110,0x12088,0x16230,0x19010
.long 0xa120,0x12090,0x162e0,0x19020,0xa130,0x12098,0x16390,0x19030
.long 0xa140,0x120a0,0x16440,0x19040,0xa150,0x120a8,0x164f0,0x19050
.long 0xa160,0x120b0,0x165a0,0x19060,0xa170,0x120b8,0x16650,0x19070
.long 0xa180,0x120c0,0x16700,0x19080,0xa190,0x120c8,0x167b0,0x19090
.long 0xa1a0,0x120d0,0x16860,0x190a0,0xa1b0,0x120d8,0x16910,0x190b0
.long 0xa1c0,0x120e0,0x169c0,0x190c0,0xa1d0,0x120e8,0x16a70,0x190d0
.long 0xa1e0,0x120f0,0x16b20,0x190e0,0xa1f0,0x120f8,0x16bd0,0x190f0
.long 0xa300,0x12180,0x16188,0x19100,0xa310,0x12188,0x16238,0x19110
.long 0xa320,0x12190,0x162e8,0x19120,0xa330,0x12198,0x16398,0x19130
.long 0xa340,0x121a0,0x16448,0x19140,0xa350,0x121a8,0x164f8,0x19150
.long 0xa360,0x121b0,0x165a8,0x19160,0xa370,0x121b8,0x16658,0x19170
.long 0xa380,0x121c0,0x16708,0x19180,0xa390,0x121c8,0x167b8,0x19190
.long 0xa3a0,0x121d0,0x16868,0x191a0,0xa3b0,0x121d8,0x16918,0x191b0
.long 0xa3c0,0x121e0,0x169c8,0x191c0,0xa3d0,0x121e8,0x16a78,0x191d0
.long 0xa3e0,0x121f0,0x16b28,0x191e0,0xa3f0,0x121f8,0x16bd8,0x191f0
.long 0xa500,0x12280,0x16190,0x19200,0xa510,0x12288,0x16240,0x19210
.long 0xa520,0x12290,0x162f0,0x19220,0xa530,0x12298,0x163a0,0x19230
.long 0xa540,0x122a0,0x16450,0x19240,0xa550,0x122a8,0x16500,0x19250
.long 0xa560,0x122b0,0x165b0,0x19260,0xa570,0x122b8,0x16660,0x19270
.long 0xa580,0x122c0,0x16710,0x19280,0xa590,0x122c8,0x167c0,0x19290
.long 0xa5a0,0x122d0,0x16870,0x192a0,0xa5b0,0x122d8,0x16920,0x192b0
.long 0xa5c0,0x122e0,0x169d0,0x192c0,0xa5d0,0x122e8,0x16a80,0x192d0
.long 0xa5e0,0x122f0,0x16b30,0x192e0,0xa5f0,0x122f8,0x16be0,0x192f0
.long 0xa700,0x12380,0x16198,0x19300,0xa710,0x12388,0x16248,0x19310
.long 0xa720,0x12390,0x162f8,0x19320,0xa730,0x12398,0x163a8,0x19330
.long 0xa740,0x123a0,0x16458,0x19340,0xa750,0x123a8,0x16508,0x19350
.long 0xa760,0x123b0,0x165b8,0x19360,0xa770,0x123b8,0x16668,0x19370
.long 0xa780,0x123c0,0x16718,0x19380,0xa790,0x123c8,0x167c8,0x19390
.long 0xa7a0,0x123d0,0x16878,0x193a0,0xa7b0,0x123d8,0x16928,0x193b0
.long 0xa7c0,0x123e0,0x169d8,0x193c0,0xa7d0,0x123e8,0x16a88,0x193d0
.long 0xa7e0,0x123f0,0x16b38,0x193e0,0xa7f0,0x123f8,0x16be8,0x193f0
.size tab_a, 12288
.p2align 8
.type tab_h,@object
tab_h:
.long 0x3f803f80,0x3f803f80,0x3f803f80,0x3f803f80,0x3f803f80,0x3f803f80,0xbf80bf80,0xbf80bf80
.long 0x3f7f3f80,0x3f753f7b,0x3f7d3f80,0x3f713f78,0xbdc98000,0xbe95be48,0xbe16bd49,0xbeacbe79
.long 0x3f7b3f80,0x3f553f6d,0x3f753f7f,0x3f463f62,0xbe488000,0xbf0ebec4,0xbe95bdc9,0xbf22bef1
.long 0x3f753f80,0x3f223f55,0x3f673f7d,0x3f043f3e,0xbe958000,0xbf46bf0e,0xbedbbe16,0xbf5cbf2c
.long 0x3f6d3f80,0x3ec43f35,0x3f553f7b,0x3e483f0e,0xbec48000,0xbf6dbf35,0xbf0ebe48,0xbf7bbf55
.long 0x3f623f80,0x3dc93f0e,0x3f3e3f78,0xbe163eac,0xbef18000,0xbf7fbf55,0xbf2cbe79,0xbf7dbf71
.long 0x3f553f80,0xbe483ec4,0x3f223f75,0xbef13dc9,0xbf0e8000,0xbf7bbf6d,0xbf46be95,0xbf62bf7f
.long 0x3f463f80,0xbef13e48,0x3f043f71,0xbf3ebe16,0xbf228000,0xbf62bf7b,0xbf5cbeac,0xbf2cbf7d
.long 0x3f803f80,0x3f803f80,0x3f803f80,0x3f803f80,0x3f803f80,0x3f803f80,0xbf80bf80,0xbf80bf80
.long 0x3f623f6d,0x3f463f55,0x3f5c3f67,0x3f3e3f4e,0xbef1bec4,0xbf22bf0e,0xbf04bedb,0xbf2cbf18
.long 0x3f0e3f35,0x3e483ec4,0x3ef13f22,0x3dc93e95,0xbf55bf35,0xbf7bbf6d,0xbf62bf46,0xbf7fbf75
.long 0x3dc93ec4,0xbef1be48,0xbd493e79,0xbf18beac,0xbf7fbf6d,0xbf62bf7b,0xbf80bf78,0xbf4ebf71
.long 0xbec4248d,0xbf6dbf35,0xbf0ebe48,0xbf7bbf55,0xbf6dbf80,0xbec4bf35,0xbf55bf7b,0xbe48bf0e
.long 0xbf46bec4,0xbf75bf7b,0xbf67bf18,0xbf5cbf80,0xbf22bf6d,0x3e95be48,0xbedbbf4e,0x3f043d49
.long 0xbf7bbf35,0xbf0ebf6d,0xbf7fbf62,0xbe95bf46,0xbe48bf35,0x3f553ec4,0x3dc9bef1,0x3f753f22
.long 0xbf75bf6d,0x3dc9bf0e,0xbf4ebf80,0x3edbbe79,0x3e95bec4,0x3f7f3f55,0x3f18bd49,0x3f673f78
.long 0x3f803f80,0x3f803f80,0x3f803f80,0x3f803f80,0x3f803f80,0x3f803f80,0xbf80bf80,0xbf80bf80
.long 0x3f223f35,0x3ef13f0e,0x3f183f2c,0x3edb3f04,0xbf46bf35,0xbf62bf55,0xbf4ebf3e,0xbf67bf5c
.long 0xbe48248d,0xbf0ebec4,0xbe95bdc9,0xbf22bef1,0xbf7bbf80,0xbf55bf6d,0xbf75bf7f,0xbf46bf62
.long 0xbf62bf35,0xbf7fbf7b,0xbf71bf4e,0xbf78bf80,0xbef1bf35,0x3dc9be48,0xbeacbf18,0x3e79bd49
.long 0xbf6dbf80,0xbec4bf35,0xbf55bf7b,0xbe48bf0e,0x3ec4a50d,0x3f6d3f35,0x3f0e3e48,0x3f7b3f55
.long 0xbe95bf35,0x3f223e48,0xbd49bf04,0x3f4e3edb,0x3f753f35,0x3f463f7b,0x3f803f5c,0x3f183f67
.long 0x3f0ea554,0x3f7b3f6d,0x3f463e95,0x3f623f7f,0x3f553f80,0xbe483ec4,0x3f223f75,0xbef13dc9
.long 0x3f7f3f35,0x3e953f55,0x3f783f67,0xbd493f18,0x3dc93f35,0xbf75bf0e,0xbe793edb,0xbf80bf4e
.long 0x3f803f80,0x3f803f80,0x3f803f80,0x3f803f80,0x3f803f80,0x3f803f80,0xbf80bf80,0xbf80bf80
.long 0x3e953ec4,0x3dc93e48,0x3e793eac,0x3d493e16,0xbf75bf6d,0xbf7fbf7b,0xbf78bf71,0xbf80bf7d
.long 0xbf55bf35,0xbf7bbf6d,0xbf62bf46,0xbf7fbf75,0xbf0ebf35,0xbe48bec4,0xbef1bf22,0xbdc9be95
.long 0xbf46bf6d,0xbe95bf0e,0xbf2cbf5c,0xbe16bedb,0x3f223ec4,0x3f753f55,0x3f3e3f04,0x3f7d3f67
.long 0x3ec4a554,0x3f6d3f35,0x3f0e3e48,0x3f7b3f55,0x3f6d3f80,0x3ec43f35,0x3f553f7b,0x3e483f0e
.long 0x3f7f3f6d,0x3ef13f55,0x3f713f7d,0x3e793f2c,0xbdc93ec4,0xbf62bf0e,0xbeac3e16,0xbf78bf3e
.long 0x3e483f35,0xbf55bec4,0xbdc93ef1,0xbf75bf22,0xbf7bbf35,0xbf0ebf6d,0xbf7fbf62,0xbe95bf46
.long 0xbf62bec4,0xbf22bf7b,0xbf7dbf2c,0xbeacbf5c,0xbef1bf6d,0x3f463e48,0xbe16bf3e,0x3f713f04
.long 0x3f803f80,0x3f803f80,0x3f803f80,0x3f803f80,0x3f803f80,0x3f803f80,0xbf80bf80,0xbf80bf80
.long 0xbdc9248d,0xbe95be48,0xbe16bd49,0xbeacbe79,0xbf7fbf80,0xbf75bf7b,0xbf7dbf80,0xbf71bf78
.long 0xbf7bbf80,0xbf55bf6d,0xbf75bf7f,0xbf46bf62,0x3e48a50d,0x3f0e3ec4,0x3e953dc9,0x3f223ef1
.long 0x3e95a554,0x3f463f0e,0x3edb3e16,0x3f5c3f2c,0x3f753f80,0x3f223f55,0x3f673f7d,0x3f043f3e
.long 0x3f6d3f80,0x3ec43f35,0x3f553f7b,0x3e483f0e,0xbec4258d,0xbf6dbf35,0xbf0ebe48,0xbf7bbf55
.long 0xbef125b0,0xbf7fbf55,0xbf2cbe79,0xbf7dbf71,0xbf62bf80,0xbdc9bf0e,0xbf3ebf78,0x3e16beac
.long 0xbf55bf80,0x3e48bec4,0xbf22bf75,0x3ef1bdc9,0x3f0ea5d4,0x3f7b3f6d,0x3f463e95,0x3f623f7f
.long 0x3f22a5f7,0x3f623f7b,0x3f5c3eac,0x3f2c3f7d,0x3f463f80,0xbef13e48,0x3f043f71,0xbf3ebe16
.long 0x3f803f80,0x3f803f80,0x3f803f80,0x3f803f80,0x3f803f80,0x3f803f80,0xbf80bf80,0xbf80bf80
.long 0xbef1bec4,0xbf22bf0e,0xbf04bedb,0xbf2cbf18,0xbf62bf6d,0xbf46bf55,0xbf5cbf67,0xbf3ebf4e
.long 0xbf0ebf35,0xbe48bec4,0xbef1bf22,0xbdc9be95,0x3f553f35,0x3f7b3f6d,0x3f623f46,0x3f7f3f75
.long 0x3f7f3f6d,0x3f623f7b,0x3f803f78,0x3f4e3f71,0x3dc93ec4,0xbef1be48,0xbd493e79,0xbf18beac
.long 0xbec425b0,0xbf6dbf35,0xbf0ebe48,0xbf7bbf55,0xbf6dbf80,0xbec4bf35,0xbf55bf7b,0xbe48bf0e
.long 0xbf22bf6d,0x3e95be48,0xbedbbf4e,0x3f043d49,0x3f463ec4,0x3f753f7b,0x3f673f18,0x3f5c3f80
.long 0x3f7b3f35,0x3f0e3f6d,0x3f7f3f62,0x3e953f46,0x3e483f35,0xbf55bec4,0xbdc93ef1,0xbf75bf22
.long 0xbe953ec4,0xbf7fbf55,0xbf183d49,0xbf67bf78,0xbf75bf6d,0x3dc9bf0e,0xbf4ebf80,0x3edbbe79
.long 0x3f803f80,0x3f803f80,0x3f803f80,0x3f803f80,0x3f803f80,0x3f803f80,0xbf80bf80,0xbf80bf80
.long 0xbf46bf35,0xbf62bf55,0xbf4ebf3e,0xbf67bf5c,0xbf22bf35,0xbef1bf0e,0xbf18bf2c,0xbedbbf04
.long 0x3e48a554,0x3f0e3ec4,0x3e953dc9,0x3f223ef1,0x3f7b3f80,0x3f553f6d,0x3f753f7f,0x3f463f62
.long 0x3ef13f35,0xbdc93e48,0x3eac3f18,0xbe793d49,0xbf62bf35,0xbf7fbf7b,0xbf71bf4e,0xbf78bf80
.long 0xbf6dbf80,0xbec4bf35,0xbf55bf7b,0xbe48bf0e,0x3ec4a5d4,0x3f6d3f35,0x3f0e3e48,0x3f7b3f55
.long 0x3f753f35,0x3f463f7b,0x3f803f5c,0x3f183f67,0x3e953f35,0xbf22be48,0x3d493f04,0xbf4ebedb
.long 0xbf0e261f,0xbf7bbf6d,0xbf46be95,0xbf62bf7f,0xbf55bf80,0x3e48bec4,0xbf22bf75,0x3ef1bdc9
.long 0xbdc9bf35,0x3f753f0e,0x3e79bedb,0x3f803f4e,0x3f7f3f35,0x3e953f55,0x3f783f67,0xbd493f18
.long 0x3f803f80,0x3f803f80,0x3f803f80,0x3f803f80,0x3f803f80,0x3f803f80,0xbf80bf80,0xbf80bf80
.long 0xbf75bf6d,0xbf7fbf7b,0xbf78bf71,0xbf80bf7d,0xbe95bec4,0xbdc9be48,0xbe79beac,0xbd49be16
.long 0x3f553f35,0x3f7b3f6d,0x3f623f46,0x3f7f3f75,0x3f0e3f35,0x3e483ec4,0x3ef13f22,0x3dc93e95
.long 0xbf22bec4,0xbf75bf55,0xbf3ebf04,0xbf7dbf67,0xbf46bf6d,0xbe95bf0e,0xbf2cbf5c,0xbe16bedb
.long 0x3ec4a5f7,0x3f6d3f35,0x3f0e3e48,0x3f7b3f55,0x3f6d3f80,0x3ec43f35,0x3f553f7b,0x3e483f0e
.long 0xbdc93ec4,0xbf62bf0e,0xbeac3e16,0xbf78bf3e,0xbf7fbf6d,0xbef1bf55,0xbf71bf7d,0xbe79bf2c
.long 0xbe48bf35,0x3f553ec4,0x3dc9bef1,0x3f753f22,0x3f7b3f35,0x3f0e3f6d,0x3f7f3f62,0x3e953f46
.long 0x3ef13f6d,0xbf46be48,0x3e163f3e,0xbf71bf04,0xbf62bec4,0xbf22bf7b,0xbf7dbf2c,0xbeacbf5c
.long 0x3f803f80,0x3f803f80,0x3f803f80,0x3f803f80,0x3f803f80,0x3f803f80,0xbf80bf80,0xbf80bf80
.long 0xbf7fbf80,0xbf75bf7b,0xbf7dbf80,0xbf71bf78,0x3dc9a50d,0x3e953e48,0x3e163d49,0x3eac3e79
.long 0x3f7b3f80,0x3f553f6d,0x3f753f7f,0x3f463f62,0xbe48258d,0xbf0ebec4,0xbe95bdc9,0xbf22bef1
.long 0xbf75bf80,0xbf22bf55,0xbf67bf7d,0xbf04bf3e,0x3e95a5d4,0x3f463f0e,0x3edb3e16,0x3f5c3f2c
.long 0x3f6d3f80,0x3ec43f35,0x3f553f7b,0x3e483f0e,0xbec4260d,0xbf6dbf35,0xbf0ebe48,0xbf7bbf55
.long 0xbf62bf80,0xbdc9bf0e,0xbf3ebf78,0x3e16beac,0x3ef1a630,0x3f7f3f55,0x3f2c3e79,0x3f7d3f71
.long 0x3f553f80,0xbe483ec4,0x3f223f75,0xbef13dc9,0xbf0e2654,0xbf7bbf6d,0xbf46be95,0xbf62bf7f
.long 0xbf46bf80,0x3ef1be48,0xbf04bf71,0x3f3e3e16,0x3f22a677,0x3f623f7b,0x3f5c3eac,0x3f2c3f7d
.long 0x3f803f80,0x3f803f80,0x3f803f80,0x3f803f80,0x3f803f80,0x3f803f80,0xbf80bf80,0xbf80bf80
.long 0xbf62bf6d,0xbf46bf55,0xbf5cbf67,0xbf3ebf4e,0x3ef13ec4,0x3f223f0e,0x3f043edb,0x3f2c3f18
.long 0x3f0e3f35,0x3e483ec4,0x3ef13f22,0x3dc93e95,0xbf55bf35,0xbf7bbf6d,0xbf62bf46,0xbf7fbf75
.long 0xbdc9bec4,0x3ef13e48,0x3d49be79,0x3f183eac,0x3f7f3f6d,0x3f623f7b,0x3f803f78,0x3f4e3f71
.long 0xbec4261f,0xbf6dbf35,0xbf0ebe48,0xbf7bbf55,0xbf6dbf80,0xbec4bf35,0xbf55bf7b,0xbe48bf0e
.long 0x3f463ec4,0x3f753f7b,0x3f673f18,0x3f5c3f80,0x3f223f6d,0xbe953e48,0x3edb3f4e,0xbf04bd49
.long 0xbf7bbf35,0xbf0ebf6d,0xbf7fbf62,0xbe95bf46,0xbe48bf35,0x3f553ec4,0x3dc9bef1,0x3f753f22
.long 0x3f753f6d,0xbdc93f0e,0x3f4e3f80,0xbedb3e79,0xbe953ec4,0xbf7fbf55,0xbf183d49,0xbf67bf78
.long 0x3f803f80,0x3f803f80,0x3f803f80,0x3f803f80,0x3f803f80,0x3f803f80,0xbf80bf80,0xbf80bf80
.long 0xbf22bf35,0xbef1bf0e,0xbf18bf2c,0xbedbbf04,0x3f463f35,0x3f623f55,0x3f4e3f3e,0x3f673f5c
.long 0xbe4825b0,0xbf0ebec4,0xbe95bdc9,0xbf22bef1,0xbf7bbf80,0xbf55bf6d,0xbf75bf7f,0xbf46bf62
.long 0x3f623f35,0x3f7f3f7b,0x3f713f4e,0x3f783f80,0x3ef13f35,0xbdc93e48,0x3eac3f18,0xbe793d49
.long 0xbf6dbf80,0xbec4bf35,0xbf55bf7b,0xbe48bf0e,0x3ec4a630,0x3f6d3f35,0x3f0e3e48,0x3f7b3f55
.long 0x3e953f35,0xbf22be48,0x3d493f04,0xbf4ebedb,0xbf75bf35,0xbf46bf7b,0xbf80bf5c,0xbf18bf67
.long 0x3f0ea742,0x3f7b3f6d,0x3f463e95,0x3f623f7f,0x3f553f80,0xbe483ec4,0x3f223f75,0xbef13dc9
.long 0xbf7fbf35,0xbe95bf55,0xbf78bf67,0x3d49bf18,0xbdc9bf35,0x3f753f0e,0x3e79bedb,0x3f803f4e
.long 0x3f803f80,0x3f803f80,0x3f803f80,0x3f803f80,0x3f803f80,0x3f803f80,0xbf80bf80,0xbf80bf80
.long 0xbe95bec4,0xbdc9be48,0xbe79beac,0xbd49be16,0x3f753f6d,0x3f7f3f7b,0x3f783f71,0x3f803f7d
.long 0xbf55bf35,0xbf7bbf6d,0xbf62bf46,0xbf7fbf75,0xbf0ebf35,0xbe48bec4,0xbef1bf22,0xbdc9be95
.long 0x3f463f6d,0x3e953f0e,0x3f2c3f5c,0x3e163edb,0xbf22bec4,0xbf75bf55,0xbf3ebf04,0xbf7dbf67
.long 0x3ec4a731,0x3f6d3f35,0x3f0e3e48,0x3f7b3f55,0x3f6d3f80,0x3ec43f35,0x3f553f7b,0x3e483f0e
.long 0xbf7fbf6d,0xbef1bf55,0xbf71bf7d,0xbe79bf2c,0x3dc9bec4,0x3f623f0e,0x3eacbe16,0x3f783f3e
.long 0x3e483f35,0xbf55bec4,0xbdc93ef1,0xbf75bf22,0xbf7bbf35,0xbf0ebf6d,0xbf7fbf62,0xbe95bf46
.long 0x3f623ec4,0x3f223f7b,0x3f7d3f2c,0x3eac3f5c,0x3ef13f6d,0xbf46be48,0x3e163f3e,0xbf71bf04
.long 0x3f803f80,0x3f803f80,0x3f803f80,0x3f803f80,0x3f803f80,0x3f803f80,0xbf80bf80,0xbf80bf80
.long 0x3dc9a554,0x3e953e48,0x3e163d49,0x3eac3e79,0x3f7f3f80,0x3f753f7b,0x3f7d3f80,0x3f713f78
.long 0xbf7bbf80,0xbf55bf6d,0xbf75bf7f,0xbf46bf62,0x3e48a5d4,0x3f0e3ec4,0x3e953dc9,0x3f223ef1
.long 0xbe95261f,0xbf46bf0e,0xbedbbe16,0xbf5cbf2c,0xbf75bf80,0xbf22bf55,0xbf67bf7d,0xbf04bf3e
.long 0x3f6d3f80,0x3ec43f35,0x3f553f7b,0x3e483f0e,0xbec42654,0xbf6dbf35,0xbf0ebe48,0xbf7bbf55
.long 0x3ef1a742,0x3f7f3f55,0x3f2c3e79,0x3f7d3f71,0x3f623f80,0x3dc93f0e,0x3f3e3f78,0xbe163eac
.long 0xbf55bf80,0x3e48bec4,0xbf22bf75,0x3ef1bdc9,0x3f0ea69f,0x3f7b3f6d,0x3f463e95,0x3f623f7f
.long 0xbf22a60d,0xbf62bf7b,0xbf5cbeac,0xbf2cbf7d,0xbf46bf80,0x3ef1be48,0xbf04bf71,0x3f3e3e16
.long 0x3f803f80,0x3f803f80,0x3f803f80,0x3f803f80,0x3f803f80,0x3f803f80,0xbf80bf80,0xbf80bf80
.long 0x3ef13ec4,0x3f223f0e,0x3f043edb,0x3f2c3f18,0x3f623f6d,0x3f463f55,0x3f5c3f67,0x3f3e3f4e
.long 0xbf0ebf35,0xbe48bec4,0xbef1bf22,0xbdc9be95,0x3f553f35,0x3f7b3f6d,0x3f623f46,0x3f7f3f75
.long 0xbf7fbf6d,0xbf62bf7b,0xbf80bf78,0xbf4ebf71,0xbdc9bec4,0x3ef13e48,0x3d49be79,0x3f183eac
.long 0xbec4a68d,0xbf6dbf35,0xbf0ebe48,0xbf7bbf55,0xbf6dbf80,0xbec4bf35,0xbf55bf7b,0xbe48bf0e
.long 0x3f223f6d,0xbe953e48,0x3edb3f4e,0xbf04bd49,0xbf46bec4,0xbf75bf7b,0xbf67bf18,0xbf5cbf80
.long 0x3f7b3f35,0x3f0e3f6d,0x3f7f3f62,0x3e953f46,0x3e483f35,0xbf55bec4,0xbdc93ef1,0xbf75bf22
.long 0x3e95bec4,0x3f7f3f55,0x3f18bd49,0x3f673f78,0x3f753f6d,0xbdc93f0e,0x3f4e3f80,0xbedb3e79
.long 0x3f803f80,0x3f803f80,0x3f803f80,0x3f803f80,0x3f803f80,0x3f803f80,0xbf80bf80,0xbf80bf80
.long 0x3f463f35,0x3f623f55,0x3f4e3f3e,0x3f673f5c,0x3f223f35,0x3ef13f0e,0x3f183f2c,0x3edb3f04
.long 0x3e48a5f7,0x3f0e3ec4,0x3e953dc9,0x3f223ef1,0x3f7b3f80,0x3f553f6d,0x3f753f7f,0x3f463f62
.long 0xbef1bf35,0x3dc9be48,0xbeacbf18,0x3e79bd49,0x3f623f35,0x3f7f3f7b,0x3f713f4e,0x3f783f80
.long 0xbf6dbf80,0xbec4bf35,0xbf55bf7b,0xbe48bf0e,0x3ec4a677,0x3f6d3f35,0x3f0e3e48,0x3f7b3f55
.long 0xbf75bf35,0xbf46bf7b,0xbf80bf5c,0xbf18bf67,0xbe95bf35,0x3f223e48,0xbd49bf04,0x3f4e3edb
.long 0xbf0ea60d,0xbf7bbf6d,0xbf46be95,0xbf62bf7f,0xbf55bf80,0x3e48bec4,0xbf22bf75,0x3ef1bdc9
.long 0x3dc93f35,0xbf75bf0e,0xbe793edb,0xbf80bf4e,0xbf7fbf35,0xbe95bf55,0xbf78bf67,0x3d49bf18
.long 0x3f803f80,0x3f803f80,0x3f803f80,0x3f803f80,0x3f803f80,0x3f803f80,0xbf80bf80,0xbf80bf80
.long 0x3f753f6d,0x3f7f3f7b,0x3f783f71,0x3f803f7d,0x3e953ec4,0x3dc93e48,0x3e793eac,0x3d493e16
.long 0x3f553f35,0x3f7b3f6d,0x3f623f46,0x3f7f3f75,0x3f0e3f35,0x3e483ec4,0x3ef13f22,0x3dc93e95
.long 0x3f223ec4,0x3f753f55,0x3f3e3f04,0x3f7d3f67,0x3f463f6d,0x3e953f0e,0x3f2c3f5c,0x3e163edb
.long 0x3ec4a742,0x3f6d3f35,0x3f0e3e48,0x3f7b3f55,0x3f6d3f80,0x3ec43f35,0x3f553f7b,0x3e483f0e
.long 0x3dc9bec4,0x3f623f0e,0x3eacbe16,0x3f783f3e,0x3f7f3f6d,0x3ef13f55,0x3f713f7d,0x3e793f2c
.long 0xbe48bf35,0x3f553ec4,0x3dc9bef1,0x3f753f22,0x3f7b3f35,0x3f0e3f6d,0x3f7f3f62,0x3e953f46
.long 0xbef1bf6d,0x3f463e48,0xbe16bf3e,0x3f713f04,0x3f623ec4,0x3f223f7b,0x3f7d3f2c,0x3eac3f5c
.long 0x3f353f80,0xbf35248d,0x3ec43f6d,0xbf6dbec4,0xbf358000,0xbf35bf80,0xbf6dbec4,0xbec4bf6d
.long 0x3f223f80,0xbf62be48,0x3e793f67,0xbf80bf18,0xbf468000,0xbef1bf7b,0xbf78bedb,0xbd49bf4e
.long 0x3f0e3f80,0xbf7bbec4,0x3dc93f62,0xbf75bf46,0xbf558000,0xbe48bf6d,0xbf7fbef1,0x3e95bf22
.long 0x3ef13f80,0xbf7fbf0e,0xbd493f5c,0xbf4ebf67,0xbf628000,0x3dc9bf55,0xbf80bf04,0x3f18bedb
.long 0x3ec43f80,0xbf6dbf35,0xbe483f55,0xbf0ebf7b,0xbf6d8000,0x3ec4bf35,0xbf7bbf0e,0x3f55be48
.long 0x3e953f80,0xbf46bf55,0xbeac3f4e,0xbe79bf80,0xbf758000,0x3f22bf0e,0xbf71bf18,0x3f783d49
.long 0x3e483f80,0xbf0ebf6d,0xbef13f46,0x3dc9bf75,0xbf7b8000,0x3f55bec4,0xbf62bf22,0x3f7f3e95
.long 0x3dc93f80,0xbe95bf7b,0xbf183f3e,0x3edbbf5c,0xbf7f8000,0x3f75be48,0xbf4ebf2c,0x3f673f04
.long 0xbf35bf80,0x3f35a554,0xbec4bf6d,0x3f6d3ec4,0x3f35a50d,0x3f353f80,0x3f6d3ec4,0x3ec43f6d
.long 0xbe95bf6d,0x3f7f3f0e,0x3e16bf2c,0x3f713f5c,0x3f753ec4,0x3dc93f55,0x3f7d3f3e,0xbeac3f04
.long 0x3e48bf35,0x3f553f6d,0x3f22be95,0x3ef13f7f,0x3f7b3f35,0xbf0e3ec4,0x3f463f75,0xbf62bdc9
.long 0x3f22bec4,0x3e953f7b,0x3f713e16,0xbe793f3e,0x3f463f6d,0xbf75be48,0x3eac3f7d,0xbf78bf2c
.long 0x3f6da554,0xbec43f35,0x3f7b3f0e,0xbf553e48,0x3ec43f80,0xbf6dbf35,0xbe483f55,0xbf0ebf7b
.long 0x3f7f3ec4,0xbf623e48,0x3f3e3f5c,0xbf7dbedb,0xbdc93f6d,0xbef1bf7b,0xbf2c3f04,0x3e16bf67
.long 0x3f553f35,0xbf7bbec4,0x3e953f7f,0xbf22bf62,0xbf0e3f35,0x3e48bf6d,0xbf753dc9,0x3f46bef1
.long 0x3ef13f6d,0xbf22bf55,0xbe793f71,0x3d49bf7d,0xbf623ec4,0x3f46bf0e,0xbf78beac,0x3f803e16
.long 0x3f353f80,0xbf3525b0,0x3ec43f6d,0xbf6dbec4,0xbf35258d,0xbf35bf80,0xbf6dbec4,0xbec4bf6d
.long 0xbdc93f35,0xbf75bf55,0xbf043eac,0xbf3ebf7d,0xbf7fbf35,0x3e95bf0e,0xbf5cbf71,0x3f2cbe16
.long 0xbf5525b0,0xbe48bf6d,0xbf7fbef1,0x3e95bf22,0xbf0ebf80,0x3f7b3ec4,0xbdc9bf62,0x3f753f46
.long 0xbf75bf35,0x3f46be48,0xbf2cbf78,0x3f7d3eac,0x3e95bf35,0x3f223f7b,0x3f3ebe79,0x3e163f71
.long 0xbec4bf80,0x3f6d3f35,0x3e48bf55,0x3f0e3f7b,0x3f6da5d4,0xbec43f35,0x3f7b3f0e,0xbf553e48
.long 0x3ef1bf35,0x3dc93f7b,0x3f67be16,0xbf043f2c,0x3f623f35,0xbf7fbe48,0x3edb3f7d,0xbf5cbf3e
.long 0x3f7ba5f7,0xbf553ec4,0x3f623f22,0xbf7fbe95,0x3e483f80,0xbf0ebf6d,0xbef13f46,0x3dc9bf75
.long 0x3f463f35,0xbf62bf0e,0x3e163f80,0xbeacbf78,0xbf223f35,0x3ef1bf55,0xbf7d3d49,0x3f71be79
.long 0xbf35bf80,0x3f35a5f7,0xbec4bf6d,0x3f6d3ec4,0x3f35a5d4,0x3f353f80,0x3f6d3ec4,0x3ec43f6d
.long 0x3ef1bec4,0x3f463f7b,0x3f4e3d49,0x3edb3f78,0x3f623f6d,0xbf223e48,0x3f183f80,0xbf67be79
.long 0x3f7b3f35,0xbf0e3ec4,0x3f463f75,0xbf62bdc9,0xbe483f35,0xbf55bf6d,0xbf223e95,0xbef1bf7f
.long 0x3dc93f6d,0xbf62bf55,0xbedb3f18,0xbf04bf80,0xbf7fbec4,0x3ef1bf0e,0xbf67bf4e,0x3f5cbd49
.long 0xbf6d261f,0x3ec4bf35,0xbf7bbf0e,0x3f55be48,0xbec4bf80,0x3f6d3f35,0x3e48bf55,0x3f0e3f7b
.long 0xbf22bf6d,0x3f753f0e,0xbd49bf78,0x3f183f71,0x3f46bec4,0xbe953f55,0x3f803e79,0xbf4e3eac
.long 0x3f0ebf35,0xbe483f6d,0x3f75bdc9,0xbf463ef1,0x3f553f35,0xbf7bbec4,0x3e953f7f,0xbf22bf62
.long 0x3f753ec4,0xbf7fbe48,0x3f043f67,0xbf2cbf4e,0xbe953f6d,0x3dc9bf7b,0xbf5c3edb,0x3f3ebf18
.long 0x3f353f80,0xbf35261f,0x3ec43f6d,0xbf6dbec4,0xbf35260d,0xbf35bf80,0xbf6dbec4,0xbec4bf6d
.long 0xbf46261f,0xbef1bf7b,0xbf78bedb,0xbd49bf4e,0xbf22bf80,0x3f623e48,0xbe79bf67,0x3f803f18
.long 0xbf0ebf80,0x3f7b3ec4,0xbdc9bf62,0x3f753f46,0x3f55a630,0x3e483f6d,0x3f7f3ef1,0xbe953f22
.long 0x3f62a731,0xbdc93f55,0x3f803f04,0xbf183edb,0x3ef13f80,0xbf7fbf0e,0xbd493f5c,0xbf4ebf67
.long 0x3ec43f80,0xbf6dbf35,0xbe483f55,0xbf0ebf7b,0xbf6d2654,0x3ec4bf35,0xbf7bbf0e,0x3f55be48
.long 0xbf75a68d,0x3f22bf0e,0xbf71bf18,0x3f783d49,0xbe95bf80,0x3f463f55,0x3eacbf4e,0x3e793f80
.long 0xbe48bf80,0x3f0e3f6d,0x3ef1bf46,0xbdc93f75,0x3f7ba677,0xbf553ec4,0x3f623f22,0xbf7fbe95
.long 0x3f7fa742,0xbf753e48,0x3f4e3f2c,0xbf67bf04,0x3dc93f80,0xbe95bf7b,0xbf183f3e,0x3edbbf5c
.long 0xbf35bf80,0x3f35a731,0xbec4bf6d,0x3f6d3ec4,0x3f35a630,0x3f353f80,0x3f6d3ec4,0x3ec43f6d
.long 0x3f753ec4,0x3dc93f55,0x3f7d3f3e,0xbeac3f04,0x3e953f6d,0xbf7fbf0e,0xbe163f2c,0xbf71bf5c
.long 0xbe483f35,0xbf55bf6d,0xbf223e95,0xbef1bf7f,0xbf7bbf35,0x3f0ebec4,0xbf46bf75,0x3f623dc9
.long 0xbf46bf6d,0x3f753e48,0xbeacbf7d,0x3f783f2c,0x3f22bec4,0x3e953f7b,0x3f713e16,0xbe793f3e
.long 0x3f6da742,0xbec43f35,0x3f7b3f0e,0xbf553e48,0x3ec43f80,0xbf6dbf35,0xbe483f55,0xbf0ebf7b
.long 0xbdc93f6d,0xbef1bf7b,0xbf2c3f04,0x3e16bf67,0xbf7fbec4,0x3f62be48,0xbf3ebf5c,0x3f7d3edb
.long 0xbf55bf35,0x3f7b3ec4,0xbe95bf7f,0x3f223f62,0x3f0ebf35,0xbe483f6d,0x3f75bdc9,0xbf463ef1
.long 0x3f62bec4,0xbf463f0e,0x3f783eac,0xbf80be16,0x3ef13f6d,0xbf22bf55,0xbe793f71,0x3d49bf7d
.long 0x3f353f80,0xbf35a68d,0x3ec43f6d,0xbf6dbec4,0xbf352654,0xbf35bf80,0xbf6dbec4,0xbec4bf6d
.long 0xbf7fbf35,0x3e95bf0e,0xbf5cbf71,0x3f2cbe16,0x3dc9bf35,0x3f753f55,0x3f04beac,0x3f3e3f7d
.long 0x3f55a742,0x3e483f6d,0x3f7f3ef1,0xbe953f22,0x3f0e3f80,0xbf7bbec4,0x3dc93f62,0xbf75bf46
.long 0xbe953f35,0xbf22bf7b,0xbf3e3e79,0xbe16bf71,0xbf75bf35,0x3f46be48,0xbf2cbf78,0x3f7d3eac
.long 0xbec4bf80,0x3f6d3f35,0x3e48bf55,0x3f0e3f7b,0x3f6da69f,0xbec43f35,0x3f7b3f0e,0xbf553e48
.long 0x3f623f35,0xbf7fbe48,0x3edb3f7d,0xbf5cbf3e,0xbef13f35,0xbdc9bf7b,0xbf673e16,0x3f04bf2c
.long 0xbf7ba60d,0x3f55bec4,0xbf62bf22,0x3f7f3e95,0xbe48bf80,0x3f0e3f6d,0x3ef1bf46,0xbdc93f75
.long 0x3f22bf35,0xbef13f55,0x3f7dbd49,0xbf713e79,0x3f463f35,0xbf62bf0e,0x3e163f80,0xbeacbf78
.long 0xbf35bf80,0x3f35a742,0xbec4bf6d,0x3f6d3ec4,0x3f35a677,0x3f353f80,0x3f6d3ec4,0x3ec43f6d
.long 0x3f623f6d,0xbf223e48,0x3f183f80,0xbf67be79,0xbef13ec4,0xbf46bf7b,0xbf4ebd49,0xbedbbf78
.long 0xbf7bbf35,0x3f0ebec4,0xbf46bf75,0x3f623dc9,0x3e48bf35,0x3f553f6d,0x3f22be95,0x3ef13f7f
.long 0x3f7f3ec4,0xbef13f0e,0x3f673f4e,0xbf5c3d49,0x3dc93f6d,0xbf62bf55,0xbedb3f18,0xbf04bf80
.long 0xbf6da60d,0x3ec4bf35,0xbf7bbf0e,0x3f55be48,0xbec4bf80,0x3f6d3f35,0x3e48bf55,0x3f0e3f7b
.long 0x3f46bec4,0xbe953f55,0x3f803e79,0xbf4e3eac,0x3f223f6d,0xbf75bf0e,0x3d493f78,0xbf18bf71
.long 0xbf0e3f35,0x3e48bf6d,0xbf753dc9,0x3f46bef1,0xbf55bf35,0x3f7b3ec4,0xbe95bf7f,0x3f223f62
.long 0x3e95bf6d,0xbdc93f7b,0x3f5cbedb,0xbf3e3f18,0x3f753ec4,0xbf7fbe48,0x3f043f67,0xbf2cbf4e
.long 0x3f353f80,0xbf35a654,0x3ec43f6d,0xbf6dbec4,0xbf35268d,0xbf35bf80,0xbf6dbec4,0xbec4bf6d
.long 0xbf22bf80,0x3f623e48,0xbe79bf67,0x3f803f18,0x3f46a69f,0x3ef13f7b,0x3f783edb,0x3d493f4e
.long 0x3f0e3f80,0xbf7bbec4,0x3dc93f62,0xbf75bf46,0xbf5526b0,0xbe48bf6d,0xbf7fbef1,0x3e95bf22
.long 0xbef1bf80,0x3f7f3f0e,0x3d49bf5c,0x3f4e3f67,0x3f62a7b1,0xbdc93f55,0x3f803f04,0xbf183edb
.long 0x3ec43f80,0xbf6dbf35,0xbe483f55,0xbf0ebf7b,0xbf6d26d4,0x3ec4bf35,0xbf7bbf0e,0x3f55be48
.long 0xbe95bf80,0x3f463f55,0x3eacbf4e,0x3e793f80,0x3f75270d,0xbf223f0e,0x3f713f18,0xbf78bd49
.long 0x3e483f80,0xbf0ebf6d,0xbef13f46,0x3dc9bf75,0xbf7b26f7,0x3f55bec4,0xbf62bf22,0x3f7f3e95
.long 0xbdc9bf80,0x3e953f7b,0x3f18bf3e,0xbedb3f5c,0x3f7fa7c2,0xbf753e48,0x3f4e3f2c,0xbf67bf04
.long 0xbf35bf80,0x3f35a754,0xbec4bf6d,0x3f6d3ec4,0x3f35a69f,0x3f353f80,0x3f6d3ec4,0x3ec43f6d
.long 0x3e953f6d,0xbf7fbf0e,0xbe163f2c,0xbf71bf5c,0xbf75bec4,0xbdc9bf55,0xbf7dbf3e,0x3eacbf04
.long 0x3e48bf35,0x3f553f6d,0x3f22be95,0x3ef13f7f,0x3f7b3f35,0xbf0e3ec4,0x3f463f75,0xbf62bdc9
.long 0xbf223ec4,0xbe95bf7b,0xbf71be16,0x3e79bf3e,0xbf46bf6d,0x3f753e48,0xbeacbf7d,0x3f783f2c
.long 0x3f6da777,0xbec43f35,0x3f7b3f0e,0xbf553e48,0x3ec43f80,0xbf6dbf35,0xbe483f55,0xbf0ebf7b
.long 0xbf7fbec4,0x3f62be48,0xbf3ebf5c,0x3f7d3edb,0x3dc9bf6d,0x3ef13f7b,0x3f2cbf04,0xbe163f67
.long 0x3f553f35,0xbf7bbec4,0x3e953f7f,0xbf22bf62,0xbf0e3f35,0x3e48bf6d,0xbf753dc9,0x3f46bef1
.long 0xbef1bf6d,0x3f223f55,0x3e79bf71,0xbd493f7d,0x3f62bec4,0xbf463f0e,0x3f783eac,0xbf80be16
.long 0x3f353f80,0xbf35a60d,0x3ec43f6d,0xbf6dbec4,0xbf3526b0,0xbf35bf80,0xbf6dbec4,0xbec4bf6d
.long 0x3dc9bf35,0x3f753f55,0x3f04beac,0x3f3e3f7d,0x3f7f3f35,0xbe953f0e,0x3f5c3f71,0xbf2c3e16
.long 0xbf55a58e,0xbe48bf6d,0xbf7fbef1,0x3e95bf22,0xbf0ebf80,0x3f7b3ec4,0xbdc9bf62,0x3f753f46
.long 0x3f753f35,0xbf463e48,0x3f2c3f78,0xbf7dbeac,0xbe953f35,0xbf22bf7b,0xbf3e3e79,0xbe16bf71
.long 0xbec4bf80,0x3f6d3f35,0x3e48bf55,0x3f0e3f7b,0x3f6da7c2,0xbec43f35,0x3f7b3f0e,0xbf553e48
.long 0xbef13f35,0xbdc9bf7b,0xbf673e16,0x3f04bf2c,0xbf62bf35,0x3f7f3e48,0xbedbbf7d,0x3f5c3f3e
.long 0x3f7ba78d,0xbf553ec4,0x3f623f22,0xbf7fbe95,0x3e483f80,0xbf0ebf6d,0xbef13f46,0x3dc9bf75
.long 0xbf46bf35,0x3f623f0e,0xbe16bf80,0x3eac3f78,0x3f22bf35,0xbef13f55,0x3f7dbd49,0xbf713e79
.long 0xbf35bf80,0x3f35a765,0xbec4bf6d,0x3f6d3ec4,0x3f35a7b1,0x3f353f80,0x3f6d3ec4,0x3ec43f6d
.long 0xbef13ec4,0xbf46bf7b,0xbf4ebd49,0xbedbbf78,0xbf62bf6d,0x3f22be48,0xbf18bf80,0x3f673e79
.long 0x3f7b3f35,0xbf0e3ec4,0x3f463f75,0xbf62bdc9,0xbe483f35,0xbf55bf6d,0xbf223e95,0xbef1bf7f
.long 0xbdc9bf6d,0x3f623f55,0x3edbbf18,0x3f043f80,0x3f7f3ec4,0xbef13f0e,0x3f673f4e,0xbf5c3d49
.long 0xbf6d258d,0x3ec4bf35,0xbf7bbf0e,0x3f55be48,0xbec4bf80,0x3f6d3f35,0x3e48bf55,0x3f0e3f7b
.long 0x3f223f6d,0xbf75bf0e,0x3d493f78,0xbf18bf71,0xbf463ec4,0x3e95bf55,0xbf80be79,0x3f4ebeac
.long 0x3f0ebf35,0xbe483f6d,0x3f75bdc9,0xbf463ef1,0x3f553f35,0xbf7bbec4,0x3e953f7f,0xbf22bf62
.long 0xbf75bec4,0x3f7f3e48,0xbf04bf67,0x3f2c3f4e,0x3e95bf6d,0xbdc93f7b,0x3f5cbedb,0xbf3e3f18
.long 0x3f353f80,0xbf35a58e,0x3ec43f6d,0xbf6dbec4,0xbf3526d4,0xbf35bf80,0xbf6dbec4,0xbec4bf6d
.long 0x3f46a777,0x3ef13f7b,0x3f783edb,0x3d493f4e,0x3f223f80,0xbf62be48,0x3e793f67,0xbf80bf18
.long 0xbf0ebf80,0x3f7b3ec4,0xbdc9bf62,0x3f753f46,0x3f55a7c2,0x3e483f6d,0x3f7f3ef1,0xbe953f22
.long 0xbf622804,0x3dc9bf55,0xbf80bf04,0x3f18bedb,0xbef1bf80,0x3f7f3f0e,0x3d49bf5c,0x3f4e3f67
.long 0x3ec43f80,0xbf6dbf35,0xbe483f55,0xbf0ebf7b,0xbf6d271f,0x3ec4bf35,0xbf7bbf0e,0x3f55be48
.long 0x3f752754,0xbf223f0e,0x3f713f18,0xbf78bd49,0x3e953f80,0xbf46bf55,0xbeac3f4e,0xbe79bf80
.long 0xbe48bf80,0x3f0e3f6d,0x3ef1bf46,0xbdc93f75,0x3f7b268d,0xbf553ec4,0x3f623f22,0xbf7fbe95
.long 0xbf7f2889,0x3f75be48,0xbf4ebf2c,0x3f673f04,0xbdc9bf80,0x3e953f7b,0x3f18bf3e,0xbedb3f5c
.long 0xbf35bf80,0x3f35a777,0xbec4bf6d,0x3f6d3ec4,0x3f35270d,0x3f353f80,0x3f6d3ec4,0x3ec43f6d
.long 0xbf75bec4,0xbdc9bf55,0xbf7dbf3e,0x3eacbf04,0xbe95bf6d,0x3f7f3f0e,0x3e16bf2c,0x3f713f5c
.long 0xbe483f35,0xbf55bf6d,0xbf223e95,0xbef1bf7f,0xbf7bbf35,0x3f0ebec4,0xbf46bf75,0x3f623dc9
.long 0x3f463f6d,0xbf75be48,0x3eac3f7d,0xbf78bf2c,0xbf223ec4,0xbe95bf7b,0xbf71be16,0x3e79bf3e
.long 0x3f6da796,0xbec43f35,0x3f7b3f0e,0xbf553e48,0x3ec43f80,0xbf6dbf35,0xbe483f55,0xbf0ebf7b
.long 0x3dc9bf6d,0x3ef13f7b,0x3f2cbf04,0xbe163f67,0x3f7f3ec4,0xbf623e48,0x3f3e3f5c,0xbf7dbedb
.long 0xbf55bf35,0x3f7b3ec4,0xbe95bf7f,0x3f223f62,0x3f0ebf35,0xbe483f6d,0x3f75bdc9,0xbf463ef1
.long 0xbf623ec4,0x3f46bf0e,0xbf78beac,0x3f803e16,0xbef1bf6d,0x3f223f55,0x3e79bf71,0xbd493f7d
.long 0x3f353f80,0xbf35a137,0x3ec43f6d,0xbf6dbec4,0xbf3526f7,0xbf35bf80,0xbf6dbec4,0xbec4bf6d
.long 0x3f7f3f35,0xbe953f0e,0x3f5c3f71,0xbf2c3e16,0xbdc93f35,0xbf75bf55,0xbf043eac,0xbf3ebf7d
.long 0x3f55a78d,0x3e483f6d,0x3f7f3ef1,0xbe953f22,0x3f0e3f80,0xbf7bbec4,0x3dc93f62,0xbf75bf46
.long 0x3e95bf35,0x3f223f7b,0x3f3ebe79,0x3e163f71,0x3f753f35,0xbf463e48,0x3f2c3f78,0xbf7dbeac
.long 0xbec4bf80,0x3f6d3f35,0x3e48bf55,0x3f0e3f7b,0x3f6d268d,0xbec43f35,0x3f7b3f0e,0xbf553e48
.long 0xbf62bf35,0x3f7f3e48,0xbedbbf7d,0x3f5c3f3e,0x3ef1bf35,0x3dc93f7b,0x3f67be16,0xbf043f2c
.long 0xbf7b2816,0x3f55bec4,0xbf62bf22,0x3f7f3e95,0xbe48bf80,0x3f0e3f6d,0x3ef1bf46,0xbdc93f75
.long 0xbf223f35,0x3ef1bf55,0xbf7d3d49,0x3f71be79,0xbf46bf35,0x3f623f0e,0xbe16bf80,0x3eac3f78
.long 0xbf35bf80,0x3f35a784,0xbec4bf6d,0x3f6d3ec4,0x3f35a7c2,0x3f353f80,0x3f6d3ec4,0x3ec43f6d
.long 0xbf62bf6d,0x3f22be48,0xbf18bf80,0x3f673e79,0x3ef1bec4,0x3f463f7b,0x3f4e3d49,0x3edb3f78
.long 0xbf7bbf35,0x3f0ebec4,0xbf46bf75,0x3f623dc9,0x3e48bf35,0x3f553f6d,0x3f22be95,0x3ef13f7f
.long 0xbf7fbec4,0x3ef1bf0e,0xbf67bf4e,0x3f5cbd49,0xbdc9bf6d,0x3f623f55,0x3edbbf18,0x3f043f80
.long 0xbf6d268d,0x3ec4bf35,0xbf7bbf0e,0x3f55be48,0xbec4bf80,0x3f6d3f35,0x3e48bf55,0x3f0e3f7b
.long 0xbf463ec4,0x3e95bf55,0xbf80be79,0x3f4ebeac,0xbf22bf6d,0x3f753f0e,0xbd49bf78,0x3f183f71
.long 0xbf0e3f35,0x3e48bf6d,0xbf753dc9,0x3f46bef1,0xbf55bf35,0x3f7b3ec4,0xbe95bf7f,0x3f223f62
.long 0xbe953f6d,0x3dc9bf7b,0xbf5c3edb,0x3f3ebf18,0xbf75bec4,0x3f7f3e48,0xbf04bf67,0x3f2c3f4e
.long 0x0,0x40,0x2800,0x2800,0x8,0x48,0x2850,0x2810
.long 0x10,0x40,0x28a0,0x2820,0x18,0x48,0x28f0,0x2830
.long 0xa0,0xe0,0x2940,0x2840,0xa8,0xe8,0x2990,0x2850
.long 0xb0,0xe0,0x29e0,0x2860,0xb8,0xe8,0x2a30,0x2870
.long 0x140,0x180,0x2a80,0x2880,0x148,0x188,0x2ad0,0x2890
.long 0x150,0x180,0x2b20,0x28a0,0x158,0x188,0x2b70,0x28b0
.long 0x1e0,0x220,0x2bc0,0x28c0,0x1e8,0x228,0x2c10,0x28d0
.long 0x1f0,0x220,0x2c60,0x28e0,0x1f8,0x228,0x2cb0,0x28f0
.long 0x280,0x2c0,0x2808,0x2900,0x288,0x2c8,0x2858,0x2910
.long 0x290,0x2c0,0x28a8,0x2920,0x298,0x2c8,0x28f8,0x2930
.long 0x320,0x360,0x2948,0x2940,0x328,0x368,0x2998,0x2950
.long 0x330,0x360,0x29e8,0x2960,0x338,0x368,0x2a38,0x2970
.long 0x3c0,0x400,0x2a88,0x2980,0x3c8,0x408,0x2ad8,0x2990
.long 0x3d0,0x400,0x2b28,0x29a0,0x3d8,0x408,0x2b78,0x29b0
.long 0x460,0x4a0,0x2bc8,0x29c0,0x468,0x4a8,0x2c18,0x29d0
.long 0x470,0x4a0,0x2c68,0x29e0,0x478,0x4a8,0x2cb8,0x29f0
.long 0x500,0x540,0x2810,0x2a00,0x508,0x548,0x2860,0x2a10
.long 0x510,0x540,0x28b0,0x2a20,0x518,0x548,0x2900,0x2a30
.long 0x5a0,0x5e0,0x2950,0x2a40,0x5a8,0x5e8,0x29a0,0x2a50
.long 0x5b0,0x5e0,0x29f0,0x2a60,0x5b8,0x5e8,0x2a40,0x2a70
.long 0x640,0x680,0x2a90,0x2a80,0x648,0x688,0x2ae0,0x2a90
.long 0x650,0x680,0x2b30,0x2aa0,0x658,0x688,0x2b80,0x2ab0
.long 0x6e0,0x720,0x2bd0,0x2ac0,0x6e8,0x728,0x2c20,0x2ad0
.long 0x6f0,0x720,0x2c70,0x2ae0,0x6f8,0x728,0x2cc0,0x2af0
.long 0x780,0x7c0,0x2818,0x2b00,0x788,0x7c8,0x2868,0x2b10
.long 0x790,0x7c0,0x28b8,0x2b20,0x798,0x7c8,0x2908,0x2b30
.long 0x820,0x860,0x2958,0x2b40,0x828,0x868,0x29a8,0x2b50
.long 0x830,0x860,0x29f8,0x2b60,0x838,0x868,0x2a48,0x2b70
.long 0x8c0,0x900,0x2a98,0x2b80,0x8c8,0x908,0x2ae8,0x2b90
.long 0x8d0,0x900,0x2b38,0x2ba0,0x8d8,0x908,0x2b88,0x2bb0
.long 0x960,0x9a0,0x2bd8,0x2bc0,0x968,0x9a8,0x2c28,0x2bd0
.long 0x970,0x9a0,0x2c78,0x2be0,0x978,0x9a8,0x2cc8,0x2bf0
.long 0x0,0xff010,0x1fe020,0x0,0x10,0xff020,0x1fe030,0x20
.long 0x20,0xff030,0x1fe040,0x40,0x30,0xff040,0x203000,0x60
.long 0x40,0x104000,0x203010,0x80,0x5000,0x104010,0x203020,0xa0
.long 0x5010,0x104020,0x203030,0xc0,0x5020,0x104030,0x203040,0xe0
.long 0x5030,0x104040,0x208000,0x100,0x5040,0x109000,0x208010,0x120
.long 0xa000,0x109010,0x208020,0x140,0xa010,0x109020,0x208030,0x160
.long 0xa020,0x109030,0x208040,0x180,0xa030,0x109040,0x20d000,0x1a0
.long 0xa040,0x10e000,0x20d010,0x1c0,0xf000,0x10e010,0x20d020,0x1e0
.long 0xf010,0x10e020,0x20d030,0x200,0xf020,0x10e030,0x20d040,0x220
.long 0xf030,0x10e040,0x212000,0x240,0xf040,0x113000,0x212010,0x260
.long 0x14000,0x113010,0x212020,0x280,0x14010,0x113020,0x212030,0x2a0
.long 0x14020,0x113030,0x212040,0x2c0,0x14030,0x113040,0x217000,0x2e0
.long 0x14040,0x118000,0x217010,0x300,0x19000,0x118010,0x217020,0x320
.long 0x19010,0x118020,0x217030,0x340,0x19020,0x118030,0x217040,0x360
.long 0x19030,0x118040,0x21c000,0x380,0x19040,0x11d000,0x21c010,0x3a0
.long 0x1e000,0x11d010,0x21c020,0x3c0,0x1e010,0x11d020,0x21c030,0x3e0
.long 0x1e020,0x11d030,0x21c040,0x400,0x1e030,0x11d040,0x221000,0x420
.long 0x1e040,0x122000,0x221010,0x440,0x23000,0x122010,0x221020,0x460
.long 0x23010,0x122020,0x221030,0x480,0x23020,0x122030,0x221040,0x4a0
.long 0x23030,0x122040,0x226000,0x4c0,0x23040,0x127000,0x226010,0x4e0
.long 0x28000,0x127010,0x226020,0x500,0x28010,0x127020,0x226030,0x520
.long 0x28020,0x127030,0x226040,0x540,0x28030,0x127040,0x22b000,0x560
.long 0x28040,0x12c000,0x22b010,0x580,0x2d000,0x12c010,0x22b020,0x5a0
.long 0x2d010,0x12c020,0x22b030,0x5c0,0x2d020,0x12c030,0x22b040,0x5e0
.long 0x2d030,0x12c040,0x230000,0x600,0x2d040,0x131000,0x230010,0x620
.long 0x32000,0x131010,0x230020,0x640,0x32010,0x131020,0x230030,0x660
.long 0x32020,0x131030,0x230040,0x680,0x32030,0x131040,0x235000,0x6a0
.long 0x32040,0x136000,0x235010,0x6c0,0x37000,0x136010,0x235020,0x6e0
.long 0x37010,0x136020,0x235030,0x700,0x37020,0x136030,0x235040,0x720
.long 0x37030,0x136040,0x23a000,0x740,0x37040,0x13b000,0x23a010,0x760
.long 0x3c000,0x13b010,0x23a020,0x780,0x3c010,0x13b020,0x23a030,0x7a0
.long 0x3c020,0x13b030,0x23a040,0x7c0,0x3c030,0x13b040,0x23f000,0x7e0
.long 0x0,0x8c60,0x10920,0x17280,0x10,0x8c70,0x10930,0x17290
.long 0x20,0x8c80,0x10940,0x18600,0x30,0x8c90,0x10950,0x18610
.long 0x40,0x7d00,0x10960,0x18620,0x50,0x7d10,0x10970,0x18630
.long 0x60,0x7d20,0x10980,0x18640,0x70,0x7d30,0x10990,0x18650
.long 0x80,0x7d40,0xfa00,0x18660,0x90,0x7d50,0xfa10,0x18670
.long 0x1400,0x7d60,0xfa20,0x18680,0x1410,0x7d70,0xfa30,0x18690
.long 0x1420,0x7d80,0xfa40,0x17700,0x1430,0x7d90,0xfa50,0x17710
.long 0x1440,0x9100,0xfa60,0x17720,0x1450,0x9110,0xfa70,0x17730
.long 0x1460,0x9120,0xfa80,0x17740,0x1470,0x9130,0xfa90,0x17750
.long 0x1480,0x9140,0x10e00,0x17760,0x1490,0x9150,0x10e10,0x17770
.long 0x500,0x9160,0x10e20,0x17780,0x510,0x9170,0x10e30,0x17790
.long 0x520,0x9180,0x10e40,0x18b00,0x530,0x9190,0x10e50,0x18b10
.long 0x540,0x8200,0x10e60,0x18b20,0x550,0x8210,0x10e70,0x18b30
.long 0x560,0x8220,0x10e80,0x18b40,0x570,0x8230,0x10e90,0x18b50
.long 0x580,0x8240,0xff00,0x18b60,0x590,0x8250,0xff10,0x18b70
.long 0x1900,0x8260,0xff20,0x18b80,0x1910,0x8270,0xff30,0x18b90
.long 0x1920,0x8280,0xff40,0x19000,0x1930,0x8290,0xff50,0x19010
.long 0x1940,0x9600,0xff60,0x19020,0x1950,0x9610,0xff70,0x19030
.long 0x1960,0x9620,0xff80,0x19040,0x1970,0x9630,0xff90,0x19050
.long 0x1980,0x9640,0x11300,0x19060,0x1990,0x9650,0x11310,0x19070
.long 0xa00,0x9660,0x11320,0x19080,0xa10,0x9670,0x11330,0x19090
.long 0xa20,0x9680,0x11340,0x1a400,0xa30,0x9690,0x11350,0x1a410
.long 0xa40,0x8700,0x11360,0x1a420,0xa50,0x8710,0x11370,0x1a430
.long 0xa60,0x8720,0x11380,0x1a440,0xa70,0x8730,0x11390,0x1a450
.long 0xa80,0x8740,0x11800,0x1a460,0xa90,0x8750,0x11810,0x1a470
.long 0x1e00,0x8760,0x11820,0x1a480,0x1e10,0x8770,0x11830,0x1a490
.long 0x1e20,0x8780,0x11840,0x19500,0x1e30,0x8790,0x11850,0x19510
.long 0x1e40,0x9b00,0x11860,0x19520,0x1e50,0x9b10,0x11870,0x19530
.long 0x1e60,0x9b20,0x11880,0x19540,0x1e70,0x9b30,0x11890,0x19550
.long 0x1e80,0x9b40,0x12c00,0x19560,0x1e90,0x9b50,0x12c10,0x19570
.long 0xf00,0x9b60,0x12c20,0x19580,0xf10,0x9b70,0x12c30,0x19590
.long 0xf20,0x9b80,0x12c40,0x1a900,0xf30,0x9b90,0x12c50,0x1a910
.long 0x1ef40,0x0,0x3e860,0x7f820,0x1ef50,0x10,0x3e870,0x7f830
.long 0x1ef60,0x20,0x3e880,0x7f840,0x1ef70,0x30,0x3e890,0x7f850
.long 0x1ef80,0x40,0x41000,0x7f860,0x1ef90,0x50,0x41010,0x7f870
.long 0x20300,0x60,0x41020,0x7f880,0x20310,0x70,0x41030,0x7f890
.long 0x20320,0x80,0x41040,0x82000,0x20330,0x90,0x41050,0x82010
.long 0x20340,0x2800,0x41060,0x82020,0x20350,0x2810,0x41070,0x82030
.long 0x20360,0x2820,0x41080,0x82040,0x20370,0x2830,0x41090,0x82050
.long 0x20380,0x2840,0x43800,0x82060,0x20390,0x2850,0x43810,0x82070
.long 0x20800,0x2860,0x43820,0x82080,0x20810,0x2870,0x43830,0x82090
.long 0x20820,0x2880,0x43840,0x84800,0x20830,0x2890,0x43850,0x84810
.long 0x20840,0x5000,0x43860,0x84820,0x20850,0x5010,0x43870,0x84830
.long 0x20860,0x5020,0x43880,0x84840,0x20870,0x5030,0x43890,0x84850
.long 0x20880,0x5040,0x46000,0x84860,0x20890,0x5050,0x46010,0x84870
.long 0x21c00,0x5060,0x46020,0x84880,0x21c10,0x5070,0x46030,0x84890
.long 0x21c20,0x5080,0x46040,0x87000,0x21c30,0x5090,0x46050,0x87010
.long 0x21c40,0x7800,0x46060,0x87020,0x21c50,0x7810,0x46070,0x87030
.long 0x21c60,0x7820,0x46080,0x87040,0x21c70,0x7830,0x46090,0x87050
.long 0x21c80,0x7840,0x48800,0x87060,0x21c90,0x7850,0x48810,0x87070
.long 0x20d00,0x7860,0x48820,0x87080,0x20d10,0x7870,0x48830,0x87090
.long 0x20d20,0x7880,0x48840,0x89800,0x20d30,0x7890,0x48850,0x89810
.long 0x20d40,0xa000,0x48860,0x89820,0x20d50,0xa010,0x48870,0x89830
.long 0x20d60,0xa020,0x48880,0x89840,0x20d70,0xa030,0x48890,0x89850
.long 0x20d80,0xa040,0x4b000,0x89860,0x20d90,0xa050,0x4b010,0x89870
.long 0x22100,0xa060,0x4b020,0x89880,0x22110,0xa070,0x4b030,0x89890
.long 0x22120,0xa080,0x4b040,0x8c000,0x22130,0xa090,0x4b050,0x8c010
.long 0x22140,0xc800,0x4b060,0x8c020,0x22150,0xc810,0x4b070,0x8c030
.long 0x22160,0xc820,0x4b080,0x8c040,0x22170,0xc830,0x4b090,0x8c050
.long 0x22180,0xc840,0x4d800,0x8c060,0x22190,0xc850,0x4d810,0x8c070
.long 0x21200,0xc860,0x4d820,0x8c080,0x21210,0xc870,0x4d830,0x8c090
.long 0x21220,0xc880,0x4d840,0x8e800,0x21230,0xc890,0x4d850,0x8e810
.long 0x21240,0xf000,0x4d860,0x8e820,0x21250,0xf010,0x4d870,0x8e830
.long 0x21260,0xf020,0x4d880,0x8e840,0x21270,0xf030,0x4d890,0x8e850
.long 0xbe080,0xff040,0x0,0x0,0xbe090,0xff050,0x8,0x8
.long 0xc0800,0xff060,0x10,0x9c0,0xc0810,0xff070,0x18,0x9c8
.long 0xc0820,0xff080,0x140,0x140,0xc0830,0xff090,0x148,0x148
.long 0xc0840,0x101800,0x150,0xb00,0xc0850,0x101810,0x158,0xb08
.long 0xc0860,0x101820,0x280,0x280,0xc0870,0x101830,0x288,0x288
.long 0xc0880,0x101840,0x290,0xc40,0xc0890,0x101850,0x298,0xc48
.long 0xc3000,0x101860,0x3c0,0x3c0,0xc3010,0x101870,0x3c8,0x3c8
.long 0xc3020,0x101880,0x3d0,0xd80,0xc3030,0x101890,0x3d8,0xd88
.long 0xc3040,0x104000,0xa0,0xa0,0xc3050,0x104010,0xa8,0xa8
.long 0xc3060,0x104020,0xb0,0xa60,0xc3070,0x104030,0xb8,0xa68
.long 0xc3080,0x104040,0x1e0,0x1e0,0xc3090,0x104050,0x1e8,0x1e8
.long 0xc5800,0x104060,0x1f0,0xba0,0xc5810,0x104070,0x1f8,0xba8
.long 0xc5820,0x104080,0x320,0x320,0xc5830,0x104090,0x328,0x328
.long 0xc5840,0x106800,0x330,0xce0,0xc5850,0x106810,0x338,0xce8
.long 0xc5860,0x106820,0x460,0x460,0xc5870,0x106830,0x468,0x468
.long 0xc5880,0x106840,0x470,0xe20,0xc5890,0x106850,0x478,0xe28
.long 0xc8000,0x106860,0x50,0x50,0xc8010,0x106870,0x58,0x58
.long 0xc8020,0x106880,0x60,0xa10,0xc8030,0x106890,0x68,0xa18
.long 0xc8040,0x109000,0x190,0x190,0xc8050,0x109010,0x198,0x198
.long 0xc8060,0x109020,0x1a0,0xb50,0xc8070,0x109030,0x1a8,0xb58
.long 0xc8080,0x109040,0x2d0,0x2d0,0xc8090,0x109050,0x2d8,0x2d8
.long 0xca800,0x109060,0x2e0,0xc90,0xca810,0x109070,0x2e8,0xc98
.long 0xca820,0x109080,0x410,0x410,0xca830,0x109090,0x418,0x418
.long 0xca840,0x10b800,0x420,0xdd0,0xca850,0x10b810,0x428,0xdd8
.long 0xca860,0x10b820,0xf0,0xf0,0xca870,0x10b830,0xf8,0xf8
.long 0xca880,0x10b840,0x100,0xab0,0xca890,0x10b850,0x108,0xab8
.long 0xcd000,0x10b860,0x230,0x230,0xcd010,0x10b870,0x238,0x238
.long 0xcd020,0x10b880,0x240,0xbf0,0xcd030,0x10b890,0x248,0xbf8
.long 0xcd040,0x10e000,0x370,0x370,0xcd050,0x10e010,0x378,0x378
.long 0xcd060,0x10e020,0x380,0xd30,0xcd070,0x10e030,0x388,0xd38
.long 0xcd080,0x10e040,0x4b0,0x4b0,0xcd090,0x10e050,0x4b8,0x4b8
.long 0xcf800,0x10e060,0x4c0,0xe70,0xcf810,0x10e070,0x4c8,0xe78
.long 0x80,0x580,0xa80,0x3c80,0x88,0x588,0xa88,0x3c88
.long 0x90,0x590,0xa90,0x3c90,0x98,0x598,0xa98,0x3c98
.long 0x1c0,0x6c0,0xbc0,0x3dc0,0x1c8,0x6c8,0xbc8,0x3dc8
.long 0x1d0,0x6d0,0xbd0,0x3dd0,0x1d8,0x6d8,0xbd8,0x3dd8
.long 0x300,0x800,0xd00,0x3f00,0x308,0x808,0xd08,0x3f08
.long 0x310,0x810,0xd10,0x3f10,0x318,0x818,0xd18,0x3f18
.long 0x440,0x940,0xe40,0x4040,0x448,0x948,0xe48,0x4048
.long 0x450,0x950,0xe50,0x4050,0x458,0x958,0xe58,0x4058
.long 0x120,0x620,0x1520,0x4720,0x128,0x628,0x1528,0x4728
.long 0x130,0x630,0x1530,0x4730,0x138,0x638,0x1538,0x4738
.long 0x260,0x760,0x1660,0x4860,0x268,0x768,0x1668,0x4868
.long 0x270,0x770,0x1670,0x4870,0x278,0x778,0x1678,0x4878
.long 0x3a0,0x8a0,0x17a0,0x49a0,0x3a8,0x8a8,0x17a8,0x49a8
.long 0x3b0,0x8b0,0x17b0,0x49b0,0x3b8,0x8b8,0x17b8,0x49b8
.long 0x4e0,0x9e0,0x18e0,0x4ae0,0x4e8,0x9e8,0x18e8,0x4ae8
.long 0x4f0,0x9f0,0x18f0,0x4af0,0x4f8,0x9f8,0x18f8,0x4af8
.long 0xb20,0x1020,0x2380,0x5580,0xb28,0x1028,0x2388,0x5588
.long 0xb30,0x1030,0x2390,0x5590,0xb38,0x1038,0x2398,0x5598
.long 0xc60,0x1160,0x24c0,0x56c0,0xc68,0x1168,0x24c8,0x56c8
.long 0xc70,0x1170,0x24d0,0x56d0,0xc78,0x1178,0x24d8,0x56d8
.long 0xda0,0x12a0,0x2600,0x5800,0xda8,0x12a8,0x2608,0x5808
.long 0xdb0,0x12b0,0x2610,0x5810,0xdb8,0x12b8,0x2618,0x5818
.long 0xee0,0x13e0,0x2740,0x5940,0xee8,0x13e8,0x2748,0x5948
.long 0xef0,0x13f0,0x2750,0x5950,0xef8,0x13f8,0x2758,0x5958
.long 0xf80,0x1480,0x2e20,0x6020,0xf88,0x1488,0x2e28,0x6028
.long 0xf90,0x1490,0x2e30,0x6030,0xf98,0x1498,0x2e38,0x6038
.long 0x10c0,0x15c0,0x2f60,0x6160,0x10c8,0x15c8,0x2f68,0x6168
.long 0x10d0,0x15d0,0x2f70,0x6170,0x10d8,0x15d8,0x2f78,0x6178
.long 0x1200,0x1700,0x30a0,0x62a0,0x1208,0x1708,0x30a8,0x62a8
.long 0x1210,0x1710,0x30b0,0x62b0,0x1218,0x1718,0x30b8,0x62b8
.long 0x1340,0x1840,0x31e0,0x63e0,0x1348,0x1848,0x31e8,0x63e8
.long 0x1350,0x1850,0x31f0,0x63f0,0x1358,0x1858,0x31f8,0x63f8
.long 0x0,0xaa0,0xa00,0x21c00,0x8,0xaa8,0xa08,0x22108
.long 0x10,0xab0,0xa10,0x22610,0x18,0xab8,0xa18,0x22b18
.long 0x140,0xbe0,0xb40,0x23020,0x148,0xbe8,0xb48,0x23528
.long 0x150,0xbf0,0xb50,0x23a30,0x158,0xbf8,0xb58,0x23f38
.long 0x280,0xd20,0xc80,0x24440,0x288,0xd28,0xc88,0x24948
.long 0x290,0xd30,0xc90,0x24e50,0x298,0xd38,0xc98,0x25358
.long 0x3c0,0xe60,0xdc0,0x25860,0x3c8,0xe68,0xdc8,0x25d68
.long 0x3d0,0xe70,0xdd0,0x26270,0x3d8,0xe78,0xdd8,0x26778
.long 0x20,0xac0,0xa20,0x21c08,0x28,0xac8,0xa28,0x22110
.long 0x30,0xad0,0xa30,0x22618,0x38,0xad8,0xa38,0x22b20
.long 0x160,0xc00,0xb60,0x23028,0x168,0xc08,0xb68,0x23530
.long 0x170,0xc10,0xb70,0x23a38,0x178,0xc18,0xb78,0x23f40
.long 0x2a0,0xd40,0xca0,0x24448,0x2a8,0xd48,0xca8,0x24950
.long 0x2b0,0xd50,0xcb0,0x24e58,0x2b8,0xd58,0xcb8,0x25360
.long 0x3e0,0xe80,0xde0,0x25868,0x3e8,0xe88,0xde8,0x25d70
.long 0x3f0,0xe90,0xdf0,0x26278,0x3f8,0xe98,0xdf8,0x26780
.long 0xa0,0xf00,0x14a0,0x21c10,0xa8,0xf08,0x14a8,0x22118
.long 0xb0,0xf10,0x14b0,0x22620,0xb8,0xf18,0x14b8,0x22b28
.long 0x1e0,0x1040,0x15e0,0x23030,0x1e8,0x1048,0x15e8,0x23538
.long 0x1f0,0x1050,0x15f0,0x23a40,0x1f8,0x1058,0x15f8,0x23f48
.long 0x320,0x1180,0x1720,0x24450,0x328,0x1188,0x1728,0x24958
.long 0x330,0x1190,0x1730,0x24e60,0x338,0x1198,0x1738,0x25368
.long 0x460,0x12c0,0x1860,0x25870,0x468,0x12c8,0x1868,0x25d78
.long 0x470,0x12d0,0x1870,0x26280,0x478,0x12d8,0x1878,0x26788
.long 0xc0,0xf20,0x14c0,0x21c18,0xc8,0xf28,0x14c8,0x22120
.long 0xd0,0xf30,0x14d0,0x22628,0xd8,0xf38,0x14d8,0x22b30
.long 0x200,0x1060,0x1600,0x23038,0x208,0x1068,0x1608,0x23540
.long 0x210,0x1070,0x1610,0x23a48,0x218,0x1078,0x1618,0x23f50
.long 0x340,0x11a0,0x1740,0x24458,0x348,0x11a8,0x1748,0x24960
.long 0x350,0x11b0,0x1750,0x24e68,0x358,0x11b8,0x1758,0x25370
.long 0x480,0x12e0,0x1880,0x25878,0x488,0x12e8,0x1888,0x25d80
.long 0x490,0x12f0,0x1890,0x26288,0x498,0x12f8,0x1898,0x26790
.long 0x0,0x8000,0x14000,0x0,0x10,0x8008,0x140b0,0x80
.long 0x20,0x8010,0x14160,0x100,0x30,0x8018,0x14210,0x180
.long 0x40,0x8020,0x142c0,0x200,0x50,0x8028,0x14370,0x280
.long 0x60,0x8030,0x14420,0x300,0x70,0x8038,0x144d0,0x380
.long 0x80,0x8040,0x14580,0x0,0x90,0x8048,0x14630,0x80
.long 0xa0,0x8050,0x146e0,0x100,0xb0,0x8058,0x14790,0x180
.long 0xc0,0x8060,0x14840,0x200,0xd0,0x8068,0x148f0,0x280
.long 0xe0,0x8070,0x149a0,0x300,0xf0,0x8078,0x14a50,0x380
.long 0x100,0x8080,0x14b00,0x0,0x110,0x8088,0x14bb0,0x80
.long 0x120,0x8090,0x14c60,0x100,0x130,0x8098,0x14d10,0x180
.long 0x140,0x80a0,0x14dc0,0x200,0x150,0x80a8,0x14e70,0x280
.long 0x160,0x80b0,0x14f20,0x300,0x170,0x80b8,0x14fd0,0x380
.long 0x180,0x80c0,0x15080,0x0,0x190,0x80c8,0x15130,0x80
.long 0x1a0,0x80d0,0x151e0,0x100,0x1b0,0x80d8,0x15290,0x180
.long 0x1c0,0x80e0,0x15340,0x200,0x1d0,0x80e8,0x153f0,0x280
.long 0x1e0,0x80f0,0x154a0,0x300,0x1f0,0x80f8,0x15550,0x380
.long 0x200,0x8100,0x14008,0x0,0x210,0x8108,0x140b8,0x80
.long 0x220,0x8110,0x14168,0x100,0x230,0x8118,0x14218,0x180
.long 0x240,0x8120,0x142c8,0x200,0x250,0x8128,0x14378,0x280
.long 0x260,0x8130,0x14428,0x300,0x270,0x8138,0x144d8,0x380
.long 0x280,0x8140,0x14588,0x0,0x290,0x8148,0x14638,0x80
.long 0x2a0,0x8150,0x146e8,0x100,0x2b0,0x8158,0x14798,0x180
.long 0x2c0,0x8160,0x14848,0x200,0x2d0,0x8168,0x148f8,0x280
.long 0x2e0,0x8170,0x149a8,0x300,0x2f0,0x8178,0x14a58,0x380
.long 0x300,0x8180,0x14b08,0x0,0x310,0x8188,0x14bb8,0x80
.long 0x320,0x8190,0x14c68,0x100,0x330,0x8198,0x14d18,0x180
.long 0x340,0x81a0,0x14dc8,0x200,0x350,0x81a8,0x14e78,0x280
.long 0x360,0x81b0,0x14f28,0x300,0x370,0x81b8,0x14fd8,0x380
.long 0x380,0x81c0,0x15088,0x0,0x390,0x81c8,0x15138,0x80
.long 0x3a0,0x81d0,0x151e8,0x100,0x3b0,0x81d8,0x15298,0x180
.long 0x3c0,0x81e0,0x15348,0x200,0x3d0,0x81e8,0x153f8,0x280
.long 0x3e0,0x81f0,0x154a8,0x300,0x3f0,0x81f8,0x15558,0x380
.long 0x15190,0xfa60,0x19000,0x1d000,0x151a0,0xfa70,0x19010,0x1d010
.long 0x151b0,0xfa80,0x19020,0x1d020,0x151c0,0xfa90,0x19030,0x1d030
.long 0x151e0,0x10400,0x19040,0x1d040,0x151f0,0x10410,0x19050,0x1d050
.long 0x15200,0x10420,0x19060,0x1d060,0x15210,0x10430,0x19070,0x1d070
.long 0x15220,0x10440,0x19080,0x1d080,0x15230,0x10450,0x19090,0x1d090
.long 0x15240,0x10460,0x190a0,0x1d0a0,0x15250,0x10470,0x190b0,0x1d0b0
.long 0x15260,0x10480,0x190c0,0x1d0c0,0x15270,0x10490,0x190d0,0x1d0d0
.long 0x15290,0x10e00,0x190e0,0x1d0e0,0x152a0,0x10e10,0x190f0,0x1d0f0
.long 0x152b0,0x10e20,0x19100,0x1d100,0x152c0,0x10e30,0x19110,0x1d110
.long 0x152d0,0x10e40,0x19120,0x1d120,0x152e0,0x10e50,0x19130,0x1d130
.long 0x152f0,0x10e60,0x19140,0x1d140,0x15300,0x10e70,0x19150,0x1d150
.long 0x15310,0x10e80,0x19160,0x1d160,0x15320,0x10e90,0x19170,0x1d170
.long 0x15340,0x11800,0x19180,0x1d180,0x15350,0x11810,0x19190,0x1d190
.long 0x15360,0x11820,0x191a0,0x1d1a0,0x15370,0x11830,0x191b0,0x1d1b0
.long 0x15380,0x11840,0x191c0,0x1d1c0,0x15390,0x11850,0x191d0,0x1d1d0
.long 0x153a0,0x11860,0x191e0,0x1d1e0,0x153b0,0x11870,0x191f0,0x1d1f0
.long 0x153c0,0x11880,0x19200,0x1d200,0x153d0,0x11890,0x19210,0x1d210
.long 0x153f0,0x12200,0x19220,0x1d220,0x15400,0x12210,0x19230,0x1d230
.long 0x15410,0x12220,0x19240,0x1d240,0x15420,0x12230,0x19250,0x1d250
.long 0x15430,0x12240,0x19260,0x1d260,0x15440,0x12250,0x19270,0x1d270
.long 0x15450,0x12260,0x19280,0x1d280,0x15460,0x12270,0x19290,0x1d290
.long 0x15470,0x12280,0x192a0,0x1d2a0,0x15480,0x12290,0x192b0,0x1d2b0
.long 0x154a0,0x12c00,0x192c0,0x1d2c0,0x154b0,0x12c10,0x192d0,0x1d2d0
.long 0x154c0,0x12c20,0x192e0,0x1d2e0,0x154d0,0x12c30,0x192f0,0x1d2f0
.long 0x154e0,0x12c40,0x19300,0x1d300,0x154f0,0x12c50,0x19310,0x1d310
.long 0x15500,0x12c60,0x19320,0x1d320,0x15510,0x12c70,0x19330,0x1d330
.long 0x15520,0x12c80,0x19340,0x1d340,0x15530,0x12c90,0x19350,0x1d350
.long 0x15550,0x13600,0x19360,0x1d360,0x15560,0x13610,0x19370,0x1d370
.long 0x15570,0x13620,0x19380,0x1d380,0x15580,0x13630,0x19390,0x1d390
.long 0x15590,0x13640,0x193a0,0x1d3a0,0x155a0,0x13650,0x193b0,0x1d3b0
.long 0x155b0,0x13660,0x193c0,0x1d3c0,0x155c0,0x13670,0x193d0,0x1d3d0
.long 0x155d0,0x13680,0x193e0,0x1d3e0,0x155e0,0x13690,0x193f0,0x1d3f0
.long 0x248d3f80,0xa554bf80,0xbf353f35,0x3f35bf35,0xbf808000,0x3f80a50d,0xbf35bf35,0x3f353f35
.long 0xbdc93f80,0x3e95bf7b,0xbf4e3f2c,0x3f67bf04,0xbf7f8000,0x3f753e48,0xbf18bf3e,0x3edb3f5c
.long 0xbe483f80,0x3f0ebf6d,0xbf623f22,0x3f7fbe95,0xbf7b8000,0x3f553ec4,0xbef1bf46,0x3dc93f75
.long 0xbe953f80,0x3f46bf55,0xbf713f18,0x3f78bd49,0xbf758000,0x3f223f0e,0xbeacbf4e,0xbe793f80
.long 0xbec43f80,0x3f6dbf35,0xbf7b3f0e,0x3f553e48,0xbf6d8000,0x3ec43f35,0xbe48bf55,0xbf0e3f7b
.long 0xbef13f80,0x3f7fbf0e,0xbf803f04,0x3f183edb,0xbf628000,0x3dc93f55,0xbd49bf5c,0xbf4e3f67
.long 0xbf0e3f80,0x3f7bbec4,0xbf7f3ef1,0x3e953f22,0xbf558000,0xbe483f6d,0x3dc9bf62,0xbf753f46
.long 0xbf223f80,0x3f62be48,0xbf783edb,0xbd493f4e,0xbf468000,0xbef13f7b,0x3e79bf67,0xbf803f18
.long 0x25b03f80,0xa5f7bf80,0xbf353f35,0x3f35bf35,0xbf80258d,0x3f80a5d4,0xbf35bf35,0x3f353f35
.long 0xbef13f6d,0x3f22bf55,0xbf783eac,0x3f80be16,0xbf62bec4,0x3f463f0e,0xbe79bf71,0x3d493f7d
.long 0xbf553f35,0x3f7bbec4,0xbf75bdc9,0x3f463ef1,0xbf0ebf35,0x3e483f6d,0x3e95bf7f,0xbf223f62
.long 0xbf7f3ec4,0x3f623e48,0xbf2cbf04,0x3e163f67,0xbdc9bf6d,0xbef13f7b,0x3f3ebf5c,0xbf7d3edb
.long 0xbf6d25b0,0x3ec43f35,0xbe48bf55,0xbf0e3f7b,0x3ec4bf80,0xbf6d3f35,0x3f7bbf0e,0xbf55be48
.long 0xbf22bec4,0xbe953f7b,0x3eacbf7d,0xbf783f2c,0x3f46bf6d,0xbf753e48,0x3f71be16,0xbe79bf3e
.long 0xbe48bf35,0xbf553f6d,0x3f46bf75,0xbf623dc9,0x3f7bbf35,0xbf0ebec4,0x3f223e95,0x3ef1bf7f
.long 0x3e95bf6d,0xbf7f3f0e,0x3f7dbf3e,0xbeacbf04,0x3f75bec4,0x3dc9bf55,0x3e163f2c,0x3f71bf5c
.long 0x261f3f80,0xa731bf80,0xbf353f35,0x3f35bf35,0xbf80260d,0x3f80a630,0xbf35bf35,0x3f353f35
.long 0xbf463f35,0x3f62bf0e,0xbf7dbd49,0x3f713e79,0xbf22bf35,0x3ef13f55,0x3e16bf80,0xbeac3f78
.long 0xbf7b261f,0x3f553ec4,0xbef1bf46,0x3dc93f75,0x3e48bf80,0xbf0e3f6d,0x3f62bf22,0xbf7f3e95
.long 0xbef1bf35,0xbdc93f7b,0x3edbbf7d,0xbf5c3f3e,0x3f62bf35,0xbf7f3e48,0x3f673e16,0xbf04bf2c
.long 0x3ec4bf80,0xbf6d3f35,0x3f7bbf0e,0xbf55be48,0x3f6da630,0xbec4bf35,0x3e483f55,0x3f0ebf7b
.long 0x3f75bf35,0xbf46be48,0x3f3e3e79,0x3e16bf71,0x3e953f35,0x3f22bf7b,0xbf2c3f78,0x3f7dbeac
.long 0x3f55a731,0x3e48bf6d,0xbdc93f62,0x3f75bf46,0xbf0e3f80,0x3f7bbec4,0xbf7f3ef1,0x3e953f22
.long 0x3dc93f35,0x3f75bf55,0xbf5c3f71,0x3f2c3e16,0xbf7f3f35,0x3e953f0e,0xbf04beac,0xbf3e3f7d
.long 0xa68d3f80,0xa742bf80,0xbf353f35,0x3f35bf35,0xbf802654,0x3f80a677,0xbf35bf35,0x3f353f35
.long 0xbf753ec4,0x3f7fbe48,0xbf5cbedb,0x3f3e3f18,0xbe95bf6d,0x3dc93f7b,0x3f04bf67,0xbf2c3f4e
.long 0xbf0ebf35,0x3e483f6d,0x3e95bf7f,0xbf223f62,0x3f55bf35,0xbf7b3ec4,0x3f753dc9,0xbf46bef1
.long 0x3f22bf6d,0xbf753f0e,0x3f80be79,0xbf4ebeac,0x3f463ec4,0xbe95bf55,0xbd493f78,0x3f18bf71
.long 0x3f6da742,0xbec4bf35,0x3e483f55,0x3f0ebf7b,0xbec43f80,0x3f6dbf35,0xbf7b3f0e,0x3f553e48
.long 0xbdc93f6d,0x3f62bf55,0xbf673f4e,0x3f5c3d49,0xbf7f3ec4,0x3ef13f0e,0xbedbbf18,0xbf043f80
.long 0xbf7b3f35,0x3f0e3ec4,0xbf22be95,0xbef13f7f,0xbe48bf35,0xbf553f6d,0x3f46bf75,0xbf623dc9
.long 0xbef1bec4,0xbf463f7b,0x3f18bf80,0xbf673e79,0x3f62bf6d,0xbf22be48,0x3f4ebd49,0x3edbbf78
.long 0xa6543f80,0xa754bf80,0xbf353f35,0x3f35bf35,0xbf80268d,0x3f80a69f,0xbf35bf35,0x3f353f35
.long 0xbf7fa654,0x3f753e48,0xbf18bf3e,0x3edb3f5c,0x3dc9bf80,0xbe953f7b,0x3f4ebf2c,0xbf673f04
.long 0x3e48bf80,0xbf0e3f6d,0x3f62bf22,0xbf7f3e95,0x3f7ba69f,0xbf55bec4,0x3ef13f46,0xbdc9bf75
.long 0x3f75a754,0xbf22bf0e,0x3eac3f4e,0x3e79bf80,0xbe953f80,0x3f46bf55,0xbf713f18,0x3f78bd49
.long 0xbec43f80,0x3f6dbf35,0xbf7b3f0e,0x3f553e48,0xbf6d26b0,0x3ec43f35,0xbe48bf55,0xbf0e3f7b
.long 0xbf62a60d,0x3dc93f55,0xbd49bf5c,0xbf4e3f67,0x3ef1bf80,0xbf7f3f0e,0x3f80bf04,0xbf18bedb
.long 0x3f0ebf80,0xbf7b3ec4,0x3f7fbef1,0xbe95bf22,0x3f55a7b1,0x3e48bf6d,0xbdc93f62,0x3f75bf46
.long 0x3f46a765,0x3ef1bf7b,0xbe793f67,0x3f80bf18,0xbf223f80,0x3f62be48,0xbf783edb,0xbd493f4e
.long 0xa60d3f80,0xa765bf80,0xbf353f35,0x3f35bf35,0xbf8026b0,0x3f80a7b1,0xbf35bf35,0x3f353f35
.long 0xbf62bec4,0x3f463f0e,0xbe79bf71,0x3d493f7d,0x3ef1bf6d,0xbf223f55,0x3f78beac,0xbf803e16
.long 0x3f55bf35,0xbf7b3ec4,0x3f753dc9,0xbf46bef1,0x3f0e3f35,0xbe48bf6d,0xbe953f7f,0x3f22bf62
.long 0x3dc93f6d,0x3ef1bf7b,0xbf3e3f5c,0x3f7dbedb,0xbf7f3ec4,0x3f623e48,0xbf2cbf04,0x3e163f67
.long 0xbf6da58e,0x3ec43f35,0xbe48bf55,0xbf0e3f7b,0x3ec4bf80,0xbf6d3f35,0x3f7bbf0e,0xbf55be48
.long 0x3f46bf6d,0xbf753e48,0x3f71be16,0xbe79bf3e,0x3f223ec4,0x3e95bf7b,0xbeac3f7d,0x3f78bf2c
.long 0x3e483f35,0x3f55bf6d,0xbf463f75,0x3f62bdc9,0xbf7b3f35,0x3f0e3ec4,0xbf22be95,0xbef13f7f
.long 0xbf753ec4,0xbdc93f55,0xbe16bf2c,0xbf713f5c,0x3e95bf6d,0xbf7f3f0e,0x3f7dbf3e,0xbeacbf04
.long 0xa58e3f80,0xa777bf80,0xbf353f35,0x3f35bf35,0xbf8026d4,0x3f80270d,0xbf35bf35,0x3f353f35
.long 0xbf22bf35,0x3ef13f55,0x3e16bf80,0xbeac3f78,0x3f46bf35,0xbf623f0e,0x3f7d3d49,0xbf71be79
.long 0x3f7ba777,0xbf55bec4,0x3ef13f46,0xbdc9bf75,0xbe483f80,0x3f0ebf6d,0xbf623f22,0x3f7fbe95
.long 0xbf623f35,0x3f7fbe48,0xbf67be16,0x3f043f2c,0xbef1bf35,0xbdc93f7b,0x3edbbf7d,0xbf5c3f3e
.long 0x3ec4bf80,0xbf6d3f35,0x3f7bbf0e,0xbf55be48,0x3f6da7c2,0xbec4bf35,0x3e483f55,0x3f0ebf7b
.long 0x3e953f35,0x3f22bf7b,0xbf2c3f78,0x3f7dbeac,0xbf753f35,0x3f463e48,0xbf3ebe79,0xbe163f71
.long 0xbf552804,0xbe483f6d,0x3dc9bf62,0xbf753f46,0x3f0ebf80,0xbf7b3ec4,0x3f7fbef1,0xbe95bf22
.long 0x3f7fbf35,0xbe95bf0e,0x3f043eac,0x3f3ebf7d,0x3dc93f35,0x3f75bf55,0xbf5c3f71,0x3f2c3e16
.long 0xa1373f80,0xa784bf80,0xbf353f35,0x3f35bf35,0xbf8026f7,0x3f80a7c2,0xbf35bf35,0x3f353f35
.long 0xbe95bf6d,0x3dc93f7b,0x3f04bf67,0xbf2c3f4e,0x3f75bec4,0xbf7f3e48,0x3f5c3edb,0xbf3ebf18
.long 0x3f0e3f35,0xbe48bf6d,0xbe953f7f,0x3f22bf62,0xbf553f35,0x3f7bbec4,0xbf75bdc9,0x3f463ef1
.long 0xbf46bec4,0x3e953f55,0x3d49bf78,0xbf183f71,0x3f22bf6d,0xbf753f0e,0x3f80be79,0xbf4ebeac
.long 0x3f6da78d,0xbec4bf35,0x3e483f55,0x3f0ebf7b,0xbec43f80,0x3f6dbf35,0xbf7b3f0e,0x3f553e48
.long 0xbf7f3ec4,0x3ef13f0e,0xbedbbf18,0xbf043f80,0x3dc9bf6d,0xbf623f55,0x3f67bf4e,0xbf5cbd49
.long 0x3f7bbf35,0xbf0ebec4,0x3f223e95,0x3ef1bf7f,0x3e483f35,0x3f55bf6d,0xbf463f75,0x3f62bdc9
.long 0xbf623f6d,0x3f223e48,0xbf4e3d49,0xbedb3f78,0xbef1bec4,0xbf463f7b,0x3f18bf80,0xbf673e79
.long 0x258d3f80,0xa78dbf80,0xbf353f35,0x3f35bf35,0xbf80270d,0x3f8026d4,0xbf35bf35,0x3f353f35
.long 0x3dc9bf80,0xbe953f7b,0x3f4ebf2c,0xbf673f04,0x3f7f26d4,0xbf75be48,0x3f183f3e,0xbedbbf5c
.long 0xbe483f80,0x3f0ebf6d,0xbf623f22,0x3f7fbe95,0xbf7b271f,0x3f553ec4,0xbef1bf46,0x3dc93f75
.long 0x3e95bf80,0xbf463f55,0x3f71bf18,0xbf783d49,0x3f75a7d4,0xbf22bf0e,0x3eac3f4e,0x3e79bf80
.long 0xbec43f80,0x3f6dbf35,0xbf7b3f0e,0x3f553e48,0xbf6d2730,0x3ec43f35,0xbe48bf55,0xbf0e3f7b
.long 0x3ef1bf80,0xbf7f3f0e,0x3f80bf04,0xbf18bedb,0x3f62268d,0xbdc9bf55,0x3d493f5c,0x3f4ebf67
.long 0xbf0e3f80,0x3f7bbec4,0xbf7f3ef1,0x3e953f22,0xbf552831,0xbe483f6d,0x3dc9bf62,0xbf753f46
.long 0x3f22bf80,0xbf623e48,0x3f78bedb,0x3d49bf4e,0x3f46a7e5,0x3ef1bf7b,0xbe793f67,0x3f80bf18
.long 0x260d3f80,0xa796bf80,0xbf353f35,0x3f35bf35,0xbf80271f,0x3f80a7d4,0xbf35bf35,0x3f353f35
.long 0x3ef1bf6d,0xbf223f55,0x3f78beac,0xbf803e16,0x3f623ec4,0xbf46bf0e,0x3e793f71,0xbd49bf7d
.long 0xbf553f35,0x3f7bbec4,0xbf75bdc9,0x3f463ef1,0xbf0ebf35,0x3e483f6d,0x3e95bf7f,0xbf223f62
.long 0x3f7fbec4,0xbf62be48,0x3f2c3f04,0xbe16bf67,0x3dc93f6d,0x3ef1bf7b,0xbf3e3f5c,0x3f7dbedb
.long 0xbf6d268d,0x3ec43f35,0xbe48bf55,0xbf0e3f7b,0x3ec4bf80,0xbf6d3f35,0x3f7bbf0e,0xbf55be48
.long 0x3f223ec4,0x3e95bf7b,0xbeac3f7d,0x3f78bf2c,0xbf463f6d,0x3f75be48,0xbf713e16,0x3e793f3e
.long 0xbe48bf35,0xbf553f6d,0x3f46bf75,0xbf623dc9,0x3f7bbf35,0xbf0ebec4,0x3f223e95,0x3ef1bf7f
.long 0xbe953f6d,0x3f7fbf0e,0xbf7d3f3e,0x3eac3f04,0xbf753ec4,0xbdc93f55,0xbe16bf2c,0xbf713f5c
.long 0x280d3f80,0xa79fbf80,0xbf353f35,0x3f35bf35,0xbf802730,0x3f80268d,0xbf35bf35,0x3f353f35
.long 0x3f46bf35,0xbf623f0e,0x3f7d3d49,0xbf71be79,0x3f223f35,0xbef1bf55,0xbe163f80,0x3eacbf78
.long 0xbf7b268d,0x3f553ec4,0xbef1bf46,0x3dc93f75,0x3e48bf80,0xbf0e3f6d,0x3f62bf22,0xbf7f3e95
.long 0x3ef13f35,0x3dc9bf7b,0xbedb3f7d,0x3f5cbf3e,0xbf623f35,0x3f7fbe48,0xbf67be16,0x3f043f2c
.long 0x3ec4bf80,0xbf6d3f35,0x3f7bbf0e,0xbf55be48,0x3f6d260e,0xbec4bf35,0x3e483f55,0x3f0ebf7b
.long 0xbf753f35,0x3f463e48,0xbf3ebe79,0xbe163f71,0xbe95bf35,0xbf223f7b,0x3f2cbf78,0xbf7d3eac
.long 0x3f55a85d,0x3e48bf6d,0xbdc93f62,0x3f75bf46,0xbf0e3f80,0x3f7bbec4,0xbf7f3ef1,0x3e953f22
.long 0xbdc9bf35,0xbf753f55,0x3f5cbf71,0xbf2cbe16,0x3f7fbf35,0xbe95bf0e,0x3f043eac,0x3f3ebf7d
.long 0x268d3f80,0x2731bf80,0xbf353f35,0x3f35bf35,0xbf802831,0x3f80a7e5,0xbf35bf35,0x3f353f35
.long 0x3f75bec4,0xbf7f3e48,0x3f5c3edb,0xbf3ebf18,0x3e953f6d,0xbdc9bf7b,0xbf043f67,0x3f2cbf4e
.long 0xbf0ebf35,0x3e483f6d,0x3e95bf7f,0xbf223f62,0x3f55bf35,0xbf7b3ec4,0x3f753dc9,0xbf46bef1
.long 0xbf223f6d,0x3f75bf0e,0xbf803e79,0x3f4e3eac,0xbf46bec4,0x3e953f55,0x3d49bf78,0xbf183f71
.long 0x3f6d270d,0xbec4bf35,0x3e483f55,0x3f0ebf7b,0xbec43f80,0x3f6dbf35,0xbf7b3f0e,0x3f553e48
.long 0x3dc9bf6d,0xbf623f55,0x3f67bf4e,0xbf5cbd49,0x3f7fbec4,0xbef1bf0e,0x3edb3f18,0x3f04bf80
.long 0xbf7b3f35,0x3f0e3ec4,0xbf22be95,0xbef13f7f,0xbe48bf35,0xbf553f6d,0x3f46bf75,0xbf623dc9
.long 0x3ef13ec4,0x3f46bf7b,0xbf183f80,0x3f67be79,0xbf623f6d,0x3f223e48,0xbf4e3d49,0xbedb3f78
.long 0x28163f80,0xa7b1bf80,0xbf353f35,0x3f35bf35,0xbf802754,0x3f80260e,0xbf35bf35,0x3f353f35
.long 0x3f7f2828,0xbf75be48,0x3f183f3e,0xbedbbf5c,0xbdc93f80,0x3e95bf7b,0xbf4e3f2c,0x3f67bf04
.long 0x3e48bf80,0xbf0e3f6d,0x3f62bf22,0xbf7f3e95,0x3f7ba7f7,0xbf55bec4,0x3ef13f46,0xbdc9bf75
.long 0xbf75281f,0x3f223f0e,0xbeacbf4e,0xbe793f80,0x3e95bf80,0xbf463f55,0x3f71bf18,0xbf783d49
.long 0xbec43f80,0x3f6dbf35,0xbf7b3f0e,0x3f553e48,0xbf6d2842,0x3ec43f35,0xbe48bf55,0xbf0e3f7b
.long 0x3f6226d4,0xbdc9bf55,0x3d493f5c,0x3f4ebf67,0xbef13f80,0x3f7fbf0e,0xbf803f04,0x3f183edb
.long 0x3f0ebf80,0xbf7b3ec4,0x3f7fbef1,0xbe95bf22,0x3f55a884,0x3e48bf6d,0xbdc93f62,0x3f75bf46
.long 0xbf462730,0xbef13f7b,0x3e79bf67,0xbf803f18,0x3f22bf80,0xbf623e48,0x3f78bedb,0x3d49bf4e
.long 0x26d43f80,0x270dbf80,0xbf353f35,0x3f35bf35,0xbf80a78d,0x3f80a7f7,0xbf35bf35,0x3f353f35
.long 0x3f623ec4,0xbf46bf0e,0x3e793f71,0xbd49bf7d,0xbef13f6d,0x3f22bf55,0xbf783eac,0x3f80be16
.long 0x3f55bf35,0xbf7b3ec4,0x3f753dc9,0xbf46bef1,0x3f0e3f35,0xbe48bf6d,0xbe953f7f,0x3f22bf62
.long 0xbdc9bf6d,0xbef13f7b,0x3f3ebf5c,0xbf7d3edb,0x3f7fbec4,0xbf62be48,0x3f2c3f04,0xbe16bf67
.long 0xbf6d2828,0x3ec43f35,0xbe48bf55,0xbf0e3f7b,0x3ec4bf80,0xbf6d3f35,0x3f7bbf0e,0xbf55be48
.long 0xbf463f6d,0x3f75be48,0xbf713e16,0x3e793f3e,0xbf22bec4,0xbe953f7b,0x3eacbf7d,0xbf783f2c
.long 0x3e483f35,0x3f55bf6d,0xbf463f75,0x3f62bdc9,0xbf7b3f35,0x3f0e3ec4,0xbf22be95,0xbef13f7f
.long 0x3f75bec4,0x3dc9bf55,0x3e163f2c,0x3f71bf5c,0xbe953f6d,0x3f7fbf0e,0xbf7d3f3e,0x3eac3f04
.long 0x281f3f80,0xa7c2bf80,0xbf353f35,0x3f35bf35,0xbf802777,0x3f8021b7,0xbf35bf35,0x3f353f35
.long 0x3f223f35,0xbef1bf55,0xbe163f80,0x3eacbf78,0xbf463f35,0x3f62bf0e,0xbf7dbd49,0x3f713e79
.long 0x3f7b26d4,0xbf55bec4,0x3ef13f46,0xbdc9bf75,0xbe483f80,0x3f0ebf6d,0xbf623f22,0x3f7fbe95
.long 0x3f62bf35,0xbf7f3e48,0x3f673e16,0xbf04bf2c,0x3ef13f35,0x3dc9bf7b,0xbedb3f7d,0x3f5cbf3e
.long 0x3ec4bf80,0xbf6d3f35,0x3f7bbf0e,0xbf55be48,0x3f6da80d,0xbec4bf35,0x3e483f55,0x3f0ebf7b
.long 0xbe95bf35,0xbf223f7b,0x3f2cbf78,0xbf7d3eac,0x3f75bf35,0xbf46be48,0x3f3e3e79,0x3e16bf71
.long 0xbf55289a,0xbe483f6d,0x3dc9bf62,0xbf753f46,0x3f0ebf80,0xbf7b3ec4,0x3f7fbef1,0xbe95bf22
.long 0xbf7f3f35,0x3e953f0e,0xbf04beac,0xbf3e3f7d,0xbdc9bf35,0xbf753f55,0x3f5cbf71,0xbf2cbe16
.long 0x270d3f80,0x26d4bf80,0xbf353f35,0x3f35bf35,0xbf802842,0x3f80a804,0xbf35bf35,0x3f353f35
.long 0x3e953f6d,0xbdc9bf7b,0xbf043f67,0x3f2cbf4e,0xbf753ec4,0x3f7fbe48,0xbf5cbedb,0x3f3e3f18
.long 0x3f0e3f35,0xbe48bf6d,0xbe953f7f,0x3f22bf62,0xbf553f35,0x3f7bbec4,0xbf75bdc9,0x3f463ef1
.long 0x3f463ec4,0xbe95bf55,0xbd493f78,0x3f18bf71,0xbf223f6d,0x3f75bf0e,0xbf803e79,0x3f4e3eac
.long 0x3f6da7e5,0xbec4bf35,0x3e483f55,0x3f0ebf7b,0xbec43f80,0x3f6dbf35,0xbf7b3f0e,0x3f553e48
.long 0x3f7fbec4,0xbef1bf0e,0x3edb3f18,0x3f04bf80,0xbdc93f6d,0x3f62bf55,0xbf673f4e,0x3f5c3d49
.long 0x3f7bbf35,0xbf0ebec4,0x3f223e95,0x3ef1bf7f,0x3e483f35,0x3f55bf6d,0xbf463f75,0x3f62bdc9
.long 0x3f62bf6d,0xbf22be48,0x3f4ebd49,0x3edbbf78,0x3ef13ec4,0x3f46bf7b,0xbf183f80,0x3f67be79
.long 0xbf353f80,0x3f35a554,0xbf6d3ec4,0xbec43f6d,0xbf358000,0xbf353f80,0x3ec4bf6d,0xbf6d3ec4
.long 0xbf463f80,0x3ef13e48,0xbf5c3eac,0xbf2c3f7d,0xbf228000,0xbf623f7b,0x3f04bf71,0xbf3e3e16
.long 0xbf553f80,0x3e483ec4,0xbf463e95,0xbf623f7f,0xbf0e8000,0xbf7b3f6d,0x3f22bf75,0xbef1bdc9
.long 0xbf623f80,0xbdc93f0e,0xbf2c3e79,0xbf7d3f71,0xbef18000,0xbf7f3f55,0x3f3ebf78,0xbe16beac
.long 0xbf6d3f80,0xbec43f35,0xbf0e3e48,0xbf7b3f55,0xbec48000,0xbf6d3f35,0x3f55bf7b,0x3e48bf0e
.long 0xbf753f80,0xbf223f55,0xbedb3e16,0xbf5c3f2c,0xbe958000,0xbf463f0e,0x3f67bf7d,0x3f04bf3e
.long 0xbf7b3f80,0xbf553f6d,0xbe953dc9,0xbf223ef1,0xbe488000,0xbf0e3ec4,0x3f75bf7f,0x3f46bf62
.long 0xbf7f3f80,0xbf753f7b,0xbe163d49,0xbeac3e79,0xbdc98000,0xbe953e48,0x3f7dbf80,0x3f71bf78
.long 0x3f35bf80,0xbf35261f,0x3f6dbec4,0x3ec4bf6d,0x3f35a5d4,0x3f35bf80,0xbec43f6d,0x3f6dbec4
.long 0x3f75bf6d,0xbdc9bf0e,0x3f183d49,0x3f67bf78,0x3e953ec4,0x3f7fbf55,0xbf4e3f80,0x3edb3e79
.long 0x3f7bbf35,0x3f0ebf6d,0x3dc93ef1,0x3f75bf22,0xbe483f35,0x3f55bec4,0xbf7f3f62,0xbe953f46
.long 0x3f46bec4,0x3f75bf7b,0xbedb3f4e,0x3f04bd49,0xbf223f6d,0x3e953e48,0xbf673f18,0xbf5c3f80
.long 0x3ec4a5f7,0x3f6dbf35,0xbf553f7b,0xbe483f0e,0xbf6d3f80,0xbec43f35,0xbf0e3e48,0xbf7b3f55
.long 0xbdc93ec4,0x3ef1be48,0xbf803f78,0xbf4e3f71,0xbf7f3f6d,0xbf623f7b,0xbd49be79,0xbf183eac
.long 0xbf0e3f35,0xbe483ec4,0xbf623f46,0xbf7f3f75,0xbf553f35,0xbf7b3f6d,0x3ef1bf22,0x3dc9be95
.long 0xbf623f6d,0xbf463f55,0xbf043edb,0xbf2c3f18,0xbef13ec4,0xbf223f0e,0x3f5cbf67,0x3f3ebf4e
.long 0xbf353f80,0x3f35a742,0xbf6d3ec4,0xbec43f6d,0xbf352654,0xbf353f80,0x3ec4bf6d,0xbf6d3ec4
.long 0xbf7f3f35,0xbe953f55,0xbe79bedb,0xbf803f4e,0x3dc9bf35,0xbf753f0e,0x3f78bf67,0xbd49bf18
.long 0xbf0ea68d,0xbf7b3f6d,0x3f22bf75,0xbef1bdc9,0x3f55bf80,0xbe48bec4,0x3f46be95,0x3f62bf7f
.long 0x3e95bf35,0xbf223e48,0x3f80bf5c,0x3f18bf67,0x3f75bf35,0x3f46bf7b,0xbd493f04,0x3f4ebedb
.long 0x3f6dbf80,0x3ec4bf35,0x3f0ebe48,0x3f7bbf55,0x3ec4a677,0x3f6dbf35,0xbf553f7b,0xbe483f0e
.long 0x3f62bf35,0x3f7fbf7b,0xbeac3f18,0x3e793d49,0xbef13f35,0x3dc93e48,0xbf713f4e,0xbf783f80
.long 0x3e48a742,0x3f0ebec4,0xbf753f7f,0xbf463f62,0xbf7b3f80,0xbf553f6d,0xbe953dc9,0xbf223ef1
.long 0xbf223f35,0xbef13f0e,0xbf4e3f3e,0xbf673f5c,0xbf463f35,0xbf623f55,0x3f18bf2c,0x3edbbf04
.long 0x3f35bf80,0xbf35a60d,0x3f6dbec4,0x3ec4bf6d,0x3f35a69f,0x3f35bf80,0xbec43f6d,0x3f6dbec4
.long 0x3f62bec4,0x3f22bf7b,0xbe163f3e,0x3f71bf04,0xbef13f6d,0x3f46be48,0xbf7d3f2c,0xbeac3f5c
.long 0xbe483f35,0x3f55bec4,0xbf7f3f62,0xbe953f46,0xbf7b3f35,0xbf0e3f6d,0xbdc9bef1,0xbf753f22
.long 0xbf7f3f6d,0xbef13f55,0xbeacbe16,0xbf783f3e,0xbdc9bec4,0xbf623f0e,0x3f71bf7d,0x3e79bf2c
.long 0xbec4a60d,0xbf6d3f35,0x3f55bf7b,0x3e48bf0e,0x3f6dbf80,0x3ec4bf35,0x3f0ebe48,0x3f7bbf55
.long 0x3f46bf6d,0x3e95bf0e,0x3f3ebf04,0x3f7dbf67,0x3f22bec4,0x3f75bf55,0xbf2c3f5c,0xbe163edb
.long 0x3f55bf35,0x3f7bbf6d,0xbef13f22,0xbdc93e95,0xbf0e3f35,0xbe483ec4,0xbf623f46,0xbf7f3f75
.long 0xbe953ec4,0xbdc93e48,0xbf783f71,0xbf803f7d,0xbf753f6d,0xbf7f3f7b,0x3e79beac,0x3d49be16
.long 0xbf353f80,0x3f35a777,0xbf6d3ec4,0xbec43f6d,0xbf3526d4,0xbf353f80,0x3ec4bf6d,0xbf6d3ec4
.long 0xbf22a58e,0xbf623f7b,0x3f04bf71,0xbf3e3e16,0x3f46bf80,0xbef1be48,0x3f5cbeac,0x3f2cbf7d
.long 0x3f55bf80,0xbe48bec4,0x3f46be95,0x3f62bf7f,0x3f0e270d,0x3f7bbf6d,0xbf223f75,0x3ef13dc9
.long 0x3ef1a777,0x3f7fbf55,0xbf3e3f78,0x3e163eac,0xbf623f80,0xbdc93f0e,0xbf2c3e79,0xbf7d3f71
.long 0xbf6d3f80,0xbec43f35,0xbf0e3e48,0xbf7b3f55,0xbec426f7,0xbf6d3f35,0x3f55bf7b,0x3e48bf0e
.long 0xbe95a137,0xbf463f0e,0x3f67bf7d,0x3f04bf3e,0x3f75bf80,0x3f22bf55,0x3edbbe16,0x3f5cbf2c
.long 0x3f7bbf80,0x3f55bf6d,0x3e95bdc9,0x3f22bef1,0x3e48a7c2,0x3f0ebec4,0xbf753f7f,0xbf463f62
.long 0x3dc9a784,0x3e95be48,0xbf7d3f80,0xbf713f78,0xbf7f3f80,0xbf753f7b,0xbe163d49,0xbeac3e79
.long 0x3f35bf80,0xbf35258d,0x3f6dbec4,0x3ec4bf6d,0x3f35a7c2,0x3f35bf80,0xbec43f6d,0x3f6dbec4
.long 0x3e953ec4,0x3f7fbf55,0xbf4e3f80,0x3edb3e79,0xbf753f6d,0x3dc93f0e,0xbf18bd49,0xbf673f78
.long 0xbf7b3f35,0xbf0e3f6d,0xbdc9bef1,0xbf753f22,0x3e48bf35,0xbf553ec4,0x3f7fbf62,0x3e95bf46
.long 0x3f22bf6d,0xbe95be48,0x3f67bf18,0x3f5cbf80,0x3f46bec4,0x3f75bf7b,0xbedb3f4e,0x3f04bd49
.long 0x3ec4a78d,0x3f6dbf35,0xbf553f7b,0xbe483f0e,0xbf6d3f80,0xbec43f35,0xbf0e3e48,0xbf7b3f55
.long 0xbf7f3f6d,0xbf623f7b,0xbd49be79,0xbf183eac,0x3dc9bec4,0xbef13e48,0x3f80bf78,0x3f4ebf71
.long 0x3f0ebf35,0x3e48bec4,0x3f62bf46,0x3f7fbf75,0x3f55bf35,0x3f7bbf6d,0xbef13f22,0xbdc93e95
.long 0x3ef1bec4,0x3f22bf0e,0xbf5c3f67,0xbf3e3f4e,0xbf623f6d,0xbf463f55,0xbf043edb,0xbf2c3f18
.long 0xbf353f80,0x3f35a796,0xbf6d3ec4,0xbec43f6d,0xbf35271f,0xbf353f80,0x3ec4bf6d,0xbf6d3ec4
.long 0x3dc9bf35,0xbf753f0e,0x3f78bf67,0xbd49bf18,0x3f7fbf35,0x3e95bf55,0x3e793edb,0x3f80bf4e
.long 0x3f0e2754,0x3f7bbf6d,0xbf223f75,0x3ef13dc9,0xbf553f80,0x3e483ec4,0xbf463e95,0xbf623f7f
.long 0xbf753f35,0xbf463f7b,0x3d49bf04,0xbf4e3edb,0x3e95bf35,0xbf223e48,0x3f80bf5c,0x3f18bf67
.long 0x3f6dbf80,0x3ec4bf35,0x3f0ebe48,0x3f7bbf55,0x3ec4268d,0x3f6dbf35,0xbf553f7b,0xbe483f0e
.long 0xbef13f35,0x3dc93e48,0xbf713f4e,0xbf783f80,0xbf623f35,0xbf7f3f7b,0x3eacbf18,0xbe79bd49
.long 0xbe482889,0xbf0e3ec4,0x3f75bf7f,0x3f46bf62,0x3f7bbf80,0x3f55bf6d,0x3e95bdc9,0x3f22bef1
.long 0x3f46bf35,0x3f62bf55,0xbf183f2c,0xbedb3f04,0xbf223f35,0xbef13f0e,0xbf4e3f3e,0xbf673f5c
.long 0x3f35bf80,0xbf35268d,0x3f6dbec4,0x3ec4bf6d,0x3f35268d,0x3f35bf80,0xbec43f6d,0x3f6dbec4
.long 0xbef13f6d,0x3f46be48,0xbf7d3f2c,0xbeac3f5c,0xbf623ec4,0xbf223f7b,0x3e16bf3e,0xbf713f04
.long 0x3e48bf35,0xbf553ec4,0x3f7fbf62,0x3e95bf46,0x3f7bbf35,0x3f0ebf6d,0x3dc93ef1,0x3f75bf22
.long 0x3dc93ec4,0x3f62bf0e,0xbf713f7d,0xbe793f2c,0xbf7f3f6d,0xbef13f55,0xbeacbe16,0xbf783f3e
.long 0xbec42816,0xbf6d3f35,0x3f55bf7b,0x3e48bf0e,0x3f6dbf80,0x3ec4bf35,0x3f0ebe48,0x3f7bbf55
.long 0x3f22bec4,0x3f75bf55,0xbf2c3f5c,0xbe163edb,0xbf463f6d,0xbe953f0e,0xbf3e3f04,0xbf7d3f67
.long 0xbf553f35,0xbf7b3f6d,0x3ef1bf22,0x3dc9be95,0x3f0ebf35,0x3e48bec4,0x3f62bf46,0x3f7fbf75
.long 0x3f75bf6d,0x3f7fbf7b,0xbe793eac,0xbd493e16,0xbe953ec4,0xbdc93e48,0xbf783f71,0xbf803f7d
.long 0xbf353f80,0x3f35a7b1,0xbf6d3ec4,0xbec43f6d,0xbf352754,0xbf353f80,0x3ec4bf6d,0xbf6d3ec4
.long 0x3f46bf80,0xbef1be48,0x3f5cbeac,0x3f2cbf7d,0x3f22260e,0x3f62bf7b,0xbf043f71,0x3f3ebe16
.long 0xbf553f80,0x3e483ec4,0xbf463e95,0xbf623f7f,0xbf0ea78d,0xbf7b3f6d,0x3f22bf75,0xbef1bdc9
.long 0x3f62bf80,0x3dc9bf0e,0x3f2cbe79,0x3f7dbf71,0x3ef1a7f7,0x3f7fbf55,0xbf3e3f78,0x3e163eac
.long 0xbf6d3f80,0xbec43f35,0xbf0e3e48,0xbf7b3f55,0xbec42777,0xbf6d3f35,0x3f55bf7b,0x3e48bf0e
.long 0x3f75bf80,0x3f22bf55,0x3edbbe16,0x3f5cbf2c,0x3e9521b7,0x3f46bf0e,0xbf673f7d,0xbf043f3e
.long 0xbf7b3f80,0xbf553f6d,0xbe953dc9,0xbf223ef1,0xbe482842,0xbf0e3ec4,0x3f75bf7f,0x3f46bf62
.long 0x3f7fbf80,0x3f75bf7b,0x3e16bd49,0x3eacbe79,0x3dc9a804,0x3e95be48,0xbf7d3f80,0xbf713f78
.long 0x3f35bf80,0xbf35281f,0x3f6dbec4,0x3ec4bf6d,0x3f35a7f7,0x3f35bf80,0xbec43f6d,0x3f6dbec4
.long 0xbf753f6d,0x3dc93f0e,0xbf18bd49,0xbf673f78,0xbe95bec4,0xbf7f3f55,0x3f4ebf80,0xbedbbe79
.long 0x3f7bbf35,0x3f0ebf6d,0x3dc93ef1,0x3f75bf22,0xbe483f35,0x3f55bec4,0xbf7f3f62,0xbe953f46
.long 0xbf463ec4,0xbf753f7b,0x3edbbf4e,0xbf043d49,0x3f22bf6d,0xbe95be48,0x3f67bf18,0x3f5cbf80
.long 0x3ec426d4,0x3f6dbf35,0xbf553f7b,0xbe483f0e,0xbf6d3f80,0xbec43f35,0xbf0e3e48,0xbf7b3f55
.long 0x3dc9bec4,0xbef13e48,0x3f80bf78,0x3f4ebf71,0x3f7fbf6d,0x3f62bf7b,0x3d493e79,0x3f18beac
.long 0xbf0e3f35,0xbe483ec4,0xbf623f46,0xbf7f3f75,0xbf553f35,0xbf7b3f6d,0x3ef1bf22,0x3dc9be95
.long 0x3f62bf6d,0x3f46bf55,0x3f04bedb,0x3f2cbf18,0x3ef1bec4,0x3f22bf0e,0xbf5c3f67,0xbf3e3f4e
.long 0xbf353f80,0x3f3526d4,0xbf6d3ec4,0xbec43f6d,0xbf352842,0xbf353f80,0x3ec4bf6d,0xbf6d3ec4
.long 0x3f7fbf35,0x3e95bf55,0x3e793edb,0x3f80bf4e,0xbdc93f35,0x3f75bf0e,0xbf783f67,0x3d493f18
.long 0xbf0ea7b1,0xbf7b3f6d,0x3f22bf75,0xbef1bdc9,0x3f55bf80,0xbe48bec4,0x3f46be95,0x3f62bf7f
.long 0xbe953f35,0x3f22be48,0xbf803f5c,0xbf183f67,0xbf753f35,0xbf463f7b,0x3d49bf04,0xbf4e3edb
.long 0x3f6dbf80,0x3ec4bf35,0x3f0ebe48,0x3f7bbf55,0x3ec4a80d,0x3f6dbf35,0xbf553f7b,0xbe483f0e
.long 0xbf623f35,0xbf7f3f7b,0x3eacbf18,0xbe79bd49,0x3ef1bf35,0xbdc9be48,0x3f71bf4e,0x3f78bf80
.long 0x3e48a7e5,0x3f0ebec4,0xbf753f7f,0xbf463f62,0xbf7b3f80,0xbf553f6d,0xbe953dc9,0xbf223ef1
.long 0x3f22bf35,0x3ef1bf0e,0x3f4ebf3e,0x3f67bf5c,0x3f46bf35,0x3f62bf55,0xbf183f2c,0xbedb3f04
.long 0x3f35bf80,0xbf352730,0x3f6dbec4,0x3ec4bf6d,0x3f35a60d,0x3f35bf80,0xbec43f6d,0x3f6dbec4
.long 0xbf623ec4,0xbf223f7b,0x3e16bf3e,0xbf713f04,0x3ef1bf6d,0xbf463e48,0x3f7dbf2c,0x3eacbf5c
.long 0xbe483f35,0x3f55bec4,0xbf7f3f62,0xbe953f46,0xbf7b3f35,0xbf0e3f6d,0xbdc9bef1,0xbf753f22
.long 0x3f7fbf6d,0x3ef1bf55,0x3eac3e16,0x3f78bf3e,0x3dc93ec4,0x3f62bf0e,0xbf713f7d,0xbe793f2c
.long 0xbec42754,0xbf6d3f35,0x3f55bf7b,0x3e48bf0e,0x3f6dbf80,0x3ec4bf35,0x3f0ebe48,0x3f7bbf55
.long 0xbf463f6d,0xbe953f0e,0xbf3e3f04,0xbf7d3f67,0xbf223ec4,0xbf753f55,0x3f2cbf5c,0x3e16bedb
.long 0x3f55bf35,0x3f7bbf6d,0xbef13f22,0xbdc93e95,0xbf0e3f35,0xbe483ec4,0xbf623f46,0xbf7f3f75
.long 0x3e95bec4,0x3dc9be48,0x3f78bf71,0x3f80bf7d,0x3f75bf6d,0x3f7fbf7b,0xbe793eac,0xbd493e16
.long 0xbf353f80,0x3f35a7e5,0xbf6d3ec4,0xbec43f6d,0xbf35279f,0xbf353f80,0x3ec4bf6d,0xbf6d3ec4
.long 0x3f22a7e5,0x3f62bf7b,0xbf043f71,0x3f3ebe16,0xbf463f80,0x3ef13e48,0xbf5c3eac,0xbf2c3f7d
.long 0x3f55bf80,0xbe48bec4,0x3f46be95,0x3f62bf7f,0x3f0e27d4,0x3f7bbf6d,0xbf223f75,0x3ef13dc9
.long 0xbef12839,0xbf7f3f55,0x3f3ebf78,0xbe16beac,0x3f62bf80,0x3dc9bf0e,0x3f2cbe79,0x3f7dbf71
.long 0xbf6d3f80,0xbec43f35,0xbf0e3e48,0xbf7b3f55,0xbec4a70d,0xbf6d3f35,0x3f55bf7b,0x3e48bf0e
.long 0x3e95a880,0x3f46bf0e,0xbf673f7d,0xbf043f3e,0xbf753f80,0xbf223f55,0xbedb3e16,0xbf5c3f2c
.long 0x3f7bbf80,0x3f55bf6d,0x3e95bdc9,0x3f22bef1,0x3e48a909,0x3f0ebec4,0xbf753f7f,0xbf463f62
.long 0xbdc928a3,0xbe953e48,0x3f7dbf80,0x3f71bf78,0x3f7fbf80,0x3f75bf7b,0x3e16bd49,0x3eacbe79
.long 0x3f35bf80,0xbf352839,0x3f6dbec4,0x3ec4bf6d,0x3f35a816,0x3f35bf80,0xbec43f6d,0x3f6dbec4
.long 0xbe95bec4,0xbf7f3f55,0x3f4ebf80,0xbedbbe79,0x3f75bf6d,0xbdc9bf0e,0x3f183d49,0x3f67bf78
.long 0xbf7b3f35,0xbf0e3f6d,0xbdc9bef1,0xbf753f22,0x3e48bf35,0xbf553ec4,0x3f7fbf62,0x3e95bf46
.long 0xbf223f6d,0x3e953e48,0xbf673f18,0xbf5c3f80,0xbf463ec4,0xbf753f7b,0x3edbbf4e,0xbf043d49
.long 0x3ec4a804,0x3f6dbf35,0xbf553f7b,0xbe483f0e,0xbf6d3f80,0xbec43f35,0xbf0e3e48,0xbf7b3f55
.long 0x3f7fbf6d,0x3f62bf7b,0x3d493e79,0x3f18beac,0xbdc93ec4,0x3ef1be48,0xbf803f78,0xbf4e3f71
.long 0x3f0ebf35,0x3e48bec4,0x3f62bf46,0x3f7fbf75,0x3f55bf35,0x3f7bbf6d,0xbef13f22,0xbdc93e95
.long 0xbef13ec4,0xbf223f0e,0x3f5cbf67,0x3f3ebf4e,0x3f62bf6d,0x3f46bf55,0x3f04bedb,0x3f2cbf18
.long 0xbf353f80,0x3f35a880,0xbf6d3ec4,0xbec43f6d,0xbf35a70d,0xbf353f80,0x3ec4bf6d,0xbf6d3ec4
.long 0xbdc93f35,0x3f75bf0e,0xbf783f67,0x3d493f18,0xbf7f3f35,0xbe953f55,0xbe79bedb,0xbf803f4e
.long 0x3f0e28be,0x3f7bbf6d,0xbf223f75,0x3ef13dc9,0xbf553f80,0x3e483ec4,0xbf463e95,0xbf623f7f
.long 0x3f75bf35,0x3f46bf7b,0xbd493f04,0x3f4ebedb,0xbe953f35,0x3f22be48,0xbf803f5c,0xbf183f67
.long 0x3f6dbf80,0x3ec4bf35,0x3f0ebe48,0x3f7bbf55,0x3ec4a896,0x3f6dbf35,0xbf553f7b,0xbe483f0e
.long 0x3ef1bf35,0xbdc9be48,0x3f71bf4e,0x3f78bf80,0x3f62bf35,0x3f7fbf7b,0xbeac3f18,0x3e793d49
.long 0xbe4828ea,0xbf0e3ec4,0x3f75bf7f,0x3f46bf62,0x3f7bbf80,0x3f55bf6d,0x3e95bdc9,0x3f22bef1
.long 0xbf463f35,0xbf623f55,0x3f18bf2c,0x3edbbf04,0x3f22bf35,0x3ef1bf0e,0x3f4ebf3e,0x3f67bf5c
.long 0x3f35bf80,0xbf3528a3,0x3f6dbec4,0x3ec4bf6d,0x3f35a70d,0x3f35bf80,0xbec43f6d,0x3f6dbec4
.long 0x3ef1bf6d,0xbf463e48,0x3f7dbf2c,0x3eacbf5c,0x3f62bec4,0x3f22bf7b,0xbe163f3e,0x3f71bf04
.long 0x3e48bf35,0xbf553ec4,0x3f7fbf62,0x3e95bf46,0x3f7bbf35,0x3f0ebf6d,0x3dc93ef1,0x3f75bf22
.long 0xbdc9bec4,0xbf623f0e,0x3f71bf7d,0x3e79bf2c,0x3f7fbf6d,0x3ef1bf55,0x3eac3e16,0x3f78bf3e
.long 0xbec4a731,0xbf6d3f35,0x3f55bf7b,0x3e48bf0e,0x3f6dbf80,0x3ec4bf35,0x3f0ebe48,0x3f7bbf55
.long 0xbf223ec4,0xbf753f55,0x3f2cbf5c,0x3e16bedb,0x3f46bf6d,0x3e95bf0e,0x3f3ebf04,0x3f7dbf67
.long 0xbf553f35,0xbf7b3f6d,0x3ef1bf22,0x3dc9be95,0x3f0ebf35,0x3e48bec4,0x3f62bf46,0x3f7fbf75
.long 0xbf753f6d,0xbf7f3f7b,0x3e79beac,0x3d49be16,0x3e95bec4,0x3dc9be48,0x3f78bf71,0x3f80bf7d
.long 0x0,0x40,0x3200,0x3200,0x8,0x48,0x3250,0x3210
.long 0x10,0x40,0x32a0,0x3220,0x18,0x48,0x32f0,0x3230
.long 0xa0,0xe0,0x3340,0x3240,0xa8,0xe8,0x3390,0x3250
.long 0xb0,0xe0,0x33e0,0x3260,0xb8,0xe8,0x3430,0x3270
.long 0x140,0x180,0x3480,0x3280,0x148,0x188,0x34d0,0x3290
.long 0x150,0x180,0x3520,0x32a0,0x158,0x188,0x3570,0x32b0
.long 0x1e0,0x220,0x35c0,0x32c0,0x1e8,0x228,0x3610,0x32d0
.long 0x1f0,0x220,0x3660,0x32e0,0x1f8,0x228,0x36b0,0x32f0
.long 0x280,0x2c0,0x3208,0x3300,0x288,0x2c8,0x3258,0x3310
.long 0x290,0x2c0,0x32a8,0x3320,0x298,0x2c8,0x32f8,0x3330
.long 0x320,0x360,0x3348,0x3340,0x328,0x368,0x3398,0x3350
.long 0x330,0x360,0x33e8,0x3360,0x338,0x368,0x3438,0x3370
.long 0x3c0,0x400,0x3488,0x3380,0x3c8,0x408,0x34d8,0x3390
.long 0x3d0,0x400,0x3528,0x33a0,0x3d8,0x408,0x3578,0x33b0
.long 0x460,0x4a0,0x35c8,0x33c0,0x468,0x4a8,0x3618,0x33d0
.long 0x470,0x4a0,0x3668,0x33e0,0x478,0x4a8,0x36b8,0x33f0
.long 0x500,0x540,0x3210,0x3400,0x508,0x548,0x3260,0x3410
.long 0x510,0x540,0x32b0,0x3420,0x518,0x548,0x3300,0x3430
.long 0x5a0,0x5e0,0x3350,0x3440,0x5a8,0x5e8,0x33a0,0x3450
.long 0x5b0,0x5e0,0x33f0,0x3460,0x5b8,0x5e8,0x3440,0x3470
.long 0x640,0x680,0x3490,0x3480,0x648,0x688,0x34e0,0x3490
.long 0x650,0x680,0x3530,0x34a0,0x658,0x688,0x3580,0x34b0
.long 0x6e0,0x720,0x35d0,0x34c0,0x6e8,0x728,0x3620,0x34d0
.long 0x6f0,0x720,0x3670,0x34e0,0x6f8,0x728,0x36c0,0x34f0
.long 0x780,0x7c0,0x3218,0x3500,0x788,0x7c8,0x3268,0x3510
.long 0x790,0x7c0,0x32b8,0x3520,0x798,0x7c8,0x3308,0x3530
.long 0x820,0x860,0x3358,0x3540,0x828,0x868,0x33a8,0x3550
.long 0x830,0x860,0x33f8,0x3560,0x838,0x868,0x3448,0x3570
.long 0x8c0,0x900,0x3498,0x3580,0x8c8,0x908,0x34e8,0x3590
.long 0x8d0,0x900,0x3538,0x35a0,0x8d8,0x908,0x3588,0x35b0
.long 0x960,0x9a0,0x35d8,0x35c0,0x968,0x9a8,0x3628,0x35d0
.long 0x970,0x9a0,0x3678,0x35e0,0x978,0x9a8,0x36c8,0x35f0
.long 0x3c040,0x140000,0x23f010,0x800,0x41000,0x140010,0x23f020,0x820
.long 0x41010,0x140020,0x23f030,0x840,0x41020,0x140030,0x23f040,0x860
.long 0x41030,0x140040,0x244000,0x880,0x41040,0x145000,0x244010,0x8a0
.long 0x46000,0x145010,0x244020,0x8c0,0x46010,0x145020,0x244030,0x8e0
.long 0x46020,0x145030,0x244040,0x900,0x46030,0x145040,0x249000,0x920
.long 0x46040,0x14a000,0x249010,0x940,0x4b000,0x14a010,0x249020,0x960
.long 0x4b010,0x14a020,0x249030,0x980,0x4b020,0x14a030,0x249040,0x9a0
.long 0x4b030,0x14a040,0x24e000,0x9c0,0x4b040,0x14f000,0x24e010,0x9e0
.long 0x50000,0x14f010,0x24e020,0xa00,0x50010,0x14f020,0x24e030,0xa20
.long 0x50020,0x14f030,0x24e040,0xa40,0x50030,0x14f040,0x253000,0xa60
.long 0x50040,0x154000,0x253010,0xa80,0x55000,0x154010,0x253020,0xaa0
.long 0x55010,0x154020,0x253030,0xac0,0x55020,0x154030,0x253040,0xae0
.long 0x55030,0x154040,0x258000,0xb00,0x55040,0x159000,0x258010,0xb20
.long 0x5a000,0x159010,0x258020,0xb40,0x5a010,0x159020,0x258030,0xb60
.long 0x5a020,0x159030,0x258040,0xb80,0x5a030,0x159040,0x25d000,0xba0
.long 0x5a040,0x15e000,0x25d010,0xbc0,0x5f000,0x15e010,0x25d020,0xbe0
.long 0x5f010,0x15e020,0x25d030,0xc00,0x5f020,0x15e030,0x25d040,0xc20
.long 0x5f030,0x15e040,0x262000,0xc40,0x5f040,0x163000,0x262010,0xc60
.long 0x64000,0x163010,0x262020,0xc80,0x64010,0x163020,0x262030,0xca0
.long 0x64020,0x163030,0x262040,0xcc0,0x64030,0x163040,0x267000,0xce0
.long 0x64040,0x168000,0x267010,0xd00,0x69000,0x168010,0x267020,0xd20
.long 0x69010,0x168020,0x267030,0xd40,0x69020,0x168030,0x267040,0xd60
.long 0x69030,0x168040,0x26c000,0xd80,0x69040,0x16d000,0x26c010,0xda0
.long 0x6e000,0x16d010,0x26c020,0xdc0,0x6e010,0x16d020,0x26c030,0xde0
.long 0x6e020,0x16d030,0x26c040,0xe00,0x6e030,0x16d040,0x271000,0xe20
.long 0x6e040,0x172000,0x271010,0xe40,0x73000,0x172010,0x271020,0xe60
.long 0x73010,0x172020,0x271030,0xe80,0x73020,0x172030,0x271040,0xea0
.long 0x73030,0x172040,0x276000,0xec0,0x73040,0x177000,0x276010,0xee0
.long 0x78000,0x177010,0x276020,0xf00,0x78010,0x177020,0x276030,0xf20
.long 0x78020,0x177030,0x276040,0xf40,0x78030,0x177040,0x27b000,0xf60
.long 0x78040,0x17c000,0x27b010,0xf80,0x7d000,0x17c010,0x27b020,0xfa0
.long 0x7d010,0x17c020,0x27b030,0xfc0,0x7d020,0x17c030,0x27b040,0xfe0
.long 0xf40,0xa000,0x12c60,0x1a920,0xf50,0xa010,0x12c70,0x1a930
.long 0xf60,0xa020,0x12c80,0x1a940,0xf70,0xa030,0x12c90,0x1a950
.long 0xf80,0xa040,0x11d00,0x1a960,0xf90,0xa050,0x11d10,0x1a970
.long 0x2300,0xa060,0x11d20,0x1a980,0x2310,0xa070,0x11d30,0x1a990
.long 0x2320,0xa080,0x11d40,0x19a00,0x2330,0xa090,0x11d50,0x19a10
.long 0x2340,0xb400,0x11d60,0x19a20,0x2350,0xb410,0x11d70,0x19a30
.long 0x2360,0xb420,0x11d80,0x19a40,0x2370,0xb430,0x11d90,0x19a50
.long 0x2380,0xb440,0x13100,0x19a60,0x2390,0xb450,0x13110,0x19a70
.long 0x2800,0xb460,0x13120,0x19a80,0x2810,0xb470,0x13130,0x19a90
.long 0x2820,0xb480,0x13140,0x1ae00,0x2830,0xb490,0x13150,0x1ae10
.long 0x2840,0xa500,0x13160,0x1ae20,0x2850,0xa510,0x13170,0x1ae30
.long 0x2860,0xa520,0x13180,0x1ae40,0x2870,0xa530,0x13190,0x1ae50
.long 0x2880,0xa540,0x12200,0x1ae60,0x2890,0xa550,0x12210,0x1ae70
.long 0x3c00,0xa560,0x12220,0x1ae80,0x3c10,0xa570,0x12230,0x1ae90
.long 0x3c20,0xa580,0x12240,0x19f00,0x3c30,0xa590,0x12250,0x19f10
.long 0x3c40,0xb900,0x12260,0x19f20,0x3c50,0xb910,0x12270,0x19f30
.long 0x3c60,0xb920,0x12280,0x19f40,0x3c70,0xb930,0x12290,0x19f50
.long 0x3c80,0xb940,0x13600,0x19f60,0x3c90,0xb950,0x13610,0x19f70
.long 0x2d00,0xb960,0x13620,0x19f80,0x2d10,0xb970,0x13630,0x19f90
.long 0x2d20,0xb980,0x13640,0x1b300,0x2d30,0xb990,0x13650,0x1b310
.long 0x2d40,0xaa00,0x13660,0x1b320,0x2d50,0xaa10,0x13670,0x1b330
.long 0x2d60,0xaa20,0x13680,0x1b340,0x2d70,0xaa30,0x13690,0x1b350
.long 0x2d80,0xaa40,0x12700,0x1b360,0x2d90,0xaa50,0x12710,0x1b370
.long 0x4100,0xaa60,0x12720,0x1b380,0x4110,0xaa70,0x12730,0x1b390
.long 0x4120,0xaa80,0x12740,0x1b800,0x4130,0xaa90,0x12750,0x1b810
.long 0x4140,0xbe00,0x12760,0x1b820,0x4150,0xbe10,0x12770,0x1b830
.long 0x4160,0xbe20,0x12780,0x1b840,0x4170,0xbe30,0x12790,0x1b850
.long 0x4180,0xbe40,0x13b00,0x1b860,0x4190,0xbe50,0x13b10,0x1b870
.long 0x3200,0xbe60,0x13b20,0x1b880,0x3210,0xbe70,0x13b30,0x1b890
.long 0x3220,0xbe80,0x13b40,0x1cc00,0x3230,0xbe90,0x13b50,0x1cc10
.long 0x3240,0xaf00,0x13b60,0x1cc20,0x3250,0xaf10,0x13b70,0x1cc30
.long 0x3260,0xaf20,0x13b80,0x1cc40,0x3270,0xaf30,0x13b90,0x1cc50
.long 0x21280,0xf040,0x50000,0x8e860,0x21290,0xf050,0x50010,0x8e870
.long 0x22600,0xf060,0x50020,0x8e880,0x22610,0xf070,0x50030,0x8e890
.long 0x22620,0xf080,0x50040,0x91000,0x22630,0xf090,0x50050,0x91010
.long 0x22640,0x11800,0x50060,0x91020,0x22650,0x11810,0x50070,0x91030
.long 0x22660,0x11820,0x50080,0x91040,0x22670,0x11830,0x50090,0x91050
.long 0x22680,0x11840,0x52800,0x91060,0x22690,0x11850,0x52810,0x91070
.long 0x21700,0x11860,0x52820,0x91080,0x21710,0x11870,0x52830,0x91090
.long 0x21720,0x11880,0x52840,0x93800,0x21730,0x11890,0x52850,0x93810
.long 0x21740,0x14000,0x52860,0x93820,0x21750,0x14010,0x52870,0x93830
.long 0x21760,0x14020,0x52880,0x93840,0x21770,0x14030,0x52890,0x93850
.long 0x21780,0x14040,0x55000,0x93860,0x21790,0x14050,0x55010,0x93870
.long 0x22b00,0x14060,0x55020,0x93880,0x22b10,0x14070,0x55030,0x93890
.long 0x22b20,0x14080,0x55040,0x96000,0x22b30,0x14090,0x55050,0x96010
.long 0x22b40,0x16800,0x55060,0x96020,0x22b50,0x16810,0x55070,0x96030
.long 0x22b60,0x16820,0x55080,0x96040,0x22b70,0x16830,0x55090,0x96050
.long 0x22b80,0x16840,0x57800,0x96060,0x22b90,0x16850,0x57810,0x96070
.long 0x23000,0x16860,0x57820,0x96080,0x23010,0x16870,0x57830,0x96090
.long 0x23020,0x16880,0x57840,0x98800,0x23030,0x16890,0x57850,0x98810
.long 0x23040,0x19000,0x57860,0x98820,0x23050,0x19010,0x57870,0x98830
.long 0x23060,0x19020,0x57880,0x98840,0x23070,0x19030,0x57890,0x98850
.long 0x23080,0x19040,0x5a000,0x98860,0x23090,0x19050,0x5a010,0x98870
.long 0x24400,0x19060,0x5a020,0x98880,0x24410,0x19070,0x5a030,0x98890
.long 0x24420,0x19080,0x5a040,0x9b000,0x24430,0x19090,0x5a050,0x9b010
.long 0x24440,0x1b800,0x5a060,0x9b020,0x24450,0x1b810,0x5a070,0x9b030
.long 0x24460,0x1b820,0x5a080,0x9b040,0x24470,0x1b830,0x5a090,0x9b050
.long 0x24480,0x1b840,0x5c800,0x9b060,0x24490,0x1b850,0x5c810,0x9b070
.long 0x23500,0x1b860,0x5c820,0x9b080,0x23510,0x1b870,0x5c830,0x9b090
.long 0x23520,0x1b880,0x5c840,0x9d800,0x23530,0x1b890,0x5c850,0x9d810
.long 0x23540,0x1e000,0x5c860,0x9d820,0x23550,0x1e010,0x5c870,0x9d830
.long 0x23560,0x1e020,0x5c880,0x9d840,0x23570,0x1e030,0x5c890,0x9d850
.long 0x23580,0x1e040,0x5f000,0x9d860,0x23590,0x1e050,0x5f010,0x9d870
.long 0x24900,0x1e060,0x5f020,0x9d880,0x24910,0x1e070,0x5f030,0x9d890
.long 0xcf820,0x10e080,0x2800,0x2800,0xcf830,0x10e090,0x2808,0x2808
.long 0xcf840,0x110800,0x2810,0x31c0,0xcf850,0x110810,0x2818,0x31c8
.long 0xcf860,0x110820,0x2940,0x2940,0xcf870,0x110830,0x2948,0x2948
.long 0xcf880,0x110840,0x2950,0x3300,0xcf890,0x110850,0x2958,0x3308
.long 0xd2000,0x110860,0x2a80,0x2a80,0xd2010,0x110870,0x2a88,0x2a88
.long 0xd2020,0x110880,0x2a90,0x3440,0xd2030,0x110890,0x2a98,0x3448
.long 0xd2040,0x113000,0x2bc0,0x2bc0,0xd2050,0x113010,0x2bc8,0x2bc8
.long 0xd2060,0x113020,0x2bd0,0x3580,0xd2070,0x113030,0x2bd8,0x3588
.long 0xd2080,0x113040,0x28a0,0x28a0,0xd2090,0x113050,0x28a8,0x28a8
.long 0xd4800,0x113060,0x28b0,0x3260,0xd4810,0x113070,0x28b8,0x3268
.long 0xd4820,0x113080,0x29e0,0x29e0,0xd4830,0x113090,0x29e8,0x29e8
.long 0xd4840,0x115800,0x29f0,0x33a0,0xd4850,0x115810,0x29f8,0x33a8
.long 0xd4860,0x115820,0x2b20,0x2b20,0xd4870,0x115830,0x2b28,0x2b28
.long 0xd4880,0x115840,0x2b30,0x34e0,0xd4890,0x115850,0x2b38,0x34e8
.long 0xd7000,0x115860,0x2c60,0x2c60,0xd7010,0x115870,0x2c68,0x2c68
.long 0xd7020,0x115880,0x2c70,0x3620,0xd7030,0x115890,0x2c78,0x3628
.long 0xd7040,0x118000,0x2850,0x2850,0xd7050,0x118010,0x2858,0x2858
.long 0xd7060,0x118020,0x2860,0x3210,0xd7070,0x118030,0x2868,0x3218
.long 0xd7080,0x118040,0x2990,0x2990,0xd7090,0x118050,0x2998,0x2998
.long 0xd9800,0x118060,0x29a0,0x3350,0xd9810,0x118070,0x29a8,0x3358
.long 0xd9820,0x118080,0x2ad0,0x2ad0,0xd9830,0x118090,0x2ad8,0x2ad8
.long 0xd9840,0x11a800,0x2ae0,0x3490,0xd9850,0x11a810,0x2ae8,0x3498
.long 0xd9860,0x11a820,0x2c10,0x2c10,0xd9870,0x11a830,0x2c18,0x2c18
.long 0xd9880,0x11a840,0x2c20,0x35d0,0xd9890,0x11a850,0x2c28,0x35d8
.long 0xdc000,0x11a860,0x28f0,0x28f0,0xdc010,0x11a870,0x28f8,0x28f8
.long 0xdc020,0x11a880,0x2900,0x32b0,0xdc030,0x11a890,0x2908,0x32b8
.long 0xdc040,0x11d000,0x2a30,0x2a30,0xdc050,0x11d010,0x2a38,0x2a38
.long 0xdc060,0x11d020,0x2a40,0x33f0,0xdc070,0x11d030,0x2a48,0x33f8
.long 0xdc080,0x11d040,0x2b70,0x2b70,0xdc090,0x11d050,0x2b78,0x2b78
.long 0xde800,0x11d060,0x2b80,0x3530,0xde810,0x11d070,0x2b88,0x3538
.long 0xde820,0x11d080,0x2cb0,0x2cb0,0xde830,0x11d090,0x2cb8,0x2cb8
.long 0xde840,0x11f800,0x2cc0,0x3670,0xde850,0x11f810,0x2cc8,0x3678
.long 0x6480,0x6980,0x6e80,0xa080,0x6488,0x6988,0x6e88,0xa088
.long 0x6490,0x6990,0x6e90,0xa090,0x6498,0x6998,0x6e98,0xa098
.long 0x65c0,0x6ac0,0x6fc0,0xa1c0,0x65c8,0x6ac8,0x6fc8,0xa1c8
.long 0x65d0,0x6ad0,0x6fd0,0xa1d0,0x65d8,0x6ad8,0x6fd8,0xa1d8
.long 0x6700,0x6c00,0x7100,0xa300,0x6708,0x6c08,0x7108,0xa308
.long 0x6710,0x6c10,0x7110,0xa310,0x6718,0x6c18,0x7118,0xa318
.long 0x6840,0x6d40,0x7240,0xa440,0x6848,0x6d48,0x7248,0xa448
.long 0x6850,0x6d50,0x7250,0xa450,0x6858,0x6d58,0x7258,0xa458
.long 0x6520,0x6a20,0x7920,0xab20,0x6528,0x6a28,0x7928,0xab28
.long 0x6530,0x6a30,0x7930,0xab30,0x6538,0x6a38,0x7938,0xab38
.long 0x6660,0x6b60,0x7a60,0xac60,0x6668,0x6b68,0x7a68,0xac68
.long 0x6670,0x6b70,0x7a70,0xac70,0x6678,0x6b78,0x7a78,0xac78
.long 0x67a0,0x6ca0,0x7ba0,0xada0,0x67a8,0x6ca8,0x7ba8,0xada8
.long 0x67b0,0x6cb0,0x7bb0,0xadb0,0x67b8,0x6cb8,0x7bb8,0xadb8
.long 0x68e0,0x6de0,0x7ce0,0xaee0,0x68e8,0x6de8,0x7ce8,0xaee8
.long 0x68f0,0x6df0,0x7cf0,0xaef0,0x68f8,0x6df8,0x7cf8,0xaef8
.long 0x6f20,0x7420,0x8780,0xb980,0x6f28,0x7428,0x8788,0xb988
.long 0x6f30,0x7430,0x8790,0xb990,0x6f38,0x7438,0x8798,0xb998
.long 0x7060,0x7560,0x88c0,0xbac0,0x7068,0x7568,0x88c8,0xbac8
.long 0x7070,0x7570,0x88d0,0xbad0,0x7078,0x7578,0x88d8,0xbad8
.long 0x71a0,0x76a0,0x8a00,0xbc00,0x71a8,0x76a8,0x8a08,0xbc08
.long 0x71b0,0x76b0,0x8a10,0xbc10,0x71b8,0x76b8,0x8a18,0xbc18
.long 0x72e0,0x77e0,0x8b40,0xbd40,0x72e8,0x77e8,0x8b48,0xbd48
.long 0x72f0,0x77f0,0x8b50,0xbd50,0x72f8,0x77f8,0x8b58,0xbd58
.long 0x7380,0x7880,0x9220,0xc420,0x7388,0x7888,0x9228,0xc428
.long 0x7390,0x7890,0x9230,0xc430,0x7398,0x7898,0x9238,0xc438
.long 0x74c0,0x79c0,0x9360,0xc560,0x74c8,0x79c8,0x9368,0xc568
.long 0x74d0,0x79d0,0x9370,0xc570,0x74d8,0x79d8,0x9378,0xc578
.long 0x7600,0x7b00,0x94a0,0xc6a0,0x7608,0x7b08,0x94a8,0xc6a8
.long 0x7610,0x7b10,0x94b0,0xc6b0,0x7618,0x7b18,0x94b8,0xc6b8
.long 0x7740,0x7c40,0x95e0,0xc7e0,0x7748,0x7c48,0x95e8,0xc7e8
.long 0x7750,0x7c50,0x95f0,0xc7f0,0x7758,0x7c58,0x95f8,0xc7f8
.long 0x0,0xaa0,0xa00,0x21d40,0x8,0xaa8,0xa08,0x22248
.long 0x10,0xab0,0xa10,0x22750,0x18,0xab8,0xa18,0x22c58
.long 0x140,0xbe0,0xb40,0x23160,0x148,0xbe8,0xb48,0x23668
.long 0x150,0xbf0,0xb50,0x23b70,0x158,0xbf8,0xb58,0x24078
.long 0x280,0xd20,0xc80,0x24580,0x288,0xd28,0xc88,0x24a88
.long 0x290,0xd30,0xc90,0x24f90,0x298,0xd38,0xc98,0x25498
.long 0x3c0,0xe60,0xdc0,0x259a0,0x3c8,0xe68,0xdc8,0x25ea8
.long 0x3d0,0xe70,0xdd0,0x263b0,0x3d8,0xe78,0xdd8,0x268b8
.long 0x20,0xac0,0xa20,0x21d48,0x28,0xac8,0xa28,0x22250
.long 0x30,0xad0,0xa30,0x22758,0x38,0xad8,0xa38,0x22c60
.long 0x160,0xc00,0xb60,0x23168,0x168,0xc08,0xb68,0x23670
.long 0x170,0xc10,0xb70,0x23b78,0x178,0xc18,0xb78,0x24080
.long 0x2a0,0xd40,0xca0,0x24588,0x2a8,0xd48,0xca8,0x24a90
.long 0x2b0,0xd50,0xcb0,0x24f98,0x2b8,0xd58,0xcb8,0x254a0
.long 0x3e0,0xe80,0xde0,0x259a8,0x3e8,0xe88,0xde8,0x25eb0
.long 0x3f0,0xe90,0xdf0,0x263b8,0x3f8,0xe98,0xdf8,0x268c0
.long 0xa0,0xf00,0x14a0,0x21d50,0xa8,0xf08,0x14a8,0x22258
.long 0xb0,0xf10,0x14b0,0x22760,0xb8,0xf18,0x14b8,0x22c68
.long 0x1e0,0x1040,0x15e0,0x23170,0x1e8,0x1048,0x15e8,0x23678
.long 0x1f0,0x1050,0x15f0,0x23b80,0x1f8,0x1058,0x15f8,0x24088
.long 0x320,0x1180,0x1720,0x24590,0x328,0x1188,0x1728,0x24a98
.long 0x330,0x1190,0x1730,0x24fa0,0x338,0x1198,0x1738,0x254a8
.long 0x460,0x12c0,0x1860,0x259b0,0x468,0x12c8,0x1868,0x25eb8
.long 0x470,0x12d0,0x1870,0x263c0,0x478,0x12d8,0x1878,0x268c8
.long 0xc0,0xf20,0x14c0,0x21d58,0xc8,0xf28,0x14c8,0x22260
.long 0xd0,0xf30,0x14d0,0x22768,0xd8,0xf38,0x14d8,0x22c70
.long 0x200,0x1060,0x1600,0x23178,0x208,0x1068,0x1608,0x23680
.long 0x210,0x1070,0x1610,0x23b88,0x218,0x1078,0x1618,0x24090
.long 0x340,0x11a0,0x1740,0x24598,0x348,0x11a8,0x1748,0x24aa0
.long 0x350,0x11b0,0x1750,0x24fa8,0x358,0x11b8,0x1758,0x254b0
.long 0x480,0x12e0,0x1880,0x259b8,0x488,0x12e8,0x1888,0x25ec0
.long 0x490,0x12f0,0x1890,0x263c8,0x498,0x12f8,0x1898,0x268d0
.long 0xa000,0x12000,0x15600,0x0,0xa010,0x12008,0x156b0,0x80
.long 0xa020,0x12010,0x15760,0x100,0xa030,0x12018,0x15810,0x180
.long 0xa040,0x12020,0x158c0,0x200,0xa050,0x12028,0x15970,0x280
.long 0xa060,0x12030,0x15a20,0x300,0xa070,0x12038,0x15ad0,0x380
.long 0xa080,0x12040,0x15b80,0x0,0xa090,0x12048,0x15c30,0x80
.long 0xa0a0,0x12050,0x15ce0,0x100,0xa0b0,0x12058,0x15d90,0x180
.long 0xa0c0,0x12060,0x15e40,0x200,0xa0d0,0x12068,0x15ef0,0x280
.long 0xa0e0,0x12070,0x15fa0,0x300,0xa0f0,0x12078,0x16050,0x380
.long 0xa100,0x12080,0x16100,0x0,0xa110,0x12088,0x161b0,0x80
.long 0xa120,0x12090,0x16260,0x100,0xa130,0x12098,0x16310,0x180
.long 0xa140,0x120a0,0x163c0,0x200,0xa150,0x120a8,0x16470,0x280
.long 0xa160,0x120b0,0x16520,0x300,0xa170,0x120b8,0x165d0,0x380
.long 0xa180,0x120c0,0x16680,0x0,0xa190,0x120c8,0x16730,0x80
.long 0xa1a0,0x120d0,0x167e0,0x100,0xa1b0,0x120d8,0x16890,0x180
.long 0xa1c0,0x120e0,0x16940,0x200,0xa1d0,0x120e8,0x169f0,0x280
.long 0xa1e0,0x120f0,0x16aa0,0x300,0xa1f0,0x120f8,0x16b50,0x380
.long 0xa200,0x12100,0x15608,0x0,0xa210,0x12108,0x156b8,0x80
.long 0xa220,0x12110,0x15768,0x100,0xa230,0x12118,0x15818,0x180
.long 0xa240,0x12120,0x158c8,0x200,0xa250,0x12128,0x15978,0x280
.long 0xa260,0x12130,0x15a28,0x300,0xa270,0x12138,0x15ad8,0x380
.long 0xa280,0x12140,0x15b88,0x0,0xa290,0x12148,0x15c38,0x80
.long 0xa2a0,0x12150,0x15ce8,0x100,0xa2b0,0x12158,0x15d98,0x180
.long 0xa2c0,0x12160,0x15e48,0x200,0xa2d0,0x12168,0x15ef8,0x280
.long 0xa2e0,0x12170,0x15fa8,0x300,0xa2f0,0x12178,0x16058,0x380
.long 0xa300,0x12180,0x16108,0x0,0xa310,0x12188,0x161b8,0x80
.long 0xa320,0x12190,0x16268,0x100,0xa330,0x12198,0x16318,0x180
.long 0xa340,0x121a0,0x163c8,0x200,0xa350,0x121a8,0x16478,0x280
.long 0xa360,0x121b0,0x16528,0x300,0xa370,0x121b8,0x165d8,0x380
.long 0xa380,0x121c0,0x16688,0x0,0xa390,0x121c8,0x16738,0x80
.long 0xa3a0,0x121d0,0x167e8,0x100,0xa3b0,0x121d8,0x16898,0x180
.long 0xa3c0,0x121e0,0x16948,0x200,0xa3d0,0x121e8,0x169f8,0x280
.long 0xa3e0,0x121f0,0x16aa8,0x300,0xa3f0,0x121f8,0x16b58,0x380
.long 0x15600,0x14000,0x1a000,0x1d400,0x15610,0x14010,0x1a010,0x1d410
.long 0x15620,0x14020,0x1a020,0x1d420,0x15630,0x14030,0x1a030,0x1d430
.long 0x15640,0x14040,0x1a040,0x1d440,0x15650,0x14050,0x1a050,0x1d450
.long 0x15660,0x14060,0x1a060,0x1d460,0x15670,0x14070,0x1a070,0x1d470
.long 0x15680,0x14080,0x1a080,0x1d480,0x15690,0x14090,0x1a090,0x1d490
.long 0x156b0,0x14a00,0x1a0a0,0x1d4a0,0x156c0,0x14a10,0x1a0b0,0x1d4b0
.long 0x156d0,0x14a20,0x1a0c0,0x1d4c0,0x156e0,0x14a30,0x1a0d0,0x1d4d0
.long 0x156f0,0x14a40,0x1a0e0,0x1d4e0,0x15700,0x14a50,0x1a0f0,0x1d4f0
.long 0x15710,0x14a60,0x1a100,0x1d500,0x15720,0x14a70,0x1a110,0x1d510
.long 0x15730,0x14a80,0x1a120,0x1d520,0x15740,0x14a90,0x1a130,0x1d530
.long 0x15760,0x15400,0x1a140,0x1d540,0x15770,0x15410,0x1a150,0x1d550
.long 0x15780,0x15420,0x1a160,0x1d560,0x15790,0x15430,0x1a170,0x1d570
.long 0x157a0,0x15440,0x1a180,0x1d580,0x157b0,0x15450,0x1a190,0x1d590
.long 0x157c0,0x15460,0x1a1a0,0x1d5a0,0x157d0,0x15470,0x1a1b0,0x1d5b0
.long 0x157e0,0x15480,0x1a1c0,0x1d5c0,0x157f0,0x15490,0x1a1d0,0x1d5d0
.long 0x15810,0x15e00,0x1a1e0,0x1d5e0,0x15820,0x15e10,0x1a1f0,0x1d5f0
.long 0x15830,0x15e20,0x1a200,0x1d600,0x15840,0x15e30,0x1a210,0x1d610
.long 0x15850,0x15e40,0x1a220,0x1d620,0x15860,0x15e50,0x1a230,0x1d630
.long 0x15870,0x15e60,0x1a240,0x1d640,0x15880,0x15e70,0x1a250,0x1d650
.long 0x15890,0x15e80,0x1a260,0x1d660,0x158a0,0x15e90,0x1a270,0x1d670
.long 0x158c0,0x16800,0x1a280,0x1d680,0x158d0,0x16810,0x1a290,0x1d690
.long 0x158e0,0x16820,0x1a2a0,0x1d6a0,0x158f0,0x16830,0x1a2b0,0x1d6b0
.long 0x15900,0x16840,0x1a2c0,0x1d6c0,0x15910,0x16850,0x1a2d0,0x1d6d0
.long 0x15920,0x16860,0x1a2e0,0x1d6e0,0x15930,0x16870,0x1a2f0,0x1d6f0
.long 0x15940,0x16880,0x1a300,0x1d700,0x15950,0x16890,0x1a310,0x1d710
.long 0x15970,0x17200,0x1a320,0x1d720,0x15980,0x17210,0x1a330,0x1d730
.long 0x15990,0x17220,0x1a340,0x1d740,0x159a0,0x17230,0x1a350,0x1d750
.long 0x159b0,0x17240,0x1a360,0x1d760,0x159c0,0x17250,0x1a370,0x1d770
.long 0x159d0,0x17260,0x1a380,0x1d780,0x159e0,0x17270,0x1a390,0x1d790
.long 0x159f0,0x17280,0x1a3a0,0x1d7a0,0x15a00,0x17290,0x1a3b0,0x1d7b0
.long 0x15a20,0x17c00,0x1a3c0,0x1d7c0,0x15a30,0x17c10,0x1a3d0,0x1d7d0
.long 0x15a40,0x17c20,0x1a3e0,0x1d7e0,0x15a50,0x17c30,0x1a3f0,0x1d7f0
.long 0xbf803f80,0xbf803f80,0xa554248d,0xa5f725b0,0xa50d8000,0xa5d4258d,0x3f80bf80,0x3f80bf80
.long 0xbf7f3f80,0xbf753f7b,0x3e16bd49,0x3eacbe79,0x3dc98000,0x3e95be48,0x3f7dbf80,0x3f71bf78
.long 0xbf7b3f80,0xbf553f6d,0x3e95bdc9,0x3f22bef1,0x3e488000,0x3f0ebec4,0x3f75bf7f,0x3f46bf62
.long 0xbf753f80,0xbf223f55,0x3edbbe16,0x3f5cbf2c,0x3e958000,0x3f46bf0e,0x3f67bf7d,0x3f04bf3e
.long 0xbf6d3f80,0xbec43f35,0x3f0ebe48,0x3f7bbf55,0x3ec48000,0x3f6dbf35,0x3f55bf7b,0x3e48bf0e
.long 0xbf623f80,0xbdc93f0e,0x3f2cbe79,0x3f7dbf71,0x3ef18000,0x3f7fbf55,0x3f3ebf78,0xbe16beac
.long 0xbf553f80,0x3e483ec4,0x3f46be95,0x3f62bf7f,0x3f0e8000,0x3f7bbf6d,0x3f22bf75,0xbef1bdc9
.long 0xbf463f80,0x3ef13e48,0x3f5cbeac,0x3f2cbf7d,0x3f228000,0x3f62bf7b,0x3f04bf71,0xbf3e3e16
.long 0xbf803f80,0xbf803f80,0xa731261f,0xa742a68d,0xa630260d,0xa6772654,0x3f80bf80,0x3f80bf80
.long 0xbf623f6d,0xbf463f55,0x3f04bedb,0x3f2cbf18,0x3ef1bec4,0x3f22bf0e,0x3f5cbf67,0x3f3ebf4e
.long 0xbf0e3f35,0xbe483ec4,0x3f62bf46,0x3f7fbf75,0x3f55bf35,0x3f7bbf6d,0x3ef1bf22,0x3dc9be95
.long 0xbdc93ec4,0x3ef1be48,0x3f80bf78,0x3f4ebf71,0x3f7fbf6d,0x3f62bf7b,0xbd49be79,0xbf183eac
.long 0x3ec4261f,0x3f6dbf35,0x3f55bf7b,0x3e48bf0e,0x3f6dbf80,0x3ec4bf35,0xbf0e3e48,0xbf7b3f55
.long 0x3f46bec4,0x3f75bf7b,0x3edbbf4e,0xbf043d49,0x3f22bf6d,0xbe95be48,0xbf673f18,0xbf5c3f80
.long 0x3f7bbf35,0x3f0ebf6d,0xbdc9bef1,0xbf753f22,0x3e48bf35,0xbf553ec4,0xbf7f3f62,0xbe953f46
.long 0x3f75bf6d,0xbdc9bf0e,0xbf18bd49,0xbf673f78,0xbe95bec4,0xbf7f3f55,0xbf4e3f80,0x3edb3e79
.long 0xbf803f80,0xbf803f80,0xa754a654,0xa765a60d,0xa69f268d,0xa7b126b0,0x3f80bf80,0x3f80bf80
.long 0xbf223f35,0xbef13f0e,0x3f4ebf3e,0x3f67bf5c,0x3f46bf35,0x3f62bf55,0x3f18bf2c,0x3edbbf04
.long 0x3e48a654,0x3f0ebec4,0x3f75bf7f,0x3f46bf62,0x3f7bbf80,0x3f55bf6d,0xbe953dc9,0xbf223ef1
.long 0x3f62bf35,0x3f7fbf7b,0x3eacbf18,0xbe79bd49,0x3ef1bf35,0xbdc9be48,0xbf713f4e,0xbf783f80
.long 0x3f6dbf80,0x3ec4bf35,0xbf0e3e48,0xbf7b3f55,0xbec4a69f,0xbf6d3f35,0xbf553f7b,0xbe483f0e
.long 0x3e95bf35,0xbf223e48,0xbf803f5c,0xbf183f67,0xbf753f35,0xbf463f7b,0xbd493f04,0x3f4ebedb
.long 0xbf0ea754,0xbf7b3f6d,0xbf223f75,0x3ef13dc9,0xbf553f80,0x3e483ec4,0x3f46be95,0x3f62bf7f
.long 0xbf7f3f35,0xbe953f55,0x3e793edb,0x3f80bf4e,0xbdc93f35,0x3f75bf0e,0x3f78bf67,0xbd49bf18
.long 0xbf803f80,0xbf803f80,0xa777a58e,0xa784a137,0x270d26d4,0xa7c226f7,0x3f80bf80,0x3f80bf80
.long 0xbe953ec4,0xbdc93e48,0x3f78bf71,0x3f80bf7d,0x3f75bf6d,0x3f7fbf7b,0x3e79beac,0x3d49be16
.long 0x3f55bf35,0x3f7bbf6d,0x3ef1bf22,0x3dc9be95,0x3f0ebf35,0x3e48bec4,0xbf623f46,0xbf7f3f75
.long 0x3f46bf6d,0x3e95bf0e,0xbf3e3f04,0xbf7d3f67,0xbf223ec4,0xbf753f55,0xbf2c3f5c,0xbe163edb
.long 0xbec4a777,0xbf6d3f35,0xbf553f7b,0xbe483f0e,0xbf6d3f80,0xbec43f35,0x3f0ebe48,0x3f7bbf55
.long 0xbf7f3f6d,0xbef13f55,0x3eac3e16,0x3f78bf3e,0x3dc93ec4,0x3f62bf0e,0x3f71bf7d,0x3e79bf2c
.long 0xbe483f35,0x3f55bec4,0x3f7fbf62,0x3e95bf46,0x3f7bbf35,0x3f0ebf6d,0xbdc9bef1,0xbf753f22
.long 0x3f62bec4,0x3f22bf7b,0x3e16bf3e,0xbf713f04,0x3ef1bf6d,0xbf463e48,0xbf7d3f2c,0xbeac3f5c
.long 0xbf803f80,0xbf803f80,0xa78d258d,0xa796260d,0x26d4270d,0xa7d4271f,0x3f80bf80,0x3f80bf80
.long 0x3dc9258d,0x3e95be48,0x3f7dbf80,0x3f71bf78,0x3f7fbf80,0x3f75bf7b,0xbe163d49,0xbeac3e79
.long 0x3f7bbf80,0x3f55bf6d,0xbe953dc9,0xbf223ef1,0xbe4826d4,0xbf0e3ec4,0xbf753f7f,0xbf463f62
.long 0xbe95a78d,0xbf463f0e,0xbf673f7d,0xbf043f3e,0xbf753f80,0xbf223f55,0x3edbbe16,0x3f5cbf2c
.long 0xbf6d3f80,0xbec43f35,0x3f0ebe48,0x3f7bbf55,0x3ec4271f,0x3f6dbf35,0x3f55bf7b,0x3e48bf0e
.long 0x3ef1260d,0x3f7fbf55,0x3f3ebf78,0xbe16beac,0x3f62bf80,0x3dc9bf0e,0xbf2c3e79,0xbf7d3f71
.long 0x3f55bf80,0xbe48bec4,0xbf463e95,0xbf623f7f,0xbf0ea7d4,0xbf7b3f6d,0xbf223f75,0x3ef13dc9
.long 0xbf22a796,0xbf623f7b,0xbf043f71,0x3f3ebe16,0xbf463f80,0x3ef13e48,0x3f5cbeac,0x3f2cbf7d
.long 0xbf803f80,0xbf803f80,0xa79f280d,0x2731268d,0x268d2730,0xa7e52831,0x3f80bf80,0x3f80bf80
.long 0x3ef1bec4,0x3f22bf0e,0x3f5cbf67,0x3f3ebf4e,0x3f62bf6d,0x3f46bf55,0xbf043edb,0xbf2c3f18
.long 0x3f0ebf35,0x3e48bec4,0xbf623f46,0xbf7f3f75,0xbf553f35,0xbf7b3f6d,0xbef13f22,0xbdc93e95
.long 0xbf7f3f6d,0xbf623f7b,0x3d493e79,0x3f18beac,0xbdc93ec4,0x3ef1be48,0x3f80bf78,0x3f4ebf71
.long 0x3ec4268d,0x3f6dbf35,0x3f55bf7b,0x3e48bf0e,0x3f6dbf80,0x3ec4bf35,0xbf0e3e48,0xbf7b3f55
.long 0x3f22bf6d,0xbe95be48,0xbf673f18,0xbf5c3f80,0xbf463ec4,0xbf753f7b,0xbedb3f4e,0x3f04bd49
.long 0xbf7b3f35,0xbf0e3f6d,0x3dc93ef1,0x3f75bf22,0xbe483f35,0x3f55bec4,0x3f7fbf62,0x3e95bf46
.long 0x3e953ec4,0x3f7fbf55,0x3f4ebf80,0xbedbbe79,0x3f75bf6d,0xbdc9bf0e,0xbf18bd49,0xbf673f78
.long 0xbf803f80,0xbf803f80,0xa7b12816,0x270d26d4,0x260e2754,0xa7f7a78d,0x3f80bf80,0x3f80bf80
.long 0x3f46bf35,0x3f62bf55,0x3f18bf2c,0x3edbbf04,0x3f22bf35,0x3ef1bf0e,0xbf4e3f3e,0xbf673f5c
.long 0xbe482828,0xbf0e3ec4,0xbf753f7f,0xbf463f62,0xbf7b3f80,0xbf553f6d,0x3e95bdc9,0x3f22bef1
.long 0xbef13f35,0x3dc93e48,0x3f71bf4e,0x3f78bf80,0x3f62bf35,0x3f7fbf7b,0x3eacbf18,0xbe79bd49
.long 0x3f6dbf80,0x3ec4bf35,0xbf0e3e48,0xbf7b3f55,0xbec4a7f7,0xbf6d3f35,0xbf553f7b,0xbe483f0e
.long 0xbf753f35,0xbf463f7b,0xbd493f04,0x3f4ebedb,0xbe953f35,0x3f22be48,0x3f80bf5c,0x3f18bf67
.long 0x3f0e281f,0x3f7bbf6d,0x3f22bf75,0xbef1bdc9,0x3f55bf80,0xbe48bec4,0xbf463e95,0xbf623f7f
.long 0x3dc9bf35,0xbf753f0e,0xbf783f67,0x3d493f18,0xbf7f3f35,0xbe953f55,0x3e793edb,0x3f80bf4e
.long 0xbf803f80,0xbf803f80,0xa7c2281f,0x26d4270d,0x21b72777,0xa8042842,0x3f80bf80,0x3f80bf80
.long 0x3f75bf6d,0x3f7fbf7b,0x3e79beac,0x3d49be16,0x3e95bec4,0x3dc9be48,0xbf783f71,0xbf803f7d
.long 0xbf553f35,0xbf7b3f6d,0xbef13f22,0xbdc93e95,0xbf0e3f35,0xbe483ec4,0x3f62bf46,0x3f7fbf75
.long 0x3f22bec4,0x3f75bf55,0x3f2cbf5c,0x3e16bedb,0x3f46bf6d,0x3e95bf0e,0xbf3e3f04,0xbf7d3f67
.long 0xbec426d4,0xbf6d3f35,0xbf553f7b,0xbe483f0e,0xbf6d3f80,0xbec43f35,0x3f0ebe48,0x3f7bbf55
.long 0x3dc93ec4,0x3f62bf0e,0x3f71bf7d,0x3e79bf2c,0x3f7fbf6d,0x3ef1bf55,0xbeacbe16,0xbf783f3e
.long 0x3e48bf35,0xbf553ec4,0xbf7f3f62,0xbe953f46,0xbf7b3f35,0xbf0e3f6d,0x3dc93ef1,0x3f75bf22
.long 0xbef13f6d,0x3f46be48,0x3f7dbf2c,0x3eacbf5c,0x3f62bec4,0x3f22bf7b,0x3e16bf3e,0xbf713f04
.long 0xbf803f80,0xbf803f80,0xa7d42828,0x268d2730,0xa60d278d,0xa80da754,0x3f80bf80,0x3f80bf80
.long 0x3f7fbf80,0x3f75bf7b,0xbe163d49,0xbeac3e79,0xbdc9a60d,0xbe953e48,0xbf7d3f80,0xbf713f78
.long 0xbf7b3f80,0xbf553f6d,0x3e95bdc9,0x3f22bef1,0x3e48a754,0x3f0ebec4,0x3f75bf7f,0x3f46bf62
.long 0x3f75bf80,0x3f22bf55,0xbedb3e16,0xbf5c3f2c,0xbe95a80d,0xbf463f0e,0xbf673f7d,0xbf043f3e
.long 0xbf6d3f80,0xbec43f35,0x3f0ebe48,0x3f7bbf55,0x3ec4279f,0x3f6dbf35,0x3f55bf7b,0x3e48bf0e
.long 0x3f62bf80,0x3dc9bf0e,0xbf2c3e79,0xbf7d3f71,0xbef1a68d,0xbf7f3f55,0xbf3e3f78,0x3e163eac
.long 0xbf553f80,0x3e483ec4,0x3f46be95,0x3f62bf7f,0x3f0e2854,0x3f7bbf6d,0x3f22bf75,0xbef1bdc9
.long 0x3f46bf80,0xbef1be48,0xbf5c3eac,0xbf2c3f7d,0xbf22a816,0xbf623f7b,0xbf043f71,0x3f3ebe16
.long 0xbf803f80,0xbf803f80,0xa7e52831,0x260e2754,0xa68d279f,0xa8162854,0x3f80bf80,0x3f80bf80
.long 0x3f62bf6d,0x3f46bf55,0xbf043edb,0xbf2c3f18,0xbef13ec4,0xbf223f0e,0xbf5c3f67,0xbf3e3f4e
.long 0xbf0e3f35,0xbe483ec4,0x3f62bf46,0x3f7fbf75,0x3f55bf35,0x3f7bbf6d,0x3ef1bf22,0x3dc9be95
.long 0x3dc9bec4,0xbef13e48,0xbf803f78,0xbf4e3f71,0xbf7f3f6d,0xbf623f7b,0x3d493e79,0x3f18beac
.long 0x3ec42839,0x3f6dbf35,0x3f55bf7b,0x3e48bf0e,0x3f6dbf80,0x3ec4bf35,0xbf0e3e48,0xbf7b3f55
.long 0xbf463ec4,0xbf753f7b,0xbedb3f4e,0x3f04bd49,0xbf223f6d,0x3e953e48,0x3f67bf18,0x3f5cbf80
.long 0x3f7bbf35,0x3f0ebf6d,0xbdc9bef1,0xbf753f22,0x3e48bf35,0xbf553ec4,0xbf7f3f62,0xbe953f46
.long 0xbf753f6d,0x3dc93f0e,0x3f183d49,0x3f67bf78,0x3e953ec4,0x3f7fbf55,0x3f4ebf80,0xbedbbe79
.long 0xbf803f80,0xbf803f80,0x28042839,0xa8802777,0xa88d27b0,0xa81fa70d,0x3f80bf80,0x3f80bf80
.long 0x3f22bf35,0x3ef1bf0e,0xbf4e3f3e,0xbf673f5c,0xbf463f35,0xbf623f55,0xbf183f2c,0xbedb3f04
.long 0x3e482777,0x3f0ebec4,0x3f75bf7f,0x3f46bf62,0x3f7bbf80,0x3f55bf6d,0xbe953dc9,0xbf223ef1
.long 0xbf623f35,0xbf7f3f7b,0xbeac3f18,0x3e793d49,0xbef13f35,0x3dc93e48,0x3f71bf4e,0x3f78bf80
.long 0x3f6dbf80,0x3ec4bf35,0xbf0e3e48,0xbf7b3f55,0xbec4a70d,0xbf6d3f35,0xbf553f7b,0xbe483f0e
.long 0xbe953f35,0x3f22be48,0x3f80bf5c,0x3f18bf67,0x3f75bf35,0x3f46bf7b,0x3d49bf04,0xbf4e3edb
.long 0xbf0ea60d,0xbf7b3f6d,0xbf223f75,0x3ef13dc9,0xbf553f80,0x3e483ec4,0x3f46be95,0x3f62bf7f
.long 0x3f7fbf35,0x3e95bf55,0xbe79bedb,0xbf803f4e,0x3dc9bf35,0xbf753f0e,0xbf783f67,0x3d493f18
.long 0xbf803f80,0xbf803f80,0xa804a777,0xa60d28a3,0xa70d28b1,0x27b12865,0x3f80bf80,0x3f80bf80
.long 0x3e95bec4,0x3dc9be48,0xbf783f71,0xbf803f7d,0xbf753f6d,0xbf7f3f7b,0xbe793eac,0xbd493e16
.long 0x3f55bf35,0x3f7bbf6d,0x3ef1bf22,0x3dc9be95,0x3f0ebf35,0x3e48bec4,0xbf623f46,0xbf7f3f75
.long 0xbf463f6d,0xbe953f0e,0x3f3ebf04,0x3f7dbf67,0x3f22bec4,0x3f75bf55,0x3f2cbf5c,0x3e16bedb
.long 0xbec427e6,0xbf6d3f35,0xbf553f7b,0xbe483f0e,0xbf6d3f80,0xbec43f35,0x3f0ebe48,0x3f7bbf55
.long 0x3f7fbf6d,0x3ef1bf55,0xbeacbe16,0xbf783f3e,0xbdc9bec4,0xbf623f0e,0xbf713f7d,0xbe793f2c
.long 0xbe483f35,0x3f55bec4,0x3f7fbf62,0x3e95bf46,0x3f7bbf35,0x3f0ebf6d,0xbdc9bef1,0xbf753f22
.long 0xbf623ec4,0xbf223f7b,0xbe163f3e,0x3f71bf04,0xbef13f6d,0x3f46be48,0x3f7dbf2c,0x3eacbf5c
.long 0xbf803f80,0xbf803f80,0x27e6284b,0xa889279f,0xa89627d4,0xa831a68e,0x3f80bf80,0x3f80bf80
.long 0xbdc927e6,0xbe953e48,0xbf7d3f80,0xbf713f78,0xbf7f3f80,0xbf753f7b,0x3e16bd49,0x3eacbe79
.long 0x3f7bbf80,0x3f55bf6d,0xbe953dc9,0xbf223ef1,0xbe4828a8,0xbf0e3ec4,0xbf753f7f,0xbf463f62
.long 0x3e95a731,0x3f46bf0e,0x3f67bf7d,0x3f04bf3e,0x3f75bf80,0x3f22bf55,0xbedb3e16,0xbf5c3f2c
.long 0xbf6d3f80,0xbec43f35,0x3f0ebe48,0x3f7bbf55,0x3ec42877,0x3f6dbf35,0x3f55bf7b,0x3e48bf0e
.long 0xbef1a6d4,0xbf7f3f55,0xbf3e3f78,0x3e163eac,0xbf623f80,0xbdc93f0e,0x3f2cbe79,0x3f7dbf71
.long 0x3f55bf80,0xbe48bec4,0xbf463e95,0xbf623f7f,0xbf0ea89f,0xbf7b3f6d,0xbf223f75,0x3ef13dc9
.long 0x3f2227c2,0x3f62bf7b,0x3f04bf71,0xbf3e3e16,0x3f46bf80,0xbef1be48,0xbf5c3eac,0xbf2c3f7d
.long 0xbf803f80,0xbf803f80,0xa816a731,0xa6d428ac,0xa754a80d,0x278d2877,0x3f80bf80,0x3f80bf80
.long 0xbef13ec4,0xbf223f0e,0xbf5c3f67,0xbf3e3f4e,0xbf623f6d,0xbf463f55,0x3f04bedb,0x3f2cbf18
.long 0x3f0ebf35,0x3e48bec4,0xbf623f46,0xbf7f3f75,0xbf553f35,0xbf7b3f6d,0xbef13f22,0xbdc93e95
.long 0x3f7fbf6d,0x3f62bf7b,0xbd49be79,0xbf183eac,0x3dc9bec4,0xbef13e48,0xbf803f78,0xbf4e3f71
.long 0x3ec427c2,0x3f6dbf35,0x3f55bf7b,0x3e48bf0e,0x3f6dbf80,0x3ec4bf35,0xbf0e3e48,0xbf7b3f55
.long 0xbf223f6d,0x3e953e48,0x3f67bf18,0x3f5cbf80,0x3f46bec4,0x3f75bf7b,0x3edbbf4e,0xbf043d49
.long 0xbf7b3f35,0xbf0e3f6d,0x3dc93ef1,0x3f75bf22,0xbe483f35,0x3f55bec4,0x3f7fbf62,0x3e95bf46
.long 0xbe95bec4,0xbf7f3f55,0xbf4e3f80,0x3edb3e79,0xbf753f6d,0x3dc93f0e,0x3f183d49,0x3f67bf78
.long 0xbf803f80,0xbf803f80,0x27c2285d,0xa89227c2,0xa89f27f7,0xa842a237,0x3f80bf80,0x3f80bf80
.long 0xbf463f35,0xbf623f55,0xbf183f2c,0xbedb3f04,0xbf223f35,0xbef13f0e,0x3f4ebf3e,0x3f67bf5c
.long 0xbe48285d,0xbf0e3ec4,0xbf753f7f,0xbf463f62,0xbf7b3f80,0xbf553f6d,0x3e95bdc9,0x3f22bef1
.long 0x3ef1bf35,0xbdc9be48,0xbf713f4e,0xbf783f80,0xbf623f35,0xbf7f3f7b,0xbeac3f18,0x3e793d49
.long 0x3f6dbf80,0x3ec4bf35,0xbf0e3e48,0xbf7b3f55,0xbec42754,0xbf6d3f35,0xbf553f7b,0xbe483f0e
.long 0x3f75bf35,0x3f46bf7b,0x3d49bf04,0xbf4e3edb,0x3e95bf35,0xbf223e48,0xbf803f5c,0xbf183f67
.long 0x3f0e291d,0x3f7bbf6d,0x3f22bf75,0xbef1bdc9,0x3f55bf80,0xbe48bec4,0xbf463e95,0xbf623f7f
.long 0xbdc93f35,0x3f75bf0e,0x3f78bf67,0xbd49bf18,0x3f7fbf35,0x3e95bf55,0xbe79bedb,0xbf803f4e
.long 0xbf803f80,0xbf803f80,0xa828a6d4,0xa73028b5,0xa78d28c2,0x27542884,0x3f80bf80,0x3f80bf80
.long 0xbf753f6d,0xbf7f3f7b,0xbe793eac,0xbd493e16,0xbe953ec4,0xbdc93e48,0x3f78bf71,0x3f80bf7d
.long 0xbf553f35,0xbf7b3f6d,0xbef13f22,0xbdc93e95,0xbf0e3f35,0xbe483ec4,0x3f62bf46,0x3f7fbf75
.long 0xbf223ec4,0xbf753f55,0xbf2c3f5c,0xbe163edb,0xbf463f6d,0xbe953f0e,0x3f3ebf04,0x3f7dbf67
.long 0xbec4a89a,0xbf6d3f35,0xbf553f7b,0xbe483f0e,0xbf6d3f80,0xbec43f35,0x3f0ebe48,0x3f7bbf55
.long 0xbdc9bec4,0xbf623f0e,0xbf713f7d,0xbe793f2c,0xbf7f3f6d,0xbef13f55,0x3eac3e16,0x3f78bf3e
.long 0x3e48bf35,0xbf553ec4,0xbf7f3f62,0xbe953f46,0xbf7b3f35,0xbf0e3f6d,0x3dc93ef1,0x3f75bf22
.long 0x3ef1bf6d,0xbf463e48,0xbf7d3f2c,0xbeac3f5c,0xbf623ec4,0xbf223f7b,0xbe163f3e,0x3f71bf04
.long 0xbf353f80,0x3f3525b0,0x3f6dbec4,0x3ec4bf6d,0x3f358000,0x3f35bf80,0x3ec4bf6d,0xbf6d3ec4
.long 0xbf223f80,0x3f62be48,0x3f78bedb,0x3d49bf4e,0x3f468000,0x3ef1bf7b,0x3e79bf67,0xbf803f18
.long 0xbf0e3f80,0x3f7bbec4,0x3f7fbef1,0xbe95bf22,0x3f558000,0x3e48bf6d,0x3dc9bf62,0xbf753f46
.long 0xbef13f80,0x3f7fbf0e,0x3f80bf04,0xbf18bedb,0x3f628000,0xbdc9bf55,0xbd49bf5c,0xbf4e3f67
.long 0xbec43f80,0x3f6dbf35,0x3f7bbf0e,0xbf55be48,0x3f6d8000,0xbec4bf35,0xbe48bf55,0xbf0e3f7b
.long 0xbe953f80,0x3f46bf55,0x3f71bf18,0xbf783d49,0x3f758000,0xbf22bf0e,0xbeacbf4e,0xbe793f80
.long 0xbe483f80,0x3f0ebf6d,0x3f62bf22,0xbf7f3e95,0x3f7b8000,0xbf55bec4,0xbef1bf46,0x3dc93f75
.long 0xbdc93f80,0x3e95bf7b,0x3f4ebf2c,0xbf673f04,0x3f7f8000,0xbf75be48,0xbf18bf3e,0x3edb3f5c
.long 0x3f35bf80,0xbf35a742,0xbf6d3ec4,0xbec43f6d,0xbf35a630,0xbf353f80,0xbec43f6d,0x3f6dbec4
.long 0x3e95bf6d,0xbf7f3f0e,0xbf7d3f3e,0x3eac3f04,0xbf753ec4,0xbdc93f55,0x3e163f2c,0x3f71bf5c
.long 0xbe48bf35,0xbf553f6d,0xbf463f75,0x3f62bdc9,0xbf7b3f35,0x3f0e3ec4,0x3f223e95,0x3ef1bf7f
.long 0xbf22bec4,0xbe953f7b,0xbeac3f7d,0x3f78bf2c,0xbf463f6d,0x3f75be48,0x3f71be16,0xbe79bf3e
.long 0xbf6da731,0x3ec43f35,0x3e483f55,0x3f0ebf7b,0xbec43f80,0x3f6dbf35,0x3f7bbf0e,0xbf55be48
.long 0xbf7f3ec4,0x3f623e48,0x3f2c3f04,0xbe16bf67,0x3dc93f6d,0x3ef1bf7b,0x3f3ebf5c,0xbf7d3edb
.long 0xbf553f35,0x3f7bbec4,0x3f753dc9,0xbf46bef1,0x3f0e3f35,0xbe48bf6d,0x3e95bf7f,0xbf223f62
.long 0xbef13f6d,0x3f22bf55,0x3f78beac,0xbf803e16,0x3f623ec4,0xbf46bf0e,0xbe79bf71,0x3d493f7d
.long 0xbf353f80,0x3f35a58e,0x3f6dbec4,0x3ec4bf6d,0x3f3526b0,0x3f35bf80,0x3ec4bf6d,0xbf6d3ec4
.long 0x3dc93f35,0x3f75bf55,0x3f5cbf71,0xbf2cbe16,0x3f7fbf35,0xbe95bf0e,0xbf04beac,0xbf3e3f7d
.long 0x3f55a60d,0x3e48bf6d,0x3dc9bf62,0xbf753f46,0x3f0ebf80,0xbf7b3ec4,0xbf7f3ef1,0x3e953f22
.long 0x3f75bf35,0xbf46be48,0xbf3ebe79,0xbe163f71,0xbe95bf35,0xbf223f7b,0xbf2c3f78,0x3f7dbeac
.long 0x3ec4bf80,0xbf6d3f35,0xbf7b3f0e,0x3f553e48,0xbf6da7b1,0x3ec43f35,0x3e483f55,0x3f0ebf7b
.long 0xbef1bf35,0xbdc93f7b,0xbedb3f7d,0x3f5cbf3e,0xbf623f35,0x3f7fbe48,0x3f673e16,0xbf04bf2c
.long 0xbf7ba765,0x3f553ec4,0x3ef13f46,0xbdc9bf75,0xbe483f80,0x3f0ebf6d,0x3f62bf22,0xbf7f3e95
.long 0xbf463f35,0x3f62bf0e,0x3f7d3d49,0xbf71be79,0x3f223f35,0xbef1bf55,0x3e16bf80,0xbeac3f78
.long 0x3f35bf80,0xbf35a78d,0xbf6d3ec4,0xbec43f6d,0xbf35a7c2,0xbf353f80,0xbec43f6d,0x3f6dbec4
.long 0xbef1bec4,0xbf463f7b,0xbf183f80,0x3f67be79,0xbf623f6d,0x3f223e48,0x3f4ebd49,0x3edbbf78
.long 0xbf7b3f35,0x3f0e3ec4,0x3f223e95,0x3ef1bf7f,0x3e483f35,0x3f55bf6d,0x3f46bf75,0xbf623dc9
.long 0xbdc93f6d,0x3f62bf55,0x3f67bf4e,0xbf5cbd49,0x3f7fbec4,0xbef1bf0e,0xbedbbf18,0xbf043f80
.long 0x3f6d2804,0xbec4bf35,0xbe48bf55,0xbf0e3f7b,0x3ec4bf80,0xbf6d3f35,0xbf7b3f0e,0x3f553e48
.long 0x3f22bf6d,0xbf753f0e,0xbf803e79,0x3f4e3eac,0xbf46bec4,0x3e953f55,0xbd493f78,0x3f18bf71
.long 0xbf0ebf35,0x3e483f6d,0xbe953f7f,0x3f22bf62,0xbf553f35,0x3f7bbec4,0x3f753dc9,0xbf46bef1
.long 0xbf753ec4,0x3f7fbe48,0x3f5c3edb,0xbf3ebf18,0x3e953f6d,0xbdc9bf7b,0x3f04bf67,0xbf2c3f4e
.long 0xbf353f80,0x3f35268d,0x3f6dbec4,0x3ec4bf6d,0x3f352730,0x3f35bf80,0x3ec4bf6d,0xbf6d3ec4
.long 0x3f46280d,0x3ef1bf7b,0x3e79bf67,0xbf803f18,0x3f22bf80,0xbf623e48,0xbf783edb,0xbd493f4e
.long 0x3f0ebf80,0xbf7b3ec4,0xbf7f3ef1,0x3e953f22,0xbf55268d,0xbe483f6d,0xbdc93f62,0x3f75bf46
.long 0xbf62a79f,0x3dc93f55,0x3d493f5c,0x3f4ebf67,0xbef13f80,0x3f7fbf0e,0x3f80bf04,0xbf18bedb
.long 0xbec43f80,0x3f6dbf35,0x3f7bbf0e,0xbf55be48,0x3f6d2831,0xbec4bf35,0xbe48bf55,0xbf0e3f7b
.long 0x3f75268d,0xbf22bf0e,0xbeacbf4e,0xbe793f80,0x3e95bf80,0xbf463f55,0xbf713f18,0x3f78bd49
.long 0x3e48bf80,0xbf0e3f6d,0xbf623f22,0x3f7fbe95,0xbf7ba7e5,0x3f553ec4,0x3ef13f46,0xbdc9bf75
.long 0xbf7f2731,0x3f753e48,0x3f183f3e,0xbedbbf5c,0xbdc93f80,0x3e95bf7b,0x3f4ebf2c,0xbf673f04
.long 0x3f35bf80,0xbf35270d,0xbf6d3ec4,0xbec43f6d,0xbf35260e,0xbf353f80,0xbec43f6d,0x3f6dbec4
.long 0xbf753ec4,0xbdc93f55,0x3e163f2c,0x3f71bf5c,0xbe953f6d,0x3f7fbf0e,0x3f7dbf3e,0xbeacbf04
.long 0x3e483f35,0x3f55bf6d,0x3f46bf75,0xbf623dc9,0x3f7bbf35,0xbf0ebec4,0xbf22be95,0xbef13f7f
.long 0x3f46bf6d,0xbf753e48,0xbf713e16,0x3e793f3e,0xbf22bec4,0xbe953f7b,0xbeac3f7d,0x3f78bf2c
.long 0xbf6da85d,0x3ec43f35,0x3e483f55,0x3f0ebf7b,0xbec43f80,0x3f6dbf35,0x3f7bbf0e,0xbf55be48
.long 0x3dc93f6d,0x3ef1bf7b,0x3f3ebf5c,0xbf7d3edb,0x3f7fbec4,0xbf62be48,0xbf2cbf04,0x3e163f67
.long 0x3f55bf35,0xbf7b3ec4,0xbf75bdc9,0x3f463ef1,0xbf0ebf35,0x3e483f6d,0xbe953f7f,0x3f22bf62
.long 0xbf62bec4,0x3f463f0e,0x3e793f71,0xbd49bf7d,0xbef13f6d,0x3f22bf55,0x3f78beac,0xbf803e16
.long 0xbf353f80,0x3f352828,0x3f6dbec4,0x3ec4bf6d,0x3f352842,0x3f35bf80,0x3ec4bf6d,0xbf6d3ec4
.long 0x3f7fbf35,0xbe95bf0e,0xbf04beac,0xbf3e3f7d,0xbdc9bf35,0xbf753f55,0xbf5c3f71,0x3f2c3e16
.long 0xbf5526d4,0xbe483f6d,0xbdc93f62,0x3f75bf46,0xbf0e3f80,0x3f7bbec4,0x3f7fbef1,0xbe95bf22
.long 0x3e953f35,0x3f22bf7b,0x3f2cbf78,0xbf7d3eac,0x3f75bf35,0xbf46be48,0xbf3ebe79,0xbe163f71
.long 0x3ec4bf80,0xbf6d3f35,0xbf7b3f0e,0x3f553e48,0xbf6da884,0x3ec43f35,0x3e483f55,0x3f0ebf7b
.long 0xbf623f35,0x3f7fbe48,0x3f673e16,0xbf04bf2c,0x3ef13f35,0x3dc9bf7b,0x3edbbf7d,0xbf5c3f3e
.long 0x3f7b2730,0xbf55bec4,0xbef1bf46,0x3dc93f75,0x3e48bf80,0xbf0e3f6d,0xbf623f22,0x3f7fbe95
.long 0xbf22bf35,0x3ef13f55,0xbe163f80,0x3eacbf78,0xbf463f35,0x3f62bf0e,0x3f7d3d49,0xbf71be79
.long 0x3f35bf80,0xbf35a7e5,0xbf6d3ec4,0xbec43f6d,0xbf35a80d,0xbf353f80,0xbec43f6d,0x3f6dbec4
.long 0xbf623f6d,0x3f223e48,0x3f4ebd49,0x3edbbf78,0x3ef13ec4,0x3f46bf7b,0x3f18bf80,0xbf673e79
.long 0x3f7bbf35,0xbf0ebec4,0xbf22be95,0xbef13f7f,0xbe48bf35,0xbf553f6d,0xbf463f75,0x3f62bdc9
.long 0xbf7f3ec4,0x3ef13f0e,0x3edb3f18,0x3f04bf80,0xbdc93f6d,0x3f62bf55,0x3f67bf4e,0xbf5cbd49
.long 0x3f6d289a,0xbec4bf35,0xbe48bf55,0xbf0e3f7b,0x3ec4bf80,0xbf6d3f35,0xbf7b3f0e,0x3f553e48
.long 0xbf46bec4,0x3e953f55,0xbd493f78,0x3f18bf71,0xbf223f6d,0x3f75bf0e,0x3f80be79,0xbf4ebeac
.long 0x3f0e3f35,0xbe48bf6d,0x3e95bf7f,0xbf223f62,0x3f55bf35,0xbf7b3ec4,0xbf75bdc9,0x3f463ef1
.long 0xbe95bf6d,0x3dc93f7b,0xbf043f67,0x3f2cbf4e,0xbf753ec4,0x3f7fbe48,0x3f5c3edb,0xbf3ebf18
.long 0xbf353f80,0x3f352777,0x3f6dbec4,0x3ec4bf6d,0x3f3527b0,0x3f35bf80,0x3ec4bf6d,0xbf6d3ec4
.long 0x3f22bf80,0xbf623e48,0xbf783edb,0xbd493f4e,0xbf46a88d,0xbef13f7b,0xbe793f67,0x3f80bf18
.long 0xbf0e3f80,0x3f7bbec4,0x3f7fbef1,0xbe95bf22,0x3f55a70d,0x3e48bf6d,0x3dc9bf62,0xbf753f46
.long 0x3ef1bf80,0xbf7f3f0e,0xbf803f04,0x3f183edb,0xbf62a81f,0x3dc93f55,0x3d493f5c,0x3f4ebf67
.long 0xbec43f80,0x3f6dbf35,0x3f7bbf0e,0xbf55be48,0x3f6d28b1,0xbec4bf35,0xbe48bf55,0xbf0e3f7b
.long 0x3e95bf80,0xbf463f55,0xbf713f18,0x3f78bd49,0xbf75a70d,0x3f223f0e,0x3eac3f4e,0x3e79bf80
.long 0xbe483f80,0x3f0ebf6d,0x3f62bf22,0xbf7f3e95,0x3f7b2865,0xbf55bec4,0xbef1bf46,0x3dc93f75
.long 0x3dc9bf80,0xbe953f7b,0xbf4e3f2c,0x3f67bf04,0xbf7f27b1,0x3f753e48,0x3f183f3e,0xbedbbf5c
.long 0x3f35bf80,0xbf35a60d,0xbf6d3ec4,0xbec43f6d,0xbf35a70d,0xbf353f80,0xbec43f6d,0x3f6dbec4
.long 0xbe953f6d,0x3f7fbf0e,0x3f7dbf3e,0xbeacbf04,0x3f75bec4,0x3dc9bf55,0xbe16bf2c,0xbf713f5c
.long 0xbe48bf35,0xbf553f6d,0xbf463f75,0x3f62bdc9,0xbf7b3f35,0x3f0e3ec4,0x3f223e95,0x3ef1bf7f
.long 0x3f223ec4,0x3e95bf7b,0x3eacbf7d,0xbf783f2c,0x3f46bf6d,0xbf753e48,0xbf713e16,0x3e793f3e
.long 0xbf6da8c7,0x3ec43f35,0x3e483f55,0x3f0ebf7b,0xbec43f80,0x3f6dbf35,0x3f7bbf0e,0xbf55be48
.long 0x3f7fbec4,0xbf62be48,0xbf2cbf04,0x3e163f67,0xbdc9bf6d,0xbef13f7b,0xbf3e3f5c,0x3f7dbedb
.long 0xbf553f35,0x3f7bbec4,0x3f753dc9,0xbf46bef1,0x3f0e3f35,0xbe48bf6d,0x3e95bf7f,0xbf223f62
.long 0x3ef1bf6d,0xbf223f55,0xbf783eac,0x3f80be16,0xbf62bec4,0x3f463f0e,0x3e793f71,0xbd49bf7d
.long 0xbf353f80,0x3f35a731,0x3f6dbec4,0x3ec4bf6d,0x3f35a68e,0x3f35bf80,0x3ec4bf6d,0xbf6d3ec4
.long 0xbdc9bf35,0xbf753f55,0xbf5c3f71,0x3f2c3e16,0xbf7f3f35,0x3e953f0e,0x3f043eac,0x3f3ebf7d
.long 0x3f55a731,0x3e48bf6d,0x3dc9bf62,0xbf753f46,0x3f0ebf80,0xbf7b3ec4,0xbf7f3ef1,0x3e953f22
.long 0xbf753f35,0x3f463e48,0x3f3e3e79,0x3e16bf71,0x3e953f35,0x3f22bf7b,0x3f2cbf78,0xbf7d3eac
.long 0x3ec4bf80,0xbf6d3f35,0xbf7b3f0e,0x3f553e48,0xbf6da8dd,0x3ec43f35,0x3e483f55,0x3f0ebf7b
.long 0x3ef13f35,0x3dc9bf7b,0x3edbbf7d,0xbf5c3f3e,0x3f62bf35,0xbf7f3e48,0xbf67be16,0x3f043f2c
.long 0xbf7ba8cf,0x3f553ec4,0x3ef13f46,0xbdc9bf75,0xbe483f80,0x3f0ebf6d,0x3f62bf22,0xbf7f3e95
.long 0x3f46bf35,0xbf623f0e,0xbf7dbd49,0x3f713e79,0xbf22bf35,0x3ef13f55,0xbe163f80,0x3eacbf78
.long 0x3f35bf80,0xbf3527c2,0xbf6d3ec4,0xbec43f6d,0xbf35278d,0xbf353f80,0xbec43f6d,0x3f6dbec4
.long 0x3ef13ec4,0x3f46bf7b,0x3f18bf80,0xbf673e79,0x3f62bf6d,0xbf22be48,0xbf4e3d49,0xbedb3f78
.long 0xbf7b3f35,0x3f0e3ec4,0x3f223e95,0x3ef1bf7f,0x3e483f35,0x3f55bf6d,0x3f46bf75,0xbf623dc9
.long 0x3dc9bf6d,0xbf623f55,0xbf673f4e,0x3f5c3d49,0xbf7f3ec4,0x3ef13f0e,0x3edb3f18,0x3f04bf80
.long 0x3f6d28f3,0xbec4bf35,0xbe48bf55,0xbf0e3f7b,0x3ec4bf80,0xbf6d3f35,0xbf7b3f0e,0x3f553e48
.long 0xbf223f6d,0x3f75bf0e,0x3f80be79,0xbf4ebeac,0x3f463ec4,0xbe95bf55,0x3d49bf78,0xbf183f71
.long 0xbf0ebf35,0x3e483f6d,0xbe953f7f,0x3f22bf62,0xbf553f35,0x3f7bbec4,0x3f753dc9,0xbf46bef1
.long 0x3f75bec4,0xbf7f3e48,0xbf5cbedb,0x3f3e3f18,0xbe95bf6d,0x3dc93f7b,0xbf043f67,0x3f2cbf4e
.long 0xbf353f80,0x3f3528b5,0x3f6dbec4,0x3ec4bf6d,0x3f3528c2,0x3f35bf80,0x3ec4bf6d,0xbf6d3ec4
.long 0xbf46a92a,0xbef13f7b,0xbe793f67,0x3f80bf18,0xbf223f80,0x3f62be48,0x3f78bedb,0x3d49bf4e
.long 0x3f0ebf80,0xbf7b3ec4,0xbf7f3ef1,0x3e953f22,0xbf552754,0xbe483f6d,0xbdc93f62,0x3f75bf46
.long 0x3f62286e,0xbdc9bf55,0xbd49bf5c,0xbf4e3f67,0x3ef1bf80,0xbf7f3f0e,0xbf803f04,0x3f183edb
.long 0xbec43f80,0x3f6dbf35,0x3f7bbf0e,0xbf55be48,0x3f6d2904,0xbec4bf35,0xbe48bf55,0xbf0e3f7b
.long 0xbf75284b,0x3f223f0e,0x3eac3f4e,0x3e79bf80,0xbe953f80,0x3f46bf55,0x3f71bf18,0xbf783d49
.long 0x3e48bf80,0xbf0e3f6d,0xbf623f22,0x3f7fbe95,0xbf7ba7b0,0x3f553ec4,0x3ef13f46,0xbdc9bf75
.long 0x3f7fa804,0xbf75be48,0xbf18bf3e,0x3edb3f5c,0x3dc9bf80,0xbe953f7b,0xbf4e3f2c,0x3f67bf04
.long 0x3f35bf80,0xbf35a89a,0xbf6d3ec4,0xbec43f6d,0xbf35a8a8,0xbf353f80,0xbec43f6d,0x3f6dbec4
.long 0x3f75bec4,0x3dc9bf55,0xbe16bf2c,0xbf713f5c,0x3e95bf6d,0xbf7f3f0e,0xbf7d3f3e,0x3eac3f04
.long 0x3e483f35,0x3f55bf6d,0x3f46bf75,0xbf623dc9,0x3f7bbf35,0xbf0ebec4,0xbf22be95,0xbef13f7f
.long 0xbf463f6d,0x3f75be48,0x3f71be16,0xbe79bf3e,0x3f223ec4,0x3e95bf7b,0x3eacbf7d,0xbf783f2c
.long 0xbf6da90f,0x3ec43f35,0x3e483f55,0x3f0ebf7b,0xbec43f80,0x3f6dbf35,0x3f7bbf0e,0xbf55be48
.long 0xbdc9bf6d,0xbef13f7b,0xbf3e3f5c,0x3f7dbedb,0xbf7f3ec4,0x3f623e48,0x3f2c3f04,0xbe16bf67
.long 0x3f55bf35,0xbf7b3ec4,0xbf75bdc9,0x3f463ef1,0xbf0ebf35,0x3e483f6d,0xbe953f7f,0x3f22bf62
.long 0x3f623ec4,0xbf46bf0e,0xbe79bf71,0x3d493f7d,0x3ef1bf6d,0xbf223f55,0xbf783eac,0x3f80be16
.long 0xbf353f80,0x3f352880,0x3f6dbec4,0x3ec4bf6d,0x3f35288d,0x3f35bf80,0x3ec4bf6d,0xbf6d3ec4
.long 0xbf7f3f35,0x3e953f0e,0x3f043eac,0x3f3ebf7d,0x3dc93f35,0x3f75bf55,0x3f5cbf71,0xbf2cbe16
.long 0xbf552777,0xbe483f6d,0xbdc93f62,0x3f75bf46,0xbf0e3f80,0x3f7bbec4,0x3f7fbef1,0xbe95bf22
.long 0xbe95bf35,0xbf223f7b,0xbf2c3f78,0x3f7dbeac,0xbf753f35,0x3f463e48,0x3f3e3e79,0x3e16bf71
.long 0x3ec4bf80,0xbf6d3f35,0xbf7b3f0e,0x3f553e48,0xbf6da91a,0x3ec43f35,0x3e483f55,0x3f0ebf7b
.long 0x3f62bf35,0xbf7f3e48,0xbf67be16,0x3f043f2c,0xbef1bf35,0xbdc93f7b,0xbedb3f7d,0x3f5cbf3e
.long 0x3f7b2889,0xbf55bec4,0xbef1bf46,0x3dc93f75,0x3e48bf80,0xbf0e3f6d,0xbf623f22,0x3f7fbe95
.long 0x3f223f35,0xbef1bf55,0x3e16bf80,0xbeac3f78,0x3f46bf35,0xbf623f0e,0xbf7dbd49,0x3f713e79
.long 0x3f35bf80,0xbf35a84b,0xbf6d3ec4,0xbec43f6d,0xbf35a865,0xbf353f80,0xbec43f6d,0x3f6dbec4
.long 0x3f62bf6d,0xbf22be48,0xbf4e3d49,0xbedb3f78,0xbef1bec4,0xbf463f7b,0xbf183f80,0x3f67be79
.long 0x3f7bbf35,0xbf0ebec4,0xbf22be95,0xbef13f7f,0xbe48bf35,0xbf553f6d,0xbf463f75,0x3f62bdc9
.long 0x3f7fbec4,0xbef1bf0e,0xbedbbf18,0xbf043f80,0x3dc9bf6d,0xbf623f55,0xbf673f4e,0x3f5c3d49
.long 0x3f6d2926,0xbec4bf35,0xbe48bf55,0xbf0e3f7b,0x3ec4bf80,0xbf6d3f35,0xbf7b3f0e,0x3f553e48
.long 0x3f463ec4,0xbe95bf55,0x3d49bf78,0xbf183f71,0x3f22bf6d,0xbf753f0e,0xbf803e79,0x3f4e3eac
.long 0x3f0e3f35,0xbe48bf6d,0x3e95bf7f,0xbf223f62,0x3f55bf35,0xbf7b3ec4,0xbf75bdc9,0x3f463ef1
.long 0x3e953f6d,0xbdc9bf7b,0x3f04bf67,0xbf2c3f4e,0x3f75bec4,0xbf7f3e48,0xbf5cbedb,0x3f3e3f18
.long 0x0,0x40,0x3c00,0x3c00,0x8,0x48,0x3c50,0x3c10
.long 0x10,0x40,0x3ca0,0x3c20,0x18,0x48,0x3cf0,0x3c30
.long 0xa0,0xe0,0x3d40,0x3c40,0xa8,0xe8,0x3d90,0x3c50
.long 0xb0,0xe0,0x3de0,0x3c60,0xb8,0xe8,0x3e30,0x3c70
.long 0x140,0x180,0x3e80,0x3c80,0x148,0x188,0x3ed0,0x3c90
.long 0x150,0x180,0x3f20,0x3ca0,0x158,0x188,0x3f70,0x3cb0
.long 0x1e0,0x220,0x3fc0,0x3cc0,0x1e8,0x228,0x4010,0x3cd0
.long 0x1f0,0x220,0x4060,0x3ce0,0x1f8,0x228,0x40b0,0x3cf0
.long 0x280,0x2c0,0x3c08,0x3d00,0x288,0x2c8,0x3c58,0x3d10
.long 0x290,0x2c0,0x3ca8,0x3d20,0x298,0x2c8,0x3cf8,0x3d30
.long 0x320,0x360,0x3d48,0x3d40,0x328,0x368,0x3d98,0x3d50
.long 0x330,0x360,0x3de8,0x3d60,0x338,0x368,0x3e38,0x3d70
.long 0x3c0,0x400,0x3e88,0x3d80,0x3c8,0x408,0x3ed8,0x3d90
.long 0x3d0,0x400,0x3f28,0x3da0,0x3d8,0x408,0x3f78,0x3db0
.long 0x460,0x4a0,0x3fc8,0x3dc0,0x468,0x4a8,0x4018,0x3dd0
.long 0x470,0x4a0,0x4068,0x3de0,0x478,0x4a8,0x40b8,0x3df0
.long 0x500,0x540,0x3c10,0x3e00,0x508,0x548,0x3c60,0x3e10
.long 0x510,0x540,0x3cb0,0x3e20,0x518,0x548,0x3d00,0x3e30
.long 0x5a0,0x5e0,0x3d50,0x3e40,0x5a8,0x5e8,0x3da0,0x3e50
.long 0x5b0,0x5e0,0x3df0,0x3e60,0x5b8,0x5e8,0x3e40,0x3e70
.long 0x640,0x680,0x3e90,0x3e80,0x648,0x688,0x3ee0,0x3e90
.long 0x650,0x680,0x3f30,0x3ea0,0x658,0x688,0x3f80,0x3eb0
.long 0x6e0,0x720,0x3fd0,0x3ec0,0x6e8,0x728,0x4020,0x3ed0
.long 0x6f0,0x720,0x4070,0x3ee0,0x6f8,0x728,0x40c0,0x3ef0
.long 0x780,0x7c0,0x3c18,0x3f00,0x788,0x7c8,0x3c68,0x3f10
.long 0x790,0x7c0,0x3cb8,0x3f20,0x798,0x7c8,0x3d08,0x3f30
.long 0x820,0x860,0x3d58,0x3f40,0x828,0x868,0x3da8,0x3f50
.long 0x830,0x860,0x3df8,0x3f60,0x838,0x868,0x3e48,0x3f70
.long 0x8c0,0x900,0x3e98,0x3f80,0x8c8,0x908,0x3ee8,0x3f90
.long 0x8d0,0x900,0x3f38,0x3fa0,0x8d8,0x908,0x3f88,0x3fb0
.long 0x960,0x9a0,0x3fd8,0x3fc0,0x968,0x9a8,0x4028,0x3fd0
.long 0x970,0x9a0,0x4078,0x3fe0,0x978,0x9a8,0x40c8,0x3ff0
.long 0x7d030,0x17c040,0x27b040,0x1000,0x7d040,0x181000,0x27b040,0x1020
.long 0x82000,0x181010,0x27b040,0x1040,0x82010,0x181020,0x27b040,0x1060
.long 0x82020,0x181030,0x27b040,0x1080,0x82030,0x181040,0x27b040,0x10a0
.long 0x82040,0x186000,0x27b040,0x10c0,0x87000,0x186010,0x27b040,0x10e0
.long 0x87010,0x186020,0x27b040,0x1100,0x87020,0x186030,0x27b040,0x1120
.long 0x87030,0x186040,0x27b040,0x1140,0x87040,0x18b000,0x27b040,0x1160
.long 0x8c000,0x18b010,0x27b040,0x1180,0x8c010,0x18b020,0x27b040,0x11a0
.long 0x8c020,0x18b030,0x27b040,0x11c0,0x8c030,0x18b040,0x27b040,0x11e0
.long 0x8c040,0x190000,0x27b040,0x1200,0x91000,0x190010,0x27b040,0x1220
.long 0x91010,0x190020,0x27b040,0x1240,0x91020,0x190030,0x27b040,0x1260
.long 0x91030,0x190040,0x27b040,0x1280,0x91040,0x195000,0x27b040,0x12a0
.long 0x96000,0x195010,0x27b040,0x12c0,0x96010,0x195020,0x27b040,0x12e0
.long 0x96020,0x195030,0x27b040,0x1300,0x96030,0x195040,0x27b040,0x1320
.long 0x96040,0x19a000,0x27b040,0x1340,0x9b000,0x19a010,0x27b040,0x1360
.long 0x9b010,0x19a020,0x27b040,0x1380,0x9b020,0x19a030,0x27b040,0x13a0
.long 0x9b030,0x19a040,0x27b040,0x13c0,0x9b040,0x19f000,0x27b040,0x13e0
.long 0xa0000,0x19f010,0x27b040,0x1400,0xa0010,0x19f020,0x27b040,0x1420
.long 0xa0020,0x19f030,0x27b040,0x1440,0xa0030,0x19f040,0x27b040,0x1460
.long 0xa0040,0x1a4000,0x27b040,0x1480,0xa5000,0x1a4010,0x27b040,0x14a0
.long 0xa5010,0x1a4020,0x27b040,0x14c0,0xa5020,0x1a4030,0x27b040,0x14e0
.long 0xa5030,0x1a4040,0x27b040,0x1500,0xa5040,0x1a9000,0x27b040,0x1520
.long 0xaa000,0x1a9010,0x27b040,0x1540,0xaa010,0x1a9020,0x27b040,0x1560
.long 0xaa020,0x1a9030,0x27b040,0x1580,0xaa030,0x1a9040,0x27b040,0x15a0
.long 0xaa040,0x1ae000,0x27b040,0x15c0,0xaf000,0x1ae010,0x27b040,0x15e0
.long 0xaf010,0x1ae020,0x27b040,0x1600,0xaf020,0x1ae030,0x27b040,0x1620
.long 0xaf030,0x1ae040,0x27b040,0x1640,0xaf040,0x1b3000,0x27b040,0x1660
.long 0xb4000,0x1b3010,0x27b040,0x1680,0xb4010,0x1b3020,0x27b040,0x16a0
.long 0xb4020,0x1b3030,0x27b040,0x16c0,0xb4030,0x1b3040,0x27b040,0x16e0
.long 0xb4040,0x1b8000,0x27b040,0x1700,0xb9000,0x1b8010,0x27b040,0x1720
.long 0xb9010,0x1b8020,0x27b040,0x1740,0xb9020,0x1b8030,0x27b040,0x1760
.long 0xb9030,0x1b8040,0x27b040,0x1780,0xb9040,0x1bd000,0x27b040,0x17a0
.long 0xbe000,0x1bd010,0x27b040,0x17c0,0xbe010,0x1bd020,0x27b040,0x17e0
.long 0x3280,0xaf40,0x14000,0x1cc60,0x3290,0xaf50,0x14010,0x1cc70
.long 0x4600,0xaf60,0x14020,0x1cc80,0x4610,0xaf70,0x14030,0x1cc90
.long 0x4620,0xaf80,0x14040,0x1bd00,0x4630,0xaf90,0x14050,0x1bd10
.long 0x4640,0xc300,0x14060,0x1bd20,0x4650,0xc310,0x14070,0x1bd30
.long 0x4660,0xc320,0x14080,0x1bd40,0x4670,0xc330,0x14090,0x1bd50
.long 0x4680,0xc340,0x15400,0x1bd60,0x4690,0xc350,0x15410,0x1bd70
.long 0x3700,0xc360,0x15420,0x1bd80,0x3710,0xc370,0x15430,0x1bd90
.long 0x3720,0xc380,0x15440,0x1d100,0x3730,0xc390,0x15450,0x1d110
.long 0x3740,0xc800,0x15460,0x1d120,0x3750,0xc810,0x15470,0x1d130
.long 0x3760,0xc820,0x15480,0x1d140,0x3770,0xc830,0x15490,0x1d150
.long 0x3780,0xc840,0x14500,0x1d160,0x3790,0xc850,0x14510,0x1d170
.long 0x4b00,0xc860,0x14520,0x1d180,0x4b10,0xc870,0x14530,0x1d190
.long 0x4b20,0xc880,0x14540,0x1c200,0x4b30,0xc890,0x14550,0x1c210
.long 0x4b40,0xdc00,0x14560,0x1c220,0x4b50,0xdc10,0x14570,0x1c230
.long 0x4b60,0xdc20,0x14580,0x1c240,0x4b70,0xdc30,0x14590,0x1c250
.long 0x4b80,0xdc40,0x15900,0x1c260,0x4b90,0xdc50,0x15910,0x1c270
.long 0x5000,0xdc60,0x15920,0x1c280,0x5010,0xdc70,0x15930,0x1c290
.long 0x5020,0xdc80,0x15940,0x1d600,0x5030,0xdc90,0x15950,0x1d610
.long 0x5040,0xcd00,0x15960,0x1d620,0x5050,0xcd10,0x15970,0x1d630
.long 0x5060,0xcd20,0x15980,0x1d640,0x5070,0xcd30,0x15990,0x1d650
.long 0x5080,0xcd40,0x14a00,0x1d660,0x5090,0xcd50,0x14a10,0x1d670
.long 0x6400,0xcd60,0x14a20,0x1d680,0x6410,0xcd70,0x14a30,0x1d690
.long 0x6420,0xcd80,0x14a40,0x1c700,0x6430,0xcd90,0x14a50,0x1c710
.long 0x6440,0xe100,0x14a60,0x1c720,0x6450,0xe110,0x14a70,0x1c730
.long 0x6460,0xe120,0x14a80,0x1c740,0x6470,0xe130,0x14a90,0x1c750
.long 0x6480,0xe140,0x15e00,0x1c760,0x6490,0xe150,0x15e10,0x1c770
.long 0x5500,0xe160,0x15e20,0x1c780,0x5510,0xe170,0x15e30,0x1c790
.long 0x5520,0xe180,0x15e40,0x1db00,0x5530,0xe190,0x15e50,0x1db10
.long 0x5540,0xd200,0x15e60,0x1db20,0x5550,0xd210,0x15e70,0x1db30
.long 0x5560,0xd220,0x15e80,0x1db40,0x5570,0xd230,0x15e90,0x1db50
.long 0x5580,0xd240,0x14f00,0x1db60,0x5590,0xd250,0x14f10,0x1db70
.long 0x6900,0xd260,0x14f20,0x1db80,0x6910,0xd270,0x14f30,0x1db90
.long 0x24920,0x1e080,0x5f040,0xa0000,0x24930,0x1e090,0x5f050,0xa0010
.long 0x24940,0x20800,0x5f060,0xa0020,0x24950,0x20810,0x5f070,0xa0030
.long 0x24960,0x20820,0x5f080,0xa0040,0x24970,0x20830,0x5f090,0xa0050
.long 0x24980,0x20840,0x61800,0xa0060,0x24990,0x20850,0x61810,0xa0070
.long 0x23a00,0x20860,0x61820,0xa0080,0x23a10,0x20870,0x61830,0xa0090
.long 0x23a20,0x20880,0x61840,0xa2800,0x23a30,0x20890,0x61850,0xa2810
.long 0x23a40,0x23000,0x61860,0xa2820,0x23a50,0x23010,0x61870,0xa2830
.long 0x23a60,0x23020,0x61880,0xa2840,0x23a70,0x23030,0x61890,0xa2850
.long 0x23a80,0x23040,0x64000,0xa2860,0x23a90,0x23050,0x64010,0xa2870
.long 0x24e00,0x23060,0x64020,0xa2880,0x24e10,0x23070,0x64030,0xa2890
.long 0x24e20,0x23080,0x64040,0xa5000,0x24e30,0x23090,0x64050,0xa5010
.long 0x24e40,0x25800,0x64060,0xa5020,0x24e50,0x25810,0x64070,0xa5030
.long 0x24e60,0x25820,0x64080,0xa5040,0x24e70,0x25830,0x64090,0xa5050
.long 0x24e80,0x25840,0x66800,0xa5060,0x24e90,0x25850,0x66810,0xa5070
.long 0x23f00,0x25860,0x66820,0xa5080,0x23f10,0x25870,0x66830,0xa5090
.long 0x23f20,0x25880,0x66840,0xa7800,0x23f30,0x25890,0x66850,0xa7810
.long 0x23f40,0x28000,0x66860,0xa7820,0x23f50,0x28010,0x66870,0xa7830
.long 0x23f60,0x28020,0x66880,0xa7840,0x23f70,0x28030,0x66890,0xa7850
.long 0x23f80,0x28040,0x69000,0xa7860,0x23f90,0x28050,0x69010,0xa7870
.long 0x25300,0x28060,0x69020,0xa7880,0x25310,0x28070,0x69030,0xa7890
.long 0x25320,0x28080,0x69040,0xaa000,0x25330,0x28090,0x69050,0xaa010
.long 0x25340,0x2a800,0x69060,0xaa020,0x25350,0x2a810,0x69070,0xaa030
.long 0x25360,0x2a820,0x69080,0xaa040,0x25370,0x2a830,0x69090,0xaa050
.long 0x25380,0x2a840,0x6b800,0xaa060,0x25390,0x2a850,0x6b810,0xaa070
.long 0x25800,0x2a860,0x6b820,0xaa080,0x25810,0x2a870,0x6b830,0xaa090
.long 0x25820,0x2a880,0x6b840,0xac800,0x25830,0x2a890,0x6b850,0xac810
.long 0x25840,0x2d000,0x6b860,0xac820,0x25850,0x2d010,0x6b870,0xac830
.long 0x25860,0x2d020,0x6b880,0xac840,0x25870,0x2d030,0x6b890,0xac850
.long 0x25880,0x2d040,0x6e000,0xac860,0x25890,0x2d050,0x6e010,0xac870
.long 0x26c00,0x2d060,0x6e020,0xac880,0x26c10,0x2d070,0x6e030,0xac890
.long 0x26c20,0x2d080,0x6e040,0xaf000,0x26c30,0x2d090,0x6e050,0xaf010
.long 0x26c40,0x2f800,0x6e060,0xaf020,0x26c50,0x2f810,0x6e070,0xaf030
.long 0xde860,0x11f820,0x5000,0x5000,0xde870,0x11f830,0x5008,0x5008
.long 0xde880,0x11f840,0x5010,0x59c0,0xde890,0x11f850,0x5018,0x59c8
.long 0xe1000,0x11f860,0x5140,0x5140,0xe1010,0x11f870,0x5148,0x5148
.long 0xe1020,0x11f880,0x5150,0x5b00,0xe1030,0x11f890,0x5158,0x5b08
.long 0xe1040,0x122000,0x5280,0x5280,0xe1050,0x122010,0x5288,0x5288
.long 0xe1060,0x122020,0x5290,0x5c40,0xe1070,0x122030,0x5298,0x5c48
.long 0xe1080,0x122040,0x53c0,0x53c0,0xe1090,0x122050,0x53c8,0x53c8
.long 0xe3800,0x122060,0x53d0,0x5d80,0xe3810,0x122070,0x53d8,0x5d88
.long 0xe3820,0x122080,0x50a0,0x50a0,0xe3830,0x122090,0x50a8,0x50a8
.long 0xe3840,0x124800,0x50b0,0x5a60,0xe3850,0x124810,0x50b8,0x5a68
.long 0xe3860,0x124820,0x51e0,0x51e0,0xe3870,0x124830,0x51e8,0x51e8
.long 0xe3880,0x124840,0x51f0,0x5ba0,0xe3890,0x124850,0x51f8,0x5ba8
.long 0xe6000,0x124860,0x5320,0x5320,0xe6010,0x124870,0x5328,0x5328
.long 0xe6020,0x124880,0x5330,0x5ce0,0xe6030,0x124890,0x5338,0x5ce8
.long 0xe6040,0x127000,0x5460,0x5460,0xe6050,0x127010,0x5468,0x5468
.long 0xe6060,0x127020,0x5470,0x5e20,0xe6070,0x127030,0x5478,0x5e28
.long 0xe6080,0x127040,0x5050,0x5050,0xe6090,0x127050,0x5058,0x5058
.long 0xe8800,0x127060,0x5060,0x5a10,0xe8810,0x127070,0x5068,0x5a18
.long 0xe8820,0x127080,0x5190,0x5190,0xe8830,0x127090,0x5198,0x5198
.long 0xe8840,0x129800,0x51a0,0x5b50,0xe8850,0x129810,0x51a8,0x5b58
.long 0xe8860,0x129820,0x52d0,0x52d0,0xe8870,0x129830,0x52d8,0x52d8
.long 0xe8880,0x129840,0x52e0,0x5c90,0xe8890,0x129850,0x52e8,0x5c98
.long 0xeb000,0x129860,0x5410,0x5410,0xeb010,0x129870,0x5418,0x5418
.long 0xeb020,0x129880,0x5420,0x5dd0,0xeb030,0x129890,0x5428,0x5dd8
.long 0xeb040,0x12c000,0x50f0,0x50f0,0xeb050,0x12c010,0x50f8,0x50f8
.long 0xeb060,0x12c020,0x5100,0x5ab0,0xeb070,0x12c030,0x5108,0x5ab8
.long 0xeb080,0x12c040,0x5230,0x5230,0xeb090,0x12c050,0x5238,0x5238
.long 0xed800,0x12c060,0x5240,0x5bf0,0xed810,0x12c070,0x5248,0x5bf8
.long 0xed820,0x12c080,0x5370,0x5370,0xed830,0x12c090,0x5378,0x5378
.long 0xed840,0x12e800,0x5380,0x5d30,0xed850,0x12e810,0x5388,0x5d38
.long 0xed860,0x12e820,0x54b0,0x54b0,0xed870,0x12e830,0x54b8,0x54b8
.long 0xed880,0x12e840,0x54c0,0x5e70,0xed890,0x12e850,0x54c8,0x5e78
.long 0xc880,0xcd80,0xd280,0x10480,0xc888,0xcd88,0xd288,0x10488
.long 0xc890,0xcd90,0xd290,0x10490,0xc898,0xcd98,0xd298,0x10498
.long 0xc9c0,0xcec0,0xd3c0,0x105c0,0xc9c8,0xcec8,0xd3c8,0x105c8
.long 0xc9d0,0xced0,0xd3d0,0x105d0,0xc9d8,0xced8,0xd3d8,0x105d8
.long 0xcb00,0xd000,0xd500,0x10700,0xcb08,0xd008,0xd508,0x10708
.long 0xcb10,0xd010,0xd510,0x10710,0xcb18,0xd018,0xd518,0x10718
.long 0xcc40,0xd140,0xd640,0x10840,0xcc48,0xd148,0xd648,0x10848
.long 0xcc50,0xd150,0xd650,0x10850,0xcc58,0xd158,0xd658,0x10858
.long 0xc920,0xce20,0xdd20,0x10f20,0xc928,0xce28,0xdd28,0x10f28
.long 0xc930,0xce30,0xdd30,0x10f30,0xc938,0xce38,0xdd38,0x10f38
.long 0xca60,0xcf60,0xde60,0x11060,0xca68,0xcf68,0xde68,0x11068
.long 0xca70,0xcf70,0xde70,0x11070,0xca78,0xcf78,0xde78,0x11078
.long 0xcba0,0xd0a0,0xdfa0,0x111a0,0xcba8,0xd0a8,0xdfa8,0x111a8
.long 0xcbb0,0xd0b0,0xdfb0,0x111b0,0xcbb8,0xd0b8,0xdfb8,0x111b8
.long 0xcce0,0xd1e0,0xe0e0,0x112e0,0xcce8,0xd1e8,0xe0e8,0x112e8
.long 0xccf0,0xd1f0,0xe0f0,0x112f0,0xccf8,0xd1f8,0xe0f8,0x112f8
.long 0xd320,0xd820,0xeb80,0x11d80,0xd328,0xd828,0xeb88,0x11d88
.long 0xd330,0xd830,0xeb90,0x11d90,0xd338,0xd838,0xeb98,0x11d98
.long 0xd460,0xd960,0xecc0,0x11ec0,0xd468,0xd968,0xecc8,0x11ec8
.long 0xd470,0xd970,0xecd0,0x11ed0,0xd478,0xd978,0xecd8,0x11ed8
.long 0xd5a0,0xdaa0,0xee00,0x12000,0xd5a8,0xdaa8,0xee08,0x12008
.long 0xd5b0,0xdab0,0xee10,0x12010,0xd5b8,0xdab8,0xee18,0x12018
.long 0xd6e0,0xdbe0,0xef40,0x12140,0xd6e8,0xdbe8,0xef48,0x12148
.long 0xd6f0,0xdbf0,0xef50,0x12150,0xd6f8,0xdbf8,0xef58,0x12158
.long 0xd780,0xdc80,0xf620,0x12820,0xd788,0xdc88,0xf628,0x12828
.long 0xd790,0xdc90,0xf630,0x12830,0xd798,0xdc98,0xf638,0x12838
.long 0xd8c0,0xddc0,0xf760,0x12960,0xd8c8,0xddc8,0xf768,0x12968
.long 0xd8d0,0xddd0,0xf770,0x12970,0xd8d8,0xddd8,0xf778,0x12978
.long 0xda00,0xdf00,0xf8a0,0x12aa0,0xda08,0xdf08,0xf8a8,0x12aa8
.long 0xda10,0xdf10,0xf8b0,0x12ab0,0xda18,0xdf18,0xf8b8,0x12ab8
.long 0xdb40,0xe040,0xf9e0,0x12be0,0xdb48,0xe048,0xf9e8,0x12be8
.long 0xdb50,0xe050,0xf9f0,0x12bf0,0xdb58,0xe058,0xf9f8,0x12bf8
.long 0x40,0xae0,0xa40,0x21e80,0x48,0xae8,0xa48,0x22388
.long 0x50,0xaf0,0xa50,0x22890,0x58,0xaf8,0xa58,0x22d98
.long 0x180,0xc20,0xb80,0x232a0,0x188,0xc28,0xb88,0x237a8
.long 0x190,0xc30,0xb90,0x23cb0,0x198,0xc38,0xb98,0x241b8
.long 0x2c0,0xd60,0xcc0,0x246c0,0x2c8,0xd68,0xcc8,0x24bc8
.long 0x2d0,0xd70,0xcd0,0x250d0,0x2d8,0xd78,0xcd8,0x255d8
.long 0x400,0xea0,0xe00,0x25ae0,0x408,0xea8,0xe08,0x25fe8
.long 0x410,0xeb0,0xe10,0x264f0,0x418,0xeb8,0xe18,0x269f8
.long 0x60,0xb00,0xa60,0x21e88,0x68,0xb08,0xa68,0x22390
.long 0x70,0xb10,0xa70,0x22898,0x78,0xb18,0xa78,0x22da0
.long 0x1a0,0xc40,0xba0,0x232a8,0x1a8,0xc48,0xba8,0x237b0
.long 0x1b0,0xc50,0xbb0,0x23cb8,0x1b8,0xc58,0xbb8,0x241c0
.long 0x2e0,0xd80,0xce0,0x246c8,0x2e8,0xd88,0xce8,0x24bd0
.long 0x2f0,0xd90,0xcf0,0x250d8,0x2f8,0xd98,0xcf8,0x255e0
.long 0x420,0xec0,0xe20,0x25ae8,0x428,0xec8,0xe28,0x25ff0
.long 0x430,0xed0,0xe30,0x264f8,0x438,0xed8,0xe38,0x26a00
.long 0xe0,0xf40,0x14e0,0x21e90,0xe8,0xf48,0x14e8,0x22398
.long 0xf0,0xf50,0x14f0,0x228a0,0xf8,0xf58,0x14f8,0x22da8
.long 0x220,0x1080,0x1620,0x232b0,0x228,0x1088,0x1628,0x237b8
.long 0x230,0x1090,0x1630,0x23cc0,0x238,0x1098,0x1638,0x241c8
.long 0x360,0x11c0,0x1760,0x246d0,0x368,0x11c8,0x1768,0x24bd8
.long 0x370,0x11d0,0x1770,0x250e0,0x378,0x11d8,0x1778,0x255e8
.long 0x4a0,0x1300,0x18a0,0x25af0,0x4a8,0x1308,0x18a8,0x25ff8
.long 0x4b0,0x1310,0x18b0,0x26500,0x4b8,0x1318,0x18b8,0x26a08
.long 0x100,0xf60,0x1500,0x21e98,0x108,0xf68,0x1508,0x223a0
.long 0x110,0xf70,0x1510,0x228a8,0x118,0xf78,0x1518,0x22db0
.long 0x240,0x10a0,0x1640,0x232b8,0x248,0x10a8,0x1648,0x237c0
.long 0x250,0x10b0,0x1650,0x23cc8,0x258,0x10b8,0x1658,0x241d0
.long 0x380,0x11e0,0x1780,0x246d8,0x388,0x11e8,0x1788,0x24be0
.long 0x390,0x11f0,0x1790,0x250e8,0x398,0x11f8,0x1798,0x255f0
.long 0x4c0,0x1320,0x18c0,0x25af8,0x4c8,0x1328,0x18c8,0x26000
.long 0x4d0,0x1330,0x18d0,0x26508,0x4d8,0x1338,0x18d8,0x26a10
.long 0x0,0x8000,0x14040,0x0,0x10,0x8008,0x140f0,0x80
.long 0x20,0x8010,0x141a0,0x100,0x30,0x8018,0x14250,0x180
.long 0x40,0x8020,0x14300,0x200,0x50,0x8028,0x143b0,0x280
.long 0x60,0x8030,0x14460,0x300,0x70,0x8038,0x14510,0x380
.long 0x80,0x8040,0x145c0,0x0,0x90,0x8048,0x14670,0x80
.long 0xa0,0x8050,0x14720,0x100,0xb0,0x8058,0x147d0,0x180
.long 0xc0,0x8060,0x14880,0x200,0xd0,0x8068,0x14930,0x280
.long 0xe0,0x8070,0x149e0,0x300,0xf0,0x8078,0x14a90,0x380
.long 0x100,0x8080,0x14b40,0x0,0x110,0x8088,0x14bf0,0x80
.long 0x120,0x8090,0x14ca0,0x100,0x130,0x8098,0x14d50,0x180
.long 0x140,0x80a0,0x14e00,0x200,0x150,0x80a8,0x14eb0,0x280
.long 0x160,0x80b0,0x14f60,0x300,0x170,0x80b8,0x15010,0x380
.long 0x180,0x80c0,0x150c0,0x0,0x190,0x80c8,0x15170,0x80
.long 0x1a0,0x80d0,0x15220,0x100,0x1b0,0x80d8,0x152d0,0x180
.long 0x1c0,0x80e0,0x15380,0x200,0x1d0,0x80e8,0x15430,0x280
.long 0x1e0,0x80f0,0x154e0,0x300,0x1f0,0x80f8,0x15590,0x380
.long 0x200,0x8100,0x14048,0x0,0x210,0x8108,0x140f8,0x80
.long 0x220,0x8110,0x141a8,0x100,0x230,0x8118,0x14258,0x180
.long 0x240,0x8120,0x14308,0x200,0x250,0x8128,0x143b8,0x280
.long 0x260,0x8130,0x14468,0x300,0x270,0x8138,0x14518,0x380
.long 0x280,0x8140,0x145c8,0x0,0x290,0x8148,0x14678,0x80
.long 0x2a0,0x8150,0x14728,0x100,0x2b0,0x8158,0x147d8,0x180
.long 0x2c0,0x8160,0x14888,0x200,0x2d0,0x8168,0x14938,0x280
.long 0x2e0,0x8170,0x149e8,0x300,0x2f0,0x8178,0x14a98,0x380
.long 0x300,0x8180,0x14b48,0x0,0x310,0x8188,0x14bf8,0x80
.long 0x320,0x8190,0x14ca8,0x100,0x330,0x8198,0x14d58,0x180
.long 0x340,0x81a0,0x14e08,0x200,0x350,0x81a8,0x14eb8,0x280
.long 0x360,0x81b0,0x14f68,0x300,0x370,0x81b8,0x15018,0x380
.long 0x380,0x81c0,0x150c8,0x0,0x390,0x81c8,0x15178,0x80
.long 0x3a0,0x81d0,0x15228,0x100,0x3b0,0x81d8,0x152d8,0x180
.long 0x3c0,0x81e0,0x15388,0x200,0x3d0,0x81e8,0x15438,0x280
.long 0x3e0,0x81f0,0x154e8,0x300,0x3f0,0x81f8,0x15598,0x380
.long 0x15a60,0x17c40,0x1b000,0x1d800,0x15a70,0x17c50,0x1b010,0x1d810
.long 0x15a80,0x17c60,0x1b020,0x1d820,0x15a90,0x17c70,0x1b030,0x1d830
.long 0x15aa0,0x17c80,0x1b040,0x1d840,0x15ab0,0x17c90,0x1b050,0x1d850
.long 0x15ad0,0x18600,0x1b060,0x1d860,0x15ae0,0x18610,0x1b070,0x1d870
.long 0x15af0,0x18620,0x1b080,0x1d880,0x15b00,0x18630,0x1b090,0x1d890
.long 0x15b10,0x18640,0x1b0a0,0x1d8a0,0x15b20,0x18650,0x1b0b0,0x1d8b0
.long 0x15b30,0x18660,0x1b0c0,0x1d8c0,0x15b40,0x18670,0x1b0d0,0x1d8d0
.long 0x15b50,0x18680,0x1b0e0,0x1d8e0,0x15b60,0x18690,0x1b0f0,0x1d8f0
.long 0x15b80,0x19000,0x1b100,0x1d900,0x15b90,0x19010,0x1b110,0x1d910
.long 0x15ba0,0x19020,0x1b120,0x1d920,0x15bb0,0x19030,0x1b130,0x1d930
.long 0x15bc0,0x19040,0x1b140,0x1d940,0x15bd0,0x19050,0x1b150,0x1d950
.long 0x15be0,0x19060,0x1b160,0x1d960,0x15bf0,0x19070,0x1b170,0x1d970
.long 0x15c00,0x19080,0x1b180,0x1d980,0x15c10,0x19090,0x1b190,0x1d990
.long 0x15c30,0x19a00,0x1b1a0,0x1d9a0,0x15c40,0x19a10,0x1b1b0,0x1d9b0
.long 0x15c50,0x19a20,0x1b1c0,0x1d9c0,0x15c60,0x19a30,0x1b1d0,0x1d9d0
.long 0x15c70,0x19a40,0x1b1e0,0x1d9e0,0x15c80,0x19a50,0x1b1f0,0x1d9f0
.long 0x15c90,0x19a60,0x1b200,0x1da00,0x15ca0,0x19a70,0x1b210,0x1da10
.long 0x15cb0,0x19a80,0x1b220,0x1da20,0x15cc0,0x19a90,0x1b230,0x1da30
.long 0x15ce0,0x1a400,0x1b240,0x1da40,0x15cf0,0x1a410,0x1b250,0x1da50
.long 0x15d00,0x1a420,0x1b260,0x1da60,0x15d10,0x1a430,0x1b270,0x1da70
.long 0x15d20,0x1a440,0x1b280,0x1da80,0x15d30,0x1a450,0x1b290,0x1da90
.long 0x15d40,0x1a460,0x1b2a0,0x1daa0,0x15d50,0x1a470,0x1b2b0,0x1dab0
.long 0x15d60,0x1a480,0x1b2c0,0x1dac0,0x15d70,0x1a490,0x1b2d0,0x1dad0
.long 0x15d90,0x1ae00,0x1b2e0,0x1dae0,0x15da0,0x1ae10,0x1b2f0,0x1daf0
.long 0x15db0,0x1ae20,0x1b300,0x1db00,0x15dc0,0x1ae30,0x1b310,0x1db10
.long 0x15dd0,0x1ae40,0x1b320,0x1db20,0x15de0,0x1ae50,0x1b330,0x1db30
.long 0x15df0,0x1ae60,0x1b340,0x1db40,0x15e00,0x1ae70,0x1b350,0x1db50
.long 0x15e10,0x1ae80,0x1b360,0x1db60,0x15e20,0x1ae90,0x1b370,0x1db70
.long 0x15e40,0x1b800,0x1b380,0x1db80,0x15e50,0x1b810,0x1b390,0x1db90
.long 0x15e60,0x1b820,0x1b3a0,0x1dba0,0x15e70,0x1b830,0x1b3b0,0x1dbb0
.long 0x15e80,0x1b840,0x1b3c0,0x1dbc0,0x15e90,0x1b850,0x1b3d0,0x1dbd0
.long 0x15ea0,0x1b860,0x1b3e0,0x1dbe0,0x15eb0,0x1b870,0x1b3f0,0x1dbf0
.long 0xa5543f80,0x261fbf80,0x3f35bf35,0xbf353f35,0x3f808000,0xbf80a5d4,0xbf35bf35,0x3f353f35
.long 0x3dc93f80,0xbe95bf7b,0x3f18bf3e,0xbedb3f5c,0x3f7f8000,0xbf753e48,0xbf4ebf2c,0x3f673f04
.long 0x3e483f80,0xbf0ebf6d,0x3ef1bf46,0xbdc93f75,0x3f7b8000,0xbf553ec4,0xbf62bf22,0x3f7f3e95
.long 0x3e953f80,0xbf46bf55,0x3eacbf4e,0x3e793f80,0x3f758000,0xbf223f0e,0xbf71bf18,0x3f783d49
.long 0x3ec43f80,0xbf6dbf35,0x3e48bf55,0x3f0e3f7b,0x3f6d8000,0xbec43f35,0xbf7bbf0e,0x3f55be48
.long 0x3ef13f80,0xbf7fbf0e,0x3d49bf5c,0x3f4e3f67,0x3f628000,0xbdc93f55,0xbf80bf04,0x3f18bedb
.long 0x3f0e3f80,0xbf7bbec4,0xbdc9bf62,0x3f753f46,0x3f558000,0x3e483f6d,0xbf7fbef1,0x3e95bf22
.long 0x3f223f80,0xbf62be48,0xbe79bf67,0x3f803f18,0x3f468000,0x3ef13f7b,0xbf78bedb,0xbd49bf4e
.long 0xa7423f80,0xa60dbf80,0x3f35bf35,0xbf353f35,0x3f802654,0xbf80a69f,0xbf35bf35,0x3f353f35
.long 0x3ef13f6d,0xbf22bf55,0x3e79bf71,0xbd493f7d,0x3f62bec4,0xbf463f0e,0xbf78beac,0x3f803e16
.long 0x3f553f35,0xbf7bbec4,0xbe95bf7f,0x3f223f62,0x3f0ebf35,0xbe483f6d,0xbf753dc9,0x3f46bef1
.long 0x3f7f3ec4,0xbf623e48,0xbf3ebf5c,0x3f7d3edb,0x3dc9bf6d,0x3ef13f7b,0xbf2c3f04,0x3e16bf67
.long 0x3f6da68d,0xbec43f35,0xbf7bbf0e,0x3f55be48,0xbec4bf80,0x3f6d3f35,0xbe483f55,0xbf0ebf7b
.long 0x3f22bec4,0x3e953f7b,0xbf71be16,0x3e79bf3e,0xbf46bf6d,0x3f753e48,0x3eac3f7d,0xbf78bf2c
.long 0x3e48bf35,0x3f553f6d,0xbf223e95,0xbef1bf7f,0xbf7bbf35,0x3f0ebec4,0x3f463f75,0xbf62bdc9
.long 0xbe95bf6d,0x3f7f3f0e,0xbe163f2c,0xbf71bf5c,0xbf75bec4,0xbdc9bf55,0x3f7d3f3e,0xbeac3f04
.long 0xa7773f80,0x258dbf80,0x3f35bf35,0xbf353f35,0x3f8026d4,0xbf80a7c2,0xbf35bf35,0x3f353f35
.long 0x3f463f35,0xbf62bf0e,0xbe16bf80,0x3eac3f78,0x3f22bf35,0xbef13f55,0xbf7d3d49,0x3f71be79
.long 0x3f7ba58e,0xbf553ec4,0xbf62bf22,0x3f7f3e95,0xbe48bf80,0x3f0e3f6d,0xbef13f46,0x3dc9bf75
.long 0x3ef1bf35,0x3dc93f7b,0xbf673e16,0x3f04bf2c,0xbf62bf35,0x3f7f3e48,0x3edb3f7d,0xbf5cbf3e
.long 0xbec4bf80,0x3f6d3f35,0xbe483f55,0xbf0ebf7b,0xbf6d270d,0x3ec4bf35,0x3f7b3f0e,0xbf553e48
.long 0xbf75bf35,0x3f46be48,0x3f2c3f78,0xbf7dbeac,0xbe953f35,0xbf22bf7b,0x3f3ebe79,0x3e163f71
.long 0xbf55a777,0xbe48bf6d,0x3f7f3ef1,0xbe953f22,0x3f0e3f80,0xbf7bbec4,0xbdc9bf62,0x3f753f46
.long 0xbdc93f35,0xbf75bf55,0x3f04beac,0x3f3e3f7d,0x3f7f3f35,0xbe953f0e,0xbf5cbf71,0x3f2cbe16
.long 0xa7963f80,0x268dbf80,0x3f35bf35,0xbf353f35,0x3f80271f,0xbf80268d,0xbf35bf35,0x3f353f35
.long 0x3f753ec4,0xbf7fbe48,0xbf04bf67,0x3f2c3f4e,0x3e95bf6d,0xbdc93f7b,0xbf5c3edb,0x3f3ebf18
.long 0x3f0ebf35,0xbe483f6d,0xbf753dc9,0x3f46bef1,0xbf55bf35,0x3f7b3ec4,0x3e953f7f,0xbf22bf62
.long 0xbf22bf6d,0x3f753f0e,0x3d493f78,0xbf18bf71,0xbf463ec4,0x3e95bf55,0x3f803e79,0xbf4e3eac
.long 0xbf6d2754,0x3ec4bf35,0x3f7b3f0e,0xbf553e48,0x3ec43f80,0xbf6dbf35,0x3e48bf55,0x3f0e3f7b
.long 0x3dc93f6d,0xbf62bf55,0x3edbbf18,0x3f043f80,0x3f7f3ec4,0xbef13f0e,0xbf67bf4e,0x3f5cbd49
.long 0x3f7b3f35,0xbf0e3ec4,0xbf46bf75,0x3f623dc9,0x3e48bf35,0x3f553f6d,0xbf223e95,0xbef1bf7f
.long 0x3ef1bec4,0x3f463f7b,0xbf4ebd49,0xbedbbf78,0xbf62bf6d,0x3f22be48,0x3f183f80,0xbf67be79
.long 0xa7b13f80,0x281fbf80,0x3f35bf35,0xbf353f35,0x3f802754,0xbf80a7f7,0xbf35bf35,0x3f353f35
.long 0x3f7f2816,0xbf753e48,0xbf4ebf2c,0x3f673f04,0xbdc9bf80,0x3e953f7b,0xbf183f3e,0x3edbbf5c
.long 0xbe48bf80,0x3f0e3f6d,0xbef13f46,0x3dc9bf75,0xbf7b260e,0x3f55bec4,0x3f623f22,0xbf7fbe95
.long 0xbf75a7b1,0x3f22bf0e,0x3f713f18,0xbf78bd49,0x3e953f80,0xbf46bf55,0x3eacbf4e,0x3e793f80
.long 0x3ec43f80,0xbf6dbf35,0x3e48bf55,0x3f0e3f7b,0x3f6da78d,0xbec43f35,0xbf7bbf0e,0x3f55be48
.long 0x3f6226d4,0xbdc93f55,0xbf80bf04,0x3f18bedb,0xbef1bf80,0x3f7f3f0e,0xbd493f5c,0xbf4ebf67
.long 0xbf0ebf80,0x3f7b3ec4,0x3dc93f62,0xbf75bf46,0xbf55a7f7,0xbe48bf6d,0x3f7f3ef1,0xbe953f22
.long 0xbf46270d,0xbef1bf7b,0x3f783edb,0x3d493f4e,0x3f223f80,0xbf62be48,0xbe79bf67,0x3f803f18
.long 0x26d43f80,0x2730bf80,0x3f35bf35,0xbf353f35,0x3f802842,0xbf80a60d,0xbf35bf35,0x3f353f35
.long 0x3f62bec4,0xbf463f0e,0xbf78beac,0x3f803e16,0xbef1bf6d,0x3f223f55,0xbe793f71,0x3d49bf7d
.long 0xbf55bf35,0x3f7b3ec4,0x3e953f7f,0xbf22bf62,0xbf0e3f35,0x3e48bf6d,0x3f75bdc9,0xbf463ef1
.long 0xbdc93f6d,0xbef1bf7b,0x3f2cbf04,0xbe163f67,0x3f7f3ec4,0xbf623e48,0xbf3ebf5c,0x3f7d3edb
.long 0x3f6da7b1,0xbec43f35,0xbf7bbf0e,0x3f55be48,0xbec4bf80,0x3f6d3f35,0xbe483f55,0xbf0ebf7b
.long 0xbf46bf6d,0x3f753e48,0x3eac3f7d,0xbf78bf2c,0xbf223ec4,0xbe95bf7b,0x3f713e16,0xbe793f3e
.long 0xbe483f35,0xbf55bf6d,0x3f22be95,0x3ef13f7f,0x3f7b3f35,0xbf0e3ec4,0xbf46bf75,0x3f623dc9
.long 0x3f753ec4,0x3dc93f55,0xbf7dbf3e,0x3eacbf04,0xbe95bf6d,0x3f7f3f0e,0xbe163f2c,0xbf71bf5c
.long 0xa7e53f80,0x2839bf80,0x3f35bf35,0xbf353f35,0x3f80279f,0xbf80a816,0xbf35bf35,0x3f353f35
.long 0x3f22bf35,0xbef13f55,0xbf7d3d49,0x3f71be79,0xbf46bf35,0x3f623f0e,0x3e163f80,0xbeacbf78
.long 0xbf7ba7e5,0x3f55bec4,0x3f623f22,0xbf7fbe95,0x3e483f80,0xbf0ebf6d,0x3ef1bf46,0xbdc93f75
.long 0x3f623f35,0xbf7fbe48,0xbedbbf7d,0x3f5c3f3e,0x3ef1bf35,0x3dc93f7b,0xbf673e16,0x3f04bf2c
.long 0xbec4bf80,0x3f6d3f35,0xbe483f55,0xbf0ebf7b,0xbf6d27d4,0x3ec4bf35,0x3f7b3f0e,0xbf553e48
.long 0xbe953f35,0xbf22bf7b,0x3f3ebe79,0x3e163f71,0x3f753f35,0xbf463e48,0xbf2cbf78,0x3f7d3eac
.long 0x3f552839,0x3e483f6d,0xbf7fbef1,0x3e95bf22,0xbf0ebf80,0x3f7b3ec4,0x3dc93f62,0xbf75bf46
.long 0xbf7fbf35,0x3e95bf0e,0x3f5c3f71,0xbf2c3e16,0xbdc93f35,0xbf75bf55,0x3f04beac,0x3f3e3f7d
.long 0xa8803f80,0x28a3bf80,0x3f35bf35,0xbf353f35,0x3f80a70d,0xbf80a70d,0xbf35bf35,0x3f353f35
.long 0x3e95bf6d,0xbdc93f7b,0xbf5c3edb,0x3f3ebf18,0xbf75bec4,0x3f7f3e48,0x3f043f67,0xbf2cbf4e
.long 0xbf0e3f35,0x3e48bf6d,0x3f75bdc9,0xbf463ef1,0x3f553f35,0xbf7bbec4,0xbe95bf7f,0x3f223f62
.long 0x3f46bec4,0xbe953f55,0xbf80be79,0x3f4ebeac,0xbf22bf6d,0x3f753f0e,0x3d493f78,0xbf18bf71
.long 0xbf6d28be,0x3ec4bf35,0x3f7b3f0e,0xbf553e48,0x3ec43f80,0xbf6dbf35,0x3e48bf55,0x3f0e3f7b
.long 0x3f7f3ec4,0xbef13f0e,0xbf67bf4e,0x3f5cbd49,0xbdc9bf6d,0x3f623f55,0xbedb3f18,0xbf04bf80
.long 0xbf7bbf35,0x3f0ebec4,0x3f463f75,0xbf62bdc9,0xbe483f35,0xbf55bf6d,0x3f22be95,0x3ef13f7f
.long 0x3f623f6d,0xbf223e48,0xbf18bf80,0x3f673e79,0x3ef1bec4,0x3f463f7b,0xbf4ebd49,0xbedbbf78
.long 0x27e63f80,0xa731bf80,0x3f35bf35,0xbf353f35,0x3f8027d4,0xbf80a831,0xbf35bf35,0x3f353f35
.long 0xbdc9bf80,0x3e953f7b,0xbf183f3e,0x3edbbf5c,0xbf7fa896,0x3f75be48,0x3f4e3f2c,0xbf67bf04
.long 0x3e483f80,0xbf0ebf6d,0x3ef1bf46,0xbdc93f75,0x3f7ba68e,0xbf553ec4,0xbf62bf22,0x3f7f3e95
.long 0xbe95bf80,0x3f463f55,0xbeac3f4e,0xbe79bf80,0xbf75a831,0x3f22bf0e,0x3f713f18,0xbf78bd49
.long 0x3ec43f80,0xbf6dbf35,0x3e48bf55,0x3f0e3f7b,0x3f6da80d,0xbec43f35,0xbf7bbf0e,0x3f55be48
.long 0xbef1bf80,0x3f7f3f0e,0xbd493f5c,0xbf4ebf67,0xbf62a754,0x3dc9bf55,0x3f803f04,0xbf183edb
.long 0x3f0e3f80,0xbf7bbec4,0xbdc9bf62,0x3f753f46,0x3f552877,0x3e483f6d,0xbf7fbef1,0x3e95bf22
.long 0xbf22bf80,0x3f623e48,0x3e793f67,0xbf80bf18,0xbf46278d,0xbef1bf7b,0x3f783edb,0x3d493f4e
.long 0xa6d43f80,0x27c2bf80,0x3f35bf35,0xbf353f35,0x3f802877,0xbf80a89f,0xbf35bf35,0x3f353f35
.long 0xbef1bf6d,0x3f223f55,0xbe793f71,0x3d49bf7d,0xbf623ec4,0x3f46bf0e,0x3f783eac,0xbf80be16
.long 0x3f553f35,0xbf7bbec4,0xbe95bf7f,0x3f223f62,0x3f0ebf35,0xbe483f6d,0xbf753dc9,0x3f46bef1
.long 0xbf7fbec4,0x3f62be48,0x3f3e3f5c,0xbf7dbedb,0xbdc93f6d,0xbef1bf7b,0x3f2cbf04,0xbe163f67
.long 0x3f6d27c2,0xbec43f35,0xbf7bbf0e,0x3f55be48,0xbec4bf80,0x3f6d3f35,0xbe483f55,0xbf0ebf7b
.long 0xbf223ec4,0xbe95bf7b,0x3f713e16,0xbe793f3e,0x3f463f6d,0xbf75be48,0xbeacbf7d,0x3f783f2c
.long 0x3e48bf35,0x3f553f6d,0xbf223e95,0xbef1bf7f,0xbf7bbf35,0x3f0ebec4,0x3f463f75,0xbf62bdc9
.long 0x3e953f6d,0xbf7fbf0e,0x3e16bf2c,0x3f713f5c,0x3f753ec4,0x3dc93f55,0xbf7dbf3e,0x3eacbf04
.long 0xa8283f80,0x286ebf80,0x3f35bf35,0xbf353f35,0x3f8028c2,0xbf802754,0xbf35bf35,0x3f353f35
.long 0xbf46bf35,0x3f623f0e,0x3e163f80,0xbeacbf78,0xbf223f35,0x3ef1bf55,0x3f7dbd49,0xbf713e79
.long 0x3f7ba816,0xbf553ec4,0xbf62bf22,0x3f7f3e95,0xbe48bf80,0x3f0e3f6d,0xbef13f46,0x3dc9bf75
.long 0xbef13f35,0xbdc9bf7b,0x3f67be16,0xbf043f2c,0x3f623f35,0xbf7fbe48,0xbedbbf7d,0x3f5c3f3e
.long 0xbec4bf80,0x3f6d3f35,0xbe483f55,0xbf0ebf7b,0xbf6d2831,0x3ec4bf35,0x3f7b3f0e,0xbf553e48
.long 0x3f753f35,0xbf463e48,0xbf2cbf78,0x3f7d3eac,0x3e95bf35,0x3f223f7b,0xbf3e3e79,0xbe16bf71
.long 0xbf55a89a,0xbe48bf6d,0x3f7f3ef1,0xbe953f22,0x3f0e3f80,0xbf7bbec4,0xbdc9bf62,0x3f753f46
.long 0x3dc9bf35,0x3f753f55,0xbf043eac,0xbf3ebf7d,0xbf7fbf35,0x3e95bf0e,0x3f5c3f71,0xbf2c3e16
.long 0xa89a3f80,0x28bebf80,0x3f35bf35,0xbf353f35,0x3f80268d,0xbf80a7b0,0xbf35bf35,0x3f353f35
.long 0xbf75bec4,0x3f7f3e48,0x3f043f67,0xbf2cbf4e,0xbe953f6d,0x3dc9bf7b,0x3f5cbedb,0xbf3e3f18
.long 0x3f0ebf35,0xbe483f6d,0xbf753dc9,0x3f46bef1,0xbf55bf35,0x3f7b3ec4,0x3e953f7f,0xbf22bf62
.long 0x3f223f6d,0xbf75bf0e,0xbd49bf78,0x3f183f71,0x3f46bec4,0xbe953f55,0xbf80be79,0x3f4ebeac
.long 0xbf6d28e1,0x3ec4bf35,0x3f7b3f0e,0xbf553e48,0x3ec43f80,0xbf6dbf35,0x3e48bf55,0x3f0e3f7b
.long 0xbdc9bf6d,0x3f623f55,0xbedb3f18,0xbf04bf80,0xbf7fbec4,0x3ef1bf0e,0x3f673f4e,0xbf5c3d49
.long 0x3f7b3f35,0xbf0e3ec4,0xbf46bf75,0x3f623dc9,0x3e48bf35,0x3f553f6d,0xbf223e95,0xbef1bf7f
.long 0xbef13ec4,0xbf46bf7b,0x3f4e3d49,0x3edb3f78,0x3f623f6d,0xbf223e48,0xbf18bf80,0x3f673e79
.long 0x27773f80,0x260cbf80,0x3f35bf35,0xbf353f35,0x3f80281f,0xbf80a865,0xbf35bf35,0x3f353f35
.long 0xbf7fa8e1,0x3f75be48,0x3f4e3f2c,0xbf67bf04,0x3dc93f80,0xbe95bf7b,0x3f18bf3e,0xbedb3f5c
.long 0xbe48bf80,0x3f0e3f6d,0xbef13f46,0x3dc9bf75,0xbf7ba865,0x3f55bec4,0x3f623f22,0xbf7fbe95
.long 0x3f752902,0xbf223f0e,0xbf71bf18,0x3f783d49,0xbe95bf80,0x3f463f55,0xbeac3f4e,0xbe79bf80
.long 0x3ec43f80,0xbf6dbf35,0x3e48bf55,0x3f0e3f7b,0x3f6da854,0xbec43f35,0xbf7bbf0e,0x3f55be48
.long 0xbf62a79f,0x3dc9bf55,0x3f803f04,0xbf183edb,0x3ef13f80,0xbf7fbf0e,0x3d49bf5c,0x3f4e3f67
.long 0xbf0ebf80,0x3f7b3ec4,0x3dc93f62,0xbf75bf46,0xbf55a8b9,0xbe48bf6d,0x3f7f3ef1,0xbe953f22
.long 0x3f46a8b5,0x3ef13f7b,0xbf78bedb,0xbd49bf4e,0xbf22bf80,0x3f623e48,0x3e793f67,0xbf80bf18
.long 0xa79f3f80,0x2926bf80,0x3f35bf35,0xbf353f35,0x3f802896,0xbf80a8b9,0xbf35bf35,0x3f353f35
.long 0xbf623ec4,0x3f46bf0e,0x3f783eac,0xbf80be16,0x3ef13f6d,0xbf22bf55,0x3e79bf71,0xbd493f7d
.long 0xbf55bf35,0x3f7b3ec4,0x3e953f7f,0xbf22bf62,0xbf0e3f35,0x3e48bf6d,0x3f75bdc9,0xbf463ef1
.long 0x3dc9bf6d,0x3ef13f7b,0xbf2c3f04,0x3e16bf67,0xbf7fbec4,0x3f62be48,0x3f3e3f5c,0xbf7dbedb
.long 0x3f6d26d3,0xbec43f35,0xbf7bbf0e,0x3f55be48,0xbec4bf80,0x3f6d3f35,0xbe483f55,0xbf0ebf7b
.long 0x3f463f6d,0xbf75be48,0xbeacbf7d,0x3f783f2c,0x3f22bec4,0x3e953f7b,0xbf71be16,0x3e79bf3e
.long 0xbe483f35,0xbf55bf6d,0x3f22be95,0x3ef13f7f,0x3f7b3f35,0xbf0e3ec4,0xbf46bf75,0x3f623dc9
.long 0xbf75bec4,0xbdc9bf55,0x3f7d3f3e,0xbeac3f04,0x3e953f6d,0xbf7fbf0e,0x3e16bf2c,0x3f713f5c
.long 0xa85d3f80,0xa85dbf80,0x3f35bf35,0xbf353f35,0x3f80a78d,0xbf80a900,0xbf35bf35,0x3f353f35
.long 0xbf223f35,0x3ef1bf55,0x3f7dbd49,0xbf713e79,0x3f463f35,0xbf62bf0e,0xbe16bf80,0x3eac3f78
.long 0xbf7b28cf,0x3f55bec4,0x3f623f22,0xbf7fbe95,0x3e483f80,0xbf0ebf6d,0x3ef1bf46,0xbdc93f75
.long 0xbf62bf35,0x3f7f3e48,0x3edb3f7d,0xbf5cbf3e,0xbef13f35,0xbdc9bf7b,0x3f67be16,0xbf043f2c
.long 0xbec4bf80,0x3f6d3f35,0xbe483f55,0xbf0ebf7b,0xbf6d293e,0x3ec4bf35,0x3f7b3f0e,0xbf553e48
.long 0x3e95bf35,0x3f223f7b,0xbf3e3e79,0xbe16bf71,0xbf75bf35,0x3f46be48,0x3f2c3f78,0xbf7dbeac
.long 0x3f55296c,0x3e483f6d,0xbf7fbef1,0x3e95bf22,0xbf0ebf80,0x3f7b3ec4,0x3dc93f62,0xbf75bf46
.long 0x3f7f3f35,0xbe953f0e,0xbf5cbf71,0x3f2cbe16,0x3dc9bf35,0x3f753f55,0xbf043eac,0xbf3ebf7d
.long 0xa8b53f80,0xa79fbf80,0x3f35bf35,0xbf353f35,0x3f80278d,0xbf80a923,0xbf35bf35,0x3f353f35
.long 0xbe953f6d,0x3dc9bf7b,0x3f5cbedb,0xbf3e3f18,0x3f753ec4,0xbf7fbe48,0xbf04bf67,0x3f2c3f4e
.long 0xbf0e3f35,0x3e48bf6d,0x3f75bdc9,0xbf463ef1,0x3f553f35,0xbf7bbec4,0xbe95bf7f,0x3f223f62
.long 0xbf463ec4,0x3e95bf55,0x3f803e79,0xbf4e3eac,0x3f223f6d,0xbf75bf0e,0xbd49bf78,0x3f183f71
.long 0xbf6d2902,0x3ec4bf35,0x3f7b3f0e,0xbf553e48,0x3ec43f80,0xbf6dbf35,0x3e48bf55,0x3f0e3f7b
.long 0xbf7fbec4,0x3ef1bf0e,0x3f673f4e,0xbf5c3d49,0x3dc93f6d,0xbf62bf55,0x3edbbf18,0x3f043f80
.long 0xbf7bbf35,0x3f0ebec4,0x3f463f75,0xbf62bdc9,0xbe483f35,0xbf55bf6d,0x3f22be95,0x3ef13f7f
.long 0xbf62bf6d,0x3f22be48,0x3f183f80,0xbf67be79,0xbef13ec4,0xbf46bf7b,0x3f4e3d49,0x3edb3f78
.long 0x3f353f80,0xbf35a5f7,0xbec4bf6d,0x3f6d3ec4,0x3f358000,0x3f353f80,0xbf6dbec4,0xbec4bf6d
.long 0x3f463f80,0xbef13e48,0xbf04bf71,0x3f3e3e16,0x3f228000,0x3f623f7b,0xbf5cbeac,0xbf2cbf7d
.long 0x3f553f80,0xbe483ec4,0xbf22bf75,0x3ef1bdc9,0x3f0e8000,0x3f7b3f6d,0xbf46be95,0xbf62bf7f
.long 0x3f623f80,0x3dc93f0e,0xbf3ebf78,0x3e16beac,0x3ef18000,0x3f7f3f55,0xbf2cbe79,0xbf7dbf71
.long 0x3f6d3f80,0x3ec43f35,0xbf55bf7b,0xbe48bf0e,0x3ec48000,0x3f6d3f35,0xbf0ebe48,0xbf7bbf55
.long 0x3f753f80,0x3f223f55,0xbf67bf7d,0xbf04bf3e,0x3e958000,0x3f463f0e,0xbedbbe16,0xbf5cbf2c
.long 0x3f7b3f80,0x3f553f6d,0xbf75bf7f,0xbf46bf62,0x3e488000,0x3f0e3ec4,0xbe95bdc9,0xbf22bef1
.long 0x3f7f3f80,0x3f753f7b,0xbf7dbf80,0xbf71bf78,0x3dc98000,0x3e953e48,0xbe16bd49,0xbeacbe79
.long 0xbf35bf80,0x3f35a60d,0x3ec43f6d,0xbf6dbec4,0xbf35a677,0xbf35bf80,0x3f6d3ec4,0x3ec43f6d
.long 0xbf75bf6d,0x3dc9bf0e,0x3f4e3f80,0xbedb3e79,0xbe953ec4,0xbf7fbf55,0x3f18bd49,0x3f673f78
.long 0xbf7bbf35,0xbf0ebf6d,0x3f7f3f62,0x3e953f46,0x3e483f35,0xbf55bec4,0x3dc9bef1,0x3f753f22
.long 0xbf46bec4,0xbf75bf7b,0x3f673f18,0x3f5c3f80,0x3f223f6d,0xbe953e48,0xbedbbf4e,0x3f043d49
.long 0xbec4a742,0xbf6dbf35,0x3f0e3e48,0x3f7b3f55,0x3f6d3f80,0x3ec43f35,0xbf55bf7b,0xbe48bf0e
.long 0x3dc93ec4,0xbef1be48,0x3d49be79,0x3f183eac,0x3f7f3f6d,0x3f623f7b,0xbf80bf78,0xbf4ebf71
.long 0x3f0e3f35,0x3e483ec4,0xbef1bf22,0xbdc9be95,0x3f553f35,0x3f7b3f6d,0xbf62bf46,0xbf7fbf75
.long 0x3f623f6d,0x3f463f55,0xbf5cbf67,0xbf3ebf4e,0x3ef13ec4,0x3f223f0e,0xbf04bedb,0xbf2cbf18
.long 0x3f353f80,0xbf35a78d,0xbec4bf6d,0x3f6d3ec4,0x3f3526f7,0x3f353f80,0xbf6dbec4,0xbec4bf6d
.long 0x3f7f3f35,0x3e953f55,0xbf78bf67,0x3d49bf18,0xbdc9bf35,0x3f753f0e,0xbe793edb,0xbf80bf4e
.long 0x3f0ea137,0x3f7b3f6d,0xbf46be95,0xbf62bf7f,0xbf55bf80,0x3e48bec4,0x3f223f75,0xbef13dc9
.long 0xbe95bf35,0x3f223e48,0x3d493f04,0xbf4ebedb,0xbf75bf35,0xbf46bf7b,0x3f803f5c,0x3f183f67
.long 0xbf6dbf80,0xbec4bf35,0x3f553f7b,0x3e483f0e,0xbec4a7c2,0xbf6dbf35,0x3f0e3e48,0x3f7b3f55
.long 0xbf62bf35,0xbf7fbf7b,0x3f713f4e,0x3f783f80,0x3ef13f35,0xbdc93e48,0xbeacbf18,0x3e79bd49
.long 0xbe48a784,0xbf0ebec4,0x3e953dc9,0x3f223ef1,0x3f7b3f80,0x3f553f6d,0xbf75bf7f,0xbf46bf62
.long 0x3f223f35,0x3ef13f0e,0xbf18bf2c,0xbedbbf04,0x3f463f35,0x3f623f55,0xbf4ebf3e,0xbf67bf5c
.long 0xbf35bf80,0x3f352816,0x3ec43f6d,0xbf6dbec4,0xbf35268d,0xbf35bf80,0x3f6d3ec4,0x3ec43f6d
.long 0xbf62bec4,0xbf22bf7b,0x3f7d3f2c,0x3eac3f5c,0x3ef13f6d,0xbf46be48,0xbe16bf3e,0x3f713f04
.long 0x3e483f35,0xbf55bec4,0x3dc9bef1,0x3f753f22,0x3f7b3f35,0x3f0e3f6d,0xbf7fbf62,0xbe95bf46
.long 0x3f7f3f6d,0x3ef13f55,0xbf71bf7d,0xbe79bf2c,0x3dc9bec4,0x3f623f0e,0xbeac3e16,0xbf78bf3e
.long 0x3ec42889,0x3f6d3f35,0xbf0ebe48,0xbf7bbf55,0xbf6dbf80,0xbec4bf35,0x3f553f7b,0x3e483f0e
.long 0xbf46bf6d,0xbe95bf0e,0x3f2c3f5c,0x3e163edb,0xbf22bec4,0xbf75bf55,0x3f3e3f04,0x3f7d3f67
.long 0xbf55bf35,0xbf7bbf6d,0x3f623f46,0x3f7f3f75,0x3f0e3f35,0x3e483ec4,0xbef1bf22,0xbdc9be95
.long 0x3e953ec4,0x3dc93e48,0xbe79beac,0xbd49be16,0x3f753f6d,0x3f7f3f7b,0xbf78bf71,0xbf80bf7d
.long 0x3f353f80,0xbf3526d4,0xbec4bf6d,0x3f6d3ec4,0x3f352777,0x3f353f80,0xbf6dbec4,0xbec4bf6d
.long 0x3f22281f,0x3f623f7b,0xbf5cbeac,0xbf2cbf7d,0xbf46bf80,0x3ef1be48,0x3f043f71,0xbf3ebe16
.long 0xbf55bf80,0x3e48bec4,0x3f223f75,0xbef13dc9,0xbf0e21b7,0xbf7bbf6d,0x3f463e95,0x3f623f7f
.long 0xbef1a7c2,0xbf7fbf55,0x3f2c3e79,0x3f7d3f71,0x3f623f80,0x3dc93f0e,0xbf3ebf78,0x3e16beac
.long 0x3f6d3f80,0x3ec43f35,0xbf55bf7b,0xbe48bf0e,0x3ec42842,0x3f6d3f35,0xbf0ebe48,0xbf7bbf55
.long 0x3e95270d,0x3f463f0e,0xbedbbe16,0xbf5cbf2c,0xbf75bf80,0xbf22bf55,0x3f673f7d,0x3f043f3e
.long 0xbf7bbf80,0xbf55bf6d,0x3f753f7f,0x3f463f62,0xbe48a804,0xbf0ebec4,0x3e953dc9,0x3f223ef1
.long 0xbdc926d4,0xbe95be48,0x3e163d49,0x3eac3e79,0x3f7f3f80,0x3f753f7b,0xbf7dbf80,0xbf71bf78
.long 0xbf35bf80,0x3f352754,0x3ec43f6d,0xbf6dbec4,0xbf35a80d,0xbf35bf80,0x3f6d3ec4,0x3ec43f6d
.long 0xbe953ec4,0xbf7fbf55,0x3f18bd49,0x3f673f78,0x3f753f6d,0xbdc93f0e,0xbf4ebf80,0x3edbbe79
.long 0x3f7b3f35,0x3f0e3f6d,0xbf7fbf62,0xbe95bf46,0xbe48bf35,0x3f553ec4,0xbdc93ef1,0xbf75bf22
.long 0xbf22bf6d,0x3e95be48,0x3edb3f4e,0xbf04bd49,0xbf46bec4,0xbf75bf7b,0x3f673f18,0x3f5c3f80
.long 0xbec4a7e5,0xbf6dbf35,0x3f0e3e48,0x3f7b3f55,0x3f6d3f80,0x3ec43f35,0xbf55bf7b,0xbe48bf0e
.long 0x3f7f3f6d,0x3f623f7b,0xbf80bf78,0xbf4ebf71,0xbdc9bec4,0x3ef13e48,0xbd493e79,0xbf18beac
.long 0xbf0ebf35,0xbe48bec4,0x3ef13f22,0x3dc93e95,0xbf55bf35,0xbf7bbf6d,0x3f623f46,0x3f7f3f75
.long 0xbef1bec4,0xbf22bf0e,0x3f043edb,0x3f2c3f18,0x3f623f6d,0x3f463f55,0xbf5cbf67,0xbf3ebf4e
.long 0x3f353f80,0xbf35a804,0xbec4bf6d,0x3f6d3ec4,0x3f35a70d,0x3f353f80,0xbf6dbec4,0xbec4bf6d
.long 0xbdc9bf35,0x3f753f0e,0xbe793edb,0xbf80bf4e,0xbf7fbf35,0xbe95bf55,0x3f783f67,0xbd493f18
.long 0xbf0ea880,0xbf7bbf6d,0x3f463e95,0x3f623f7f,0x3f553f80,0xbe483ec4,0xbf22bf75,0x3ef1bdc9
.long 0x3f753f35,0x3f463f7b,0xbf80bf5c,0xbf18bf67,0xbe95bf35,0x3f223e48,0x3d493f04,0xbf4ebedb
.long 0xbf6dbf80,0xbec4bf35,0x3f553f7b,0x3e483f0e,0xbec4a909,0xbf6dbf35,0x3f0e3e48,0x3f7b3f55
.long 0x3ef13f35,0xbdc93e48,0xbeacbf18,0x3e79bd49,0x3f623f35,0x3f7f3f7b,0xbf71bf4e,0xbf78bf80
.long 0x3e4828a3,0x3f0e3ec4,0xbe95bdc9,0xbf22bef1,0xbf7bbf80,0xbf55bf6d,0x3f753f7f,0x3f463f62
.long 0xbf46bf35,0xbf62bf55,0x3f4e3f3e,0x3f673f5c,0x3f223f35,0x3ef13f0e,0xbf18bf2c,0xbedbbf04
.long 0xbf35bf80,0x3f35a731,0x3ec43f6d,0xbf6dbec4,0xbf35a896,0xbf35bf80,0x3f6d3ec4,0x3ec43f6d
.long 0x3ef13f6d,0xbf46be48,0xbe16bf3e,0x3f713f04,0x3f623ec4,0x3f223f7b,0xbf7dbf2c,0xbeacbf5c
.long 0xbe48bf35,0x3f553ec4,0xbdc93ef1,0xbf75bf22,0xbf7bbf35,0xbf0ebf6d,0x3f7f3f62,0x3e953f46
.long 0xbdc93ec4,0xbf62bf0e,0x3eacbe16,0x3f783f3e,0x3f7f3f6d,0x3ef13f55,0xbf71bf7d,0xbe79bf2c
.long 0x3ec428ea,0x3f6d3f35,0xbf0ebe48,0xbf7bbf55,0xbf6dbf80,0xbec4bf35,0x3f553f7b,0x3e483f0e
.long 0xbf22bec4,0xbf75bf55,0x3f3e3f04,0x3f7d3f67,0x3f463f6d,0x3e953f0e,0xbf2cbf5c,0xbe16bedb
.long 0x3f553f35,0x3f7b3f6d,0xbf62bf46,0xbf7fbf75,0xbf0ebf35,0xbe48bec4,0x3ef13f22,0x3dc93e95
.long 0xbf75bf6d,0xbf7fbf7b,0x3f783f71,0x3f803f7d,0x3e953ec4,0x3dc93e48,0xbe79beac,0xbd49be16
.long 0x3f353f80,0xbf35a892,0xbec4bf6d,0x3f6d3ec4,0x3f3527f7,0x3f353f80,0xbf6dbec4,0xbec4bf6d
.long 0xbf46bf80,0x3ef1be48,0x3f043f71,0xbf3ebe16,0xbf22a89f,0xbf62bf7b,0x3f5c3eac,0x3f2c3f7d
.long 0x3f553f80,0xbe483ec4,0xbf22bf75,0x3ef1bdc9,0x3f0ea237,0x3f7b3f6d,0xbf46be95,0xbf62bf7f
.long 0xbf62bf80,0xbdc9bf0e,0x3f3e3f78,0xbe163eac,0xbef1a842,0xbf7fbf55,0x3f2c3e79,0x3f7d3f71
.long 0x3f6d3f80,0x3ec43f35,0xbf55bf7b,0xbe48bf0e,0x3ec428c2,0x3f6d3f35,0xbf0ebe48,0xbf7bbf55
.long 0xbf75bf80,0xbf22bf55,0x3f673f7d,0x3f043f3e,0xbe95a78d,0xbf46bf0e,0x3edb3e16,0x3f5c3f2c
.long 0x3f7b3f80,0x3f553f6d,0xbf75bf7f,0xbf46bf62,0x3e482884,0x3f0e3ec4,0xbe95bdc9,0xbf22bef1
.long 0xbf7fbf80,0xbf75bf7b,0x3f7d3f80,0x3f713f78,0xbdc92754,0xbe95be48,0x3e163d49,0x3eac3e79
.long 0xbf35bf80,0x3f3527e5,0x3ec43f6d,0xbf6dbec4,0xbf352754,0xbf35bf80,0x3f6d3ec4,0x3ec43f6d
.long 0x3f753f6d,0xbdc93f0e,0xbf4ebf80,0x3edbbe79,0x3e95bec4,0x3f7f3f55,0xbf183d49,0xbf67bf78
.long 0xbf7bbf35,0xbf0ebf6d,0x3f7f3f62,0x3e953f46,0x3e483f35,0xbf55bec4,0x3dc9bef1,0x3f753f22
.long 0x3f463ec4,0x3f753f7b,0xbf67bf18,0xbf5cbf80,0xbf22bf6d,0x3e95be48,0x3edb3f4e,0xbf04bd49
.long 0xbec4a89a,0xbf6dbf35,0x3f0e3e48,0x3f7b3f55,0x3f6d3f80,0x3ec43f35,0xbf55bf7b,0xbe48bf0e
.long 0xbdc9bec4,0x3ef13e48,0xbd493e79,0xbf18beac,0xbf7fbf6d,0xbf62bf7b,0x3f803f78,0x3f4e3f71
.long 0x3f0e3f35,0x3e483ec4,0xbef1bf22,0xbdc9be95,0x3f553f35,0x3f7b3f6d,0xbf62bf46,0xbf7fbf75
.long 0xbf62bf6d,0xbf46bf55,0x3f5c3f67,0x3f3e3f4e,0xbef1bec4,0xbf22bf0e,0x3f043edb,0x3f2c3f18
.long 0x3f353f80,0xbf352777,0xbec4bf6d,0x3f6d3ec4,0x3f35288d,0x3f353f80,0xbf6dbec4,0xbec4bf6d
.long 0xbf7fbf35,0xbe95bf55,0x3f783f67,0xbd493f18,0x3dc93f35,0xbf75bf0e,0x3e79bedb,0x3f803f4e
.long 0x3f0ea880,0x3f7b3f6d,0xbf46be95,0xbf62bf7f,0xbf55bf80,0x3e48bec4,0x3f223f75,0xbef13dc9
.long 0x3e953f35,0xbf22be48,0xbd49bf04,0x3f4e3edb,0x3f753f35,0x3f463f7b,0xbf80bf5c,0xbf18bf67
.long 0xbf6dbf80,0xbec4bf35,0x3f553f7b,0x3e483f0e,0xbec4a865,0xbf6dbf35,0x3f0e3e48,0x3f7b3f55
.long 0x3f623f35,0x3f7f3f7b,0xbf71bf4e,0xbf78bf80,0xbef1bf35,0x3dc9be48,0x3eac3f18,0xbe793d49
.long 0xbe48a84b,0xbf0ebec4,0x3e953dc9,0x3f223ef1,0x3f7b3f80,0x3f553f6d,0xbf75bf7f,0xbf46bf62
.long 0xbf22bf35,0xbef1bf0e,0x3f183f2c,0x3edb3f04,0xbf46bf35,0xbf62bf55,0x3f4e3f3e,0x3f673f5c
.long 0xbf35bf80,0x3f352889,0x3ec43f6d,0xbf6dbec4,0xbf35a7d4,0xbf35bf80,0x3f6d3ec4,0x3ec43f6d
.long 0x3f623ec4,0x3f223f7b,0xbf7dbf2c,0xbeacbf5c,0xbef1bf6d,0x3f463e48,0x3e163f3e,0xbf71bf04
.long 0x3e483f35,0xbf55bec4,0x3dc9bef1,0x3f753f22,0x3f7b3f35,0x3f0e3f6d,0xbf7fbf62,0xbe95bf46
.long 0xbf7fbf6d,0xbef1bf55,0x3f713f7d,0x3e793f2c,0xbdc93ec4,0xbf62bf0e,0x3eacbe16,0x3f783f3e
.long 0x3ec42926,0x3f6d3f35,0xbf0ebe48,0xbf7bbf55,0xbf6dbf80,0xbec4bf35,0x3f553f7b,0x3e483f0e
.long 0x3f463f6d,0x3e953f0e,0xbf2cbf5c,0xbe16bedb,0x3f223ec4,0x3f753f55,0xbf3ebf04,0xbf7dbf67
.long 0xbf55bf35,0xbf7bbf6d,0x3f623f46,0x3f7f3f75,0x3f0e3f35,0x3e483ec4,0xbef1bf22,0xbdc9be95
.long 0xbe95bec4,0xbdc9be48,0x3e793eac,0x3d493e16,0xbf75bf6d,0xbf7fbf7b,0x3f783f71,0x3f803f7d
.long 0x3f353f80,0xbf35a918,0xbec4bf6d,0x3f6d3ec4,0x3f35a78d,0x3f353f80,0xbf6dbec4,0xbec4bf6d
.long 0xbf22a85d,0xbf62bf7b,0x3f5c3eac,0x3f2c3f7d,0x3f463f80,0xbef13e48,0xbf04bf71,0x3f3e3e16
.long 0xbf55bf80,0x3e48bec4,0x3f223f75,0xbef13dc9,0xbf0ea900,0xbf7bbf6d,0x3f463e95,0x3f623f7f
.long 0x3ef1a85d,0x3f7f3f55,0xbf2cbe79,0xbf7dbf71,0xbf62bf80,0xbdc9bf0e,0x3f3e3f78,0xbe163eac
.long 0x3f6d3f80,0x3ec43f35,0xbf55bf7b,0xbe48bf0e,0x3ec42989,0x3f6d3f35,0xbf0ebe48,0xbf7bbf55
.long 0xbe95a8b5,0xbf46bf0e,0x3edb3e16,0x3f5c3f2c,0x3f753f80,0x3f223f55,0xbf67bf7d,0xbf04bf3e
.long 0xbf7bbf80,0xbf55bf6d,0x3f753f7f,0x3f463f62,0xbe48a923,0xbf0ebec4,0x3e953dc9,0x3f223ef1
.long 0x3dc9a79f,0x3e953e48,0xbe16bd49,0xbeacbe79,0xbf7fbf80,0xbf75bf7b,0x3f7d3f80,0x3f713f78
.long 0xbf35bf80,0x3f35a79f,0x3ec43f6d,0xbf6dbec4,0xbf35a884,0xbf35bf80,0x3f6d3ec4,0x3ec43f6d
.long 0x3e95bec4,0x3f7f3f55,0xbf183d49,0xbf67bf78,0xbf75bf6d,0x3dc9bf0e,0x3f4e3f80,0xbedb3e79
.long 0x3f7b3f35,0x3f0e3f6d,0xbf7fbf62,0xbe95bf46,0xbe48bf35,0x3f553ec4,0xbdc93ef1,0xbf75bf22
.long 0x3f223f6d,0xbe953e48,0xbedbbf4e,0x3f043d49,0x3f463ec4,0x3f753f7b,0xbf67bf18,0xbf5cbf80
.long 0xbec4a8fc,0xbf6dbf35,0x3f0e3e48,0x3f7b3f55,0x3f6d3f80,0x3ec43f35,0xbf55bf7b,0xbe48bf0e
.long 0xbf7fbf6d,0xbf62bf7b,0x3f803f78,0x3f4e3f71,0x3dc93ec4,0xbef1be48,0x3d49be79,0x3f183eac
.long 0xbf0ebf35,0xbe48bec4,0x3ef13f22,0x3dc93e95,0xbf55bf35,0xbf7bbf6d,0x3f623f46,0x3f7f3f75
.long 0x3ef13ec4,0x3f223f0e,0xbf04bedb,0xbf2cbf18,0xbf62bf6d,0xbf46bf55,0x3f5c3f67,0x3f3e3f4e
.long 0x3f353f80,0xbf35a880,0xbec4bf6d,0x3f6d3ec4,0x3f352916,0x3f353f80,0xbf6dbec4,0xbec4bf6d
.long 0x3dc93f35,0xbf75bf0e,0x3e79bedb,0x3f803f4e,0x3f7f3f35,0x3e953f55,0xbf78bf67,0x3d49bf18
.long 0xbf0ea880,0xbf7bbf6d,0x3f463e95,0x3f623f7f,0x3f553f80,0xbe483ec4,0xbf22bf75,0x3ef1bdc9
.long 0xbf75bf35,0xbf46bf7b,0x3f803f5c,0x3f183f67,0x3e953f35,0xbf22be48,0xbd49bf04,0x3f4e3edb
.long 0xbf6dbf80,0xbec4bf35,0x3f553f7b,0x3e483f0e,0xbec4a96a,0xbf6dbf35,0x3f0e3e48,0x3f7b3f55
.long 0xbef1bf35,0x3dc9be48,0x3eac3f18,0xbe793d49,0xbf62bf35,0xbf7fbf7b,0x3f713f4e,0x3f783f80
.long 0x3e482914,0x3f0e3ec4,0xbe95bdc9,0xbf22bef1,0xbf7bbf80,0xbf55bf6d,0x3f753f7f,0x3f463f62
.long 0x3f463f35,0x3f623f55,0xbf4ebf3e,0xbf67bf5c,0xbf22bf35,0xbef1bf0e,0x3f183f2c,0x3edb3f04
.long 0xbf35bf80,0x3f352914,0x3ec43f6d,0xbf6dbec4,0xbf3527b1,0xbf35bf80,0x3f6d3ec4,0x3ec43f6d
.long 0xbef1bf6d,0x3f463e48,0x3e163f3e,0xbf71bf04,0xbf62bec4,0xbf22bf7b,0x3f7d3f2c,0x3eac3f5c
.long 0xbe48bf35,0x3f553ec4,0xbdc93ef1,0xbf75bf22,0xbf7bbf35,0xbf0ebf6d,0x3f7f3f62,0x3e953f46
.long 0x3dc9bec4,0x3f623f0e,0xbeac3e16,0xbf78bf3e,0xbf7fbf6d,0xbef1bf55,0x3f713f7d,0x3e793f2c
.long 0x3ec428ac,0x3f6d3f35,0xbf0ebe48,0xbf7bbf55,0xbf6dbf80,0xbec4bf35,0x3f553f7b,0x3e483f0e
.long 0x3f223ec4,0x3f753f55,0xbf3ebf04,0xbf7dbf67,0xbf46bf6d,0xbe95bf0e,0x3f2c3f5c,0x3e163edb
.long 0x3f553f35,0x3f7b3f6d,0xbf62bf46,0xbf7fbf75,0xbf0ebf35,0xbe48bec4,0x3ef13f22,0x3dc93e95
.long 0x3f753f6d,0x3f7f3f7b,0xbf78bf71,0xbf80bf7d,0xbe95bec4,0xbdc9be48,0x3e793eac,0x3d493e16
.long 0x0,0x40,0x4600,0x4600,0x8,0x48,0x4650,0x4610
.long 0x10,0x40,0x46a0,0x4620,0x18,0x48,0x46f0,0x4630
.long 0xa0,0xe0,0x4740,0x4640,0xa8,0xe8,0x4790,0x4650
.long 0xb0,0xe0,0x47e0,0x4660,0xb8,0xe8,0x4830,0x4670
.long 0x140,0x180,0x4880,0x4680,0x148,0x188,0x48d0,0x4690
.long 0x150,0x180,0x4920,0x46a0,0x158,0x188,0x4970,0x46b0
.long 0x1e0,0x220,0x49c0,0x46c0,0x1e8,0x228,0x4a10,0x46d0
.long 0x1f0,0x220,0x4a60,0x46e0,0x1f8,0x228,0x4ab0,0x46f0
.long 0x280,0x2c0,0x4608,0x4700,0x288,0x2c8,0x4658,0x4710
.long 0x290,0x2c0,0x46a8,0x4720,0x298,0x2c8,0x46f8,0x4730
.long 0x320,0x360,0x4748,0x4740,0x328,0x368,0x4798,0x4750
.long 0x330,0x360,0x47e8,0x4760,0x338,0x368,0x4838,0x4770
.long 0x3c0,0x400,0x4888,0x4780,0x3c8,0x408,0x48d8,0x4790
.long 0x3d0,0x400,0x4928,0x47a0,0x3d8,0x408,0x4978,0x47b0
.long 0x460,0x4a0,0x49c8,0x47c0,0x468,0x4a8,0x4a18,0x47d0
.long 0x470,0x4a0,0x4a68,0x47e0,0x478,0x4a8,0x4ab8,0x47f0
.long 0x500,0x540,0x4610,0x4800,0x508,0x548,0x4660,0x4810
.long 0x510,0x540,0x46b0,0x4820,0x518,0x548,0x4700,0x4830
.long 0x5a0,0x5e0,0x4750,0x4840,0x5a8,0x5e8,0x47a0,0x4850
.long 0x5b0,0x5e0,0x47f0,0x4860,0x5b8,0x5e8,0x4840,0x4870
.long 0x640,0x680,0x4890,0x4880,0x648,0x688,0x48e0,0x4890
.long 0x650,0x680,0x4930,0x48a0,0x658,0x688,0x4980,0x48b0
.long 0x6e0,0x720,0x49d0,0x48c0,0x6e8,0x728,0x4a20,0x48d0
.long 0x6f0,0x720,0x4a70,0x48e0,0x6f8,0x728,0x4ac0,0x48f0
.long 0x780,0x7c0,0x4618,0x4900,0x788,0x7c8,0x4668,0x4910
.long 0x790,0x7c0,0x46b8,0x4920,0x798,0x7c8,0x4708,0x4930
.long 0x820,0x860,0x4758,0x4940,0x828,0x868,0x47a8,0x4950
.long 0x830,0x860,0x47f8,0x4960,0x838,0x868,0x4848,0x4970
.long 0x8c0,0x900,0x4898,0x4980,0x8c8,0x908,0x48e8,0x4990
.long 0x8d0,0x900,0x4938,0x49a0,0x8d8,0x908,0x4988,0x49b0
.long 0x960,0x9a0,0x49d8,0x49c0,0x968,0x9a8,0x4a28,0x49d0
.long 0x970,0x9a0,0x4a78,0x49e0,0x978,0x9a8,0x4ac8,0x49f0
.long 0xbe020,0x1bd030,0x27b040,0x1800,0xbe030,0x1bd040,0x27b040,0x1820
.long 0xbe040,0x1c2000,0x27b040,0x1840,0xc3000,0x1c2010,0x27b040,0x1860
.long 0xc3010,0x1c2020,0x27b040,0x1880,0xc3020,0x1c2030,0x27b040,0x18a0
.long 0xc3030,0x1c2040,0x27b040,0x18c0,0xc3040,0x1c7000,0x27b040,0x18e0
.long 0xc8000,0x1c7010,0x27b040,0x1900,0xc8010,0x1c7020,0x27b040,0x1920
.long 0xc8020,0x1c7030,0x27b040,0x1940,0xc8030,0x1c7040,0x27b040,0x1960
.long 0xc8040,0x1cc000,0x27b040,0x1980,0xcd000,0x1cc010,0x27b040,0x19a0
.long 0xcd010,0x1cc020,0x27b040,0x19c0,0xcd020,0x1cc030,0x27b040,0x19e0
.long 0xcd030,0x1cc040,0x27b040,0x1a00,0xcd040,0x1d1000,0x27b040,0x1a20
.long 0xd2000,0x1d1010,0x27b040,0x1a40,0xd2010,0x1d1020,0x27b040,0x1a60
.long 0xd2020,0x1d1030,0x27b040,0x1a80,0xd2030,0x1d1040,0x27b040,0x1aa0
.long 0xd2040,0x1d6000,0x27b040,0x1ac0,0xd7000,0x1d6010,0x27b040,0x1ae0
.long 0xd7010,0x1d6020,0x27b040,0x1b00,0xd7020,0x1d6030,0x27b040,0x1b20
.long 0xd7030,0x1d6040,0x27b040,0x1b40,0xd7040,0x1db000,0x27b040,0x1b60
.long 0xdc000,0x1db010,0x27b040,0x1b80,0xdc010,0x1db020,0x27b040,0x1ba0
.long 0xdc020,0x1db030,0x27b040,0x1bc0,0xdc030,0x1db040,0x27b040,0x1be0
.long 0xdc040,0x1e0000,0x27b040,0x1c00,0xe1000,0x1e0010,0x27b040,0x1c20
.long 0xe1010,0x1e0020,0x27b040,0x1c40,0xe1020,0x1e0030,0x27b040,0x1c60
.long 0xe1030,0x1e0040,0x27b040,0x1c80,0xe1040,0x1e5000,0x27b040,0x1ca0
.long 0xe6000,0x1e5010,0x27b040,0x1cc0,0xe6010,0x1e5020,0x27b040,0x1ce0
.long 0xe6020,0x1e5030,0x27b040,0x1d00,0xe6030,0x1e5040,0x27b040,0x1d20
.long 0xe6040,0x1ea000,0x27b040,0x1d40,0xeb000,0x1ea010,0x27b040,0x1d60
.long 0xeb010,0x1ea020,0x27b040,0x1d80,0xeb020,0x1ea030,0x27b040,0x1da0
.long 0xeb030,0x1ea040,0x27b040,0x1dc0,0xeb040,0x1ef000,0x27b040,0x1de0
.long 0xf0000,0x1ef010,0x27b040,0x1e00,0xf0010,0x1ef020,0x27b040,0x1e20
.long 0xf0020,0x1ef030,0x27b040,0x1e40,0xf0030,0x1ef040,0x27b040,0x1e60
.long 0xf0040,0x1f4000,0x27b040,0x1e80,0xf5000,0x1f4010,0x27b040,0x1ea0
.long 0xf5010,0x1f4020,0x27b040,0x1ec0,0xf5020,0x1f4030,0x27b040,0x1ee0
.long 0xf5030,0x1f4040,0x27b040,0x1f00,0xf5040,0x1f9000,0x27b040,0x1f20
.long 0xfa000,0x1f9010,0x27b040,0x1f40,0xfa010,0x1f9020,0x27b040,0x1f60
.long 0xfa020,0x1f9030,0x27b040,0x1f80,0xfa030,0x1f9040,0x27b040,0x1fa0
.long 0xfa040,0x1fe000,0x27b040,0x1fc0,0xff000,0x1fe010,0x27b040,0x1fe0
.long 0x6920,0xd280,0x14f40,0x1e000,0x6930,0xd290,0x14f50,0x1e010
.long 0x6940,0xe600,0x14f60,0x1e020,0x6950,0xe610,0x14f70,0x1e030
.long 0x6960,0xe620,0x14f80,0x1e040,0x6970,0xe630,0x14f90,0x1e050
.long 0x6980,0xe640,0x16300,0x1e060,0x6990,0xe650,0x16310,0x1e070
.long 0x5a00,0xe660,0x16320,0x1e080,0x5a10,0xe670,0x16330,0x1e090
.long 0x5a20,0xe680,0x16340,0x1f400,0x5a30,0xe690,0x16350,0x1f410
.long 0x5a40,0xd700,0x16360,0x1f420,0x5a50,0xd710,0x16370,0x1f430
.long 0x5a60,0xd720,0x16380,0x1f440,0x5a70,0xd730,0x16390,0x1f450
.long 0x5a80,0xd740,0x16800,0x1f460,0x5a90,0xd750,0x16810,0x1f470
.long 0x6e00,0xd760,0x16820,0x1f480,0x6e10,0xd770,0x16830,0x1f490
.long 0x6e20,0xd780,0x16840,0x1e500,0x6e30,0xd790,0x16850,0x1e510
.long 0x6e40,0xeb00,0x16860,0x1e520,0x6e50,0xeb10,0x16870,0x1e530
.long 0x6e60,0xeb20,0x16880,0x1e540,0x6e70,0xeb30,0x16890,0x1e550
.long 0x6e80,0xeb40,0x17c00,0x1e560,0x6e90,0xeb50,0x17c10,0x1e570
.long 0x5f00,0xeb60,0x17c20,0x1e580,0x5f10,0xeb70,0x17c30,0x1e590
.long 0x5f20,0xeb80,0x17c40,0x1f900,0x5f30,0xeb90,0x17c50,0x1f910
.long 0x5f40,0xf000,0x17c60,0x1f920,0x5f50,0xf010,0x17c70,0x1f930
.long 0x5f60,0xf020,0x17c80,0x1f940,0x5f70,0xf030,0x17c90,0x1f950
.long 0x5f80,0xf040,0x16d00,0x1f960,0x5f90,0xf050,0x16d10,0x1f970
.long 0x7300,0xf060,0x16d20,0x1f980,0x7310,0xf070,0x16d30,0x1f990
.long 0x7320,0xf080,0x16d40,0x1ea00,0x7330,0xf090,0x16d50,0x1ea10
.long 0x7340,0x10400,0x16d60,0x1ea20,0x7350,0x10410,0x16d70,0x1ea30
.long 0x7360,0x10420,0x16d80,0x1ea40,0x7370,0x10430,0x16d90,0x1ea50
.long 0x7380,0x10440,0x18100,0x1ea60,0x7390,0x10450,0x18110,0x1ea70
.long 0x7800,0x10460,0x18120,0x1ea80,0x7810,0x10470,0x18130,0x1ea90
.long 0x7820,0x10480,0x18140,0x1fe00,0x7830,0x10490,0x18150,0x1fe10
.long 0x7840,0xf500,0x18160,0x1fe20,0x7850,0xf510,0x18170,0x1fe30
.long 0x7860,0xf520,0x18180,0x1fe40,0x7870,0xf530,0x18190,0x1fe50
.long 0x7880,0xf540,0x17200,0x1fe60,0x7890,0xf550,0x17210,0x1fe70
.long 0x8c00,0xf560,0x17220,0x1fe80,0x8c10,0xf570,0x17230,0x1fe90
.long 0x8c20,0xf580,0x17240,0x1ef00,0x8c30,0xf590,0x17250,0x1ef10
.long 0x8c40,0x10900,0x17260,0x1ef20,0x8c50,0x10910,0x17270,0x1ef30
.long 0x26c60,0x2f820,0x6e080,0xaf040,0x26c70,0x2f830,0x6e090,0xaf050
.long 0x26c80,0x2f840,0x70800,0xaf060,0x26c90,0x2f850,0x70810,0xaf070
.long 0x25d00,0x2f860,0x70820,0xaf080,0x25d10,0x2f870,0x70830,0xaf090
.long 0x25d20,0x2f880,0x70840,0xb1800,0x25d30,0x2f890,0x70850,0xb1810
.long 0x25d40,0x32000,0x70860,0xb1820,0x25d50,0x32010,0x70870,0xb1830
.long 0x25d60,0x32020,0x70880,0xb1840,0x25d70,0x32030,0x70890,0xb1850
.long 0x25d80,0x32040,0x73000,0xb1860,0x25d90,0x32050,0x73010,0xb1870
.long 0x27100,0x32060,0x73020,0xb1880,0x27110,0x32070,0x73030,0xb1890
.long 0x27120,0x32080,0x73040,0xb4000,0x27130,0x32090,0x73050,0xb4010
.long 0x27140,0x34800,0x73060,0xb4020,0x27150,0x34810,0x73070,0xb4030
.long 0x27160,0x34820,0x73080,0xb4040,0x27170,0x34830,0x73090,0xb4050
.long 0x27180,0x34840,0x75800,0xb4060,0x27190,0x34850,0x75810,0xb4070
.long 0x26200,0x34860,0x75820,0xb4080,0x26210,0x34870,0x75830,0xb4090
.long 0x26220,0x34880,0x75840,0xb6800,0x26230,0x34890,0x75850,0xb6810
.long 0x26240,0x37000,0x75860,0xb6820,0x26250,0x37010,0x75870,0xb6830
.long 0x26260,0x37020,0x75880,0xb6840,0x26270,0x37030,0x75890,0xb6850
.long 0x26280,0x37040,0x78000,0xb6860,0x26290,0x37050,0x78010,0xb6870
.long 0x27600,0x37060,0x78020,0xb6880,0x27610,0x37070,0x78030,0xb6890
.long 0x27620,0x37080,0x78040,0xb9000,0x27630,0x37090,0x78050,0xb9010
.long 0x27640,0x39800,0x78060,0xb9020,0x27650,0x39810,0x78070,0xb9030
.long 0x27660,0x39820,0x78080,0xb9040,0x27670,0x39830,0x78090,0xb9050
.long 0x27680,0x39840,0x7a800,0xb9060,0x27690,0x39850,0x7a810,0xb9070
.long 0x26700,0x39860,0x7a820,0xb9080,0x26710,0x39870,0x7a830,0xb9090
.long 0x26720,0x39880,0x7a840,0xbb800,0x26730,0x39890,0x7a850,0xbb810
.long 0x26740,0x3c000,0x7a860,0xbb820,0x26750,0x3c010,0x7a870,0xbb830
.long 0x26760,0x3c020,0x7a880,0xbb840,0x26770,0x3c030,0x7a890,0xbb850
.long 0x26780,0x3c040,0x7d000,0xbb860,0x26790,0x3c050,0x7d010,0xbb870
.long 0x27b00,0x3c060,0x7d020,0xbb880,0x27b10,0x3c070,0x7d030,0xbb890
.long 0x27b20,0x3c080,0x7d040,0xbe000,0x27b30,0x3c090,0x7d050,0xbe010
.long 0x27b40,0x3e800,0x7d060,0xbe020,0x27b50,0x3e810,0x7d070,0xbe030
.long 0x27b60,0x3e820,0x7d080,0xbe040,0x27b70,0x3e830,0x7d090,0xbe050
.long 0x27b80,0x3e840,0x7f800,0xbe060,0x27b90,0x3e850,0x7f810,0xbe070
.long 0xf0000,0x12e860,0x7800,0x7800,0xf0010,0x12e870,0x7808,0x7808
.long 0xf0020,0x12e880,0x7810,0x81c0,0xf0030,0x12e890,0x7818,0x81c8
.long 0xf0040,0x131000,0x7940,0x7940,0xf0050,0x131010,0x7948,0x7948
.long 0xf0060,0x131020,0x7950,0x8300,0xf0070,0x131030,0x7958,0x8308
.long 0xf0080,0x131040,0x7a80,0x7a80,0xf0090,0x131050,0x7a88,0x7a88
.long 0xf2800,0x131060,0x7a90,0x8440,0xf2810,0x131070,0x7a98,0x8448
.long 0xf2820,0x131080,0x7bc0,0x7bc0,0xf2830,0x131090,0x7bc8,0x7bc8
.long 0xf2840,0x133800,0x7bd0,0x8580,0xf2850,0x133810,0x7bd8,0x8588
.long 0xf2860,0x133820,0x78a0,0x78a0,0xf2870,0x133830,0x78a8,0x78a8
.long 0xf2880,0x133840,0x78b0,0x8260,0xf2890,0x133850,0x78b8,0x8268
.long 0xf5000,0x133860,0x79e0,0x79e0,0xf5010,0x133870,0x79e8,0x79e8
.long 0xf5020,0x133880,0x79f0,0x83a0,0xf5030,0x133890,0x79f8,0x83a8
.long 0xf5040,0x136000,0x7b20,0x7b20,0xf5050,0x136010,0x7b28,0x7b28
.long 0xf5060,0x136020,0x7b30,0x84e0,0xf5070,0x136030,0x7b38,0x84e8
.long 0xf5080,0x136040,0x7c60,0x7c60,0xf5090,0x136050,0x7c68,0x7c68
.long 0xf7800,0x136060,0x7c70,0x8620,0xf7810,0x136070,0x7c78,0x8628
.long 0xf7820,0x136080,0x7850,0x7850,0xf7830,0x136090,0x7858,0x7858
.long 0xf7840,0x138800,0x7860,0x8210,0xf7850,0x138810,0x7868,0x8218
.long 0xf7860,0x138820,0x7990,0x7990,0xf7870,0x138830,0x7998,0x7998
.long 0xf7880,0x138840,0x79a0,0x8350,0xf7890,0x138850,0x79a8,0x8358
.long 0xfa000,0x138860,0x7ad0,0x7ad0,0xfa010,0x138870,0x7ad8,0x7ad8
.long 0xfa020,0x138880,0x7ae0,0x8490,0xfa030,0x138890,0x7ae8,0x8498
.long 0xfa040,0x13b000,0x7c10,0x7c10,0xfa050,0x13b010,0x7c18,0x7c18
.long 0xfa060,0x13b020,0x7c20,0x85d0,0xfa070,0x13b030,0x7c28,0x85d8
.long 0xfa080,0x13b040,0x78f0,0x78f0,0xfa090,0x13b050,0x78f8,0x78f8
.long 0xfc800,0x13b060,0x7900,0x82b0,0xfc810,0x13b070,0x7908,0x82b8
.long 0xfc820,0x13b080,0x7a30,0x7a30,0xfc830,0x13b090,0x7a38,0x7a38
.long 0xfc840,0x13d800,0x7a40,0x83f0,0xfc850,0x13d810,0x7a48,0x83f8
.long 0xfc860,0x13d820,0x7b70,0x7b70,0xfc870,0x13d830,0x7b78,0x7b78
.long 0xfc880,0x13d840,0x7b80,0x8530,0xfc890,0x13d850,0x7b88,0x8538
.long 0xff000,0x13d860,0x7cb0,0x7cb0,0xff010,0x13d870,0x7cb8,0x7cb8
.long 0xff020,0x13d880,0x7cc0,0x8670,0xff030,0x13d890,0x7cc8,0x8678
.long 0x12c80,0x13180,0x13680,0x16880,0x12c88,0x13188,0x13688,0x16888
.long 0x12c90,0x13190,0x13690,0x16890,0x12c98,0x13198,0x13698,0x16898
.long 0x12dc0,0x132c0,0x137c0,0x169c0,0x12dc8,0x132c8,0x137c8,0x169c8
.long 0x12dd0,0x132d0,0x137d0,0x169d0,0x12dd8,0x132d8,0x137d8,0x169d8
.long 0x12f00,0x13400,0x13900,0x16b00,0x12f08,0x13408,0x13908,0x16b08
.long 0x12f10,0x13410,0x13910,0x16b10,0x12f18,0x13418,0x13918,0x16b18
.long 0x13040,0x13540,0x13a40,0x16c40,0x13048,0x13548,0x13a48,0x16c48
.long 0x13050,0x13550,0x13a50,0x16c50,0x13058,0x13558,0x13a58,0x16c58
.long 0x12d20,0x13220,0x14120,0x17320,0x12d28,0x13228,0x14128,0x17328
.long 0x12d30,0x13230,0x14130,0x17330,0x12d38,0x13238,0x14138,0x17338
.long 0x12e60,0x13360,0x14260,0x17460,0x12e68,0x13368,0x14268,0x17468
.long 0x12e70,0x13370,0x14270,0x17470,0x12e78,0x13378,0x14278,0x17478
.long 0x12fa0,0x134a0,0x143a0,0x175a0,0x12fa8,0x134a8,0x143a8,0x175a8
.long 0x12fb0,0x134b0,0x143b0,0x175b0,0x12fb8,0x134b8,0x143b8,0x175b8
.long 0x130e0,0x135e0,0x144e0,0x176e0,0x130e8,0x135e8,0x144e8,0x176e8
.long 0x130f0,0x135f0,0x144f0,0x176f0,0x130f8,0x135f8,0x144f8,0x176f8
.long 0x13720,0x13c20,0x14f80,0x18180,0x13728,0x13c28,0x14f88,0x18188
.long 0x13730,0x13c30,0x14f90,0x18190,0x13738,0x13c38,0x14f98,0x18198
.long 0x13860,0x13d60,0x150c0,0x182c0,0x13868,0x13d68,0x150c8,0x182c8
.long 0x13870,0x13d70,0x150d0,0x182d0,0x13878,0x13d78,0x150d8,0x182d8
.long 0x139a0,0x13ea0,0x15200,0x18400,0x139a8,0x13ea8,0x15208,0x18408
.long 0x139b0,0x13eb0,0x15210,0x18410,0x139b8,0x13eb8,0x15218,0x18418
.long 0x13ae0,0x13fe0,0x15340,0x18540,0x13ae8,0x13fe8,0x15348,0x18548
.long 0x13af0,0x13ff0,0x15350,0x18550,0x13af8,0x13ff8,0x15358,0x18558
.long 0x13b80,0x14080,0x15a20,0x18c20,0x13b88,0x14088,0x15a28,0x18c28
.long 0x13b90,0x14090,0x15a30,0x18c30,0x13b98,0x14098,0x15a38,0x18c38
.long 0x13cc0,0x141c0,0x15b60,0x18d60,0x13cc8,0x141c8,0x15b68,0x18d68
.long 0x13cd0,0x141d0,0x15b70,0x18d70,0x13cd8,0x141d8,0x15b78,0x18d78
.long 0x13e00,0x14300,0x15ca0,0x18ea0,0x13e08,0x14308,0x15ca8,0x18ea8
.long 0x13e10,0x14310,0x15cb0,0x18eb0,0x13e18,0x14318,0x15cb8,0x18eb8
.long 0x13f40,0x14440,0x15de0,0x18fe0,0x13f48,0x14448,0x15de8,0x18fe8
.long 0x13f50,0x14450,0x15df0,0x18ff0,0x13f58,0x14458,0x15df8,0x18ff8
.long 0x40,0xae0,0xa40,0x21fc0,0x48,0xae8,0xa48,0x224c8
.long 0x50,0xaf0,0xa50,0x229d0,0x58,0xaf8,0xa58,0x22ed8
.long 0x180,0xc20,0xb80,0x233e0,0x188,0xc28,0xb88,0x238e8
.long 0x190,0xc30,0xb90,0x23df0,0x198,0xc38,0xb98,0x242f8
.long 0x2c0,0xd60,0xcc0,0x24800,0x2c8,0xd68,0xcc8,0x24d08
.long 0x2d0,0xd70,0xcd0,0x25210,0x2d8,0xd78,0xcd8,0x25718
.long 0x400,0xea0,0xe00,0x25c20,0x408,0xea8,0xe08,0x26128
.long 0x410,0xeb0,0xe10,0x26630,0x418,0xeb8,0xe18,0x26b38
.long 0x60,0xb00,0xa60,0x21fc8,0x68,0xb08,0xa68,0x224d0
.long 0x70,0xb10,0xa70,0x229d8,0x78,0xb18,0xa78,0x22ee0
.long 0x1a0,0xc40,0xba0,0x233e8,0x1a8,0xc48,0xba8,0x238f0
.long 0x1b0,0xc50,0xbb0,0x23df8,0x1b8,0xc58,0xbb8,0x24300
.long 0x2e0,0xd80,0xce0,0x24808,0x2e8,0xd88,0xce8,0x24d10
.long 0x2f0,0xd90,0xcf0,0x25218,0x2f8,0xd98,0xcf8,0x25720
.long 0x420,0xec0,0xe20,0x25c28,0x428,0xec8,0xe28,0x26130
.long 0x430,0xed0,0xe30,0x26638,0x438,0xed8,0xe38,0x26b40
.long 0xe0,0xf40,0x14e0,0x21fd0,0xe8,0xf48,0x14e8,0x224d8
.long 0xf0,0xf50,0x14f0,0x229e0,0xf8,0xf58,0x14f8,0x22ee8
.long 0x220,0x1080,0x1620,0x233f0,0x228,0x1088,0x1628,0x238f8
.long 0x230,0x1090,0x1630,0x23e00,0x238,0x1098,0x1638,0x24308
.long 0x360,0x11c0,0x1760,0x24810,0x368,0x11c8,0x1768,0x24d18
.long 0x370,0x11d0,0x1770,0x25220,0x378,0x11d8,0x1778,0x25728
.long 0x4a0,0x1300,0x18a0,0x25c30,0x4a8,0x1308,0x18a8,0x26138
.long 0x4b0,0x1310,0x18b0,0x26640,0x4b8,0x1318,0x18b8,0x26b48
.long 0x100,0xf60,0x1500,0x21fd8,0x108,0xf68,0x1508,0x224e0
.long 0x110,0xf70,0x1510,0x229e8,0x118,0xf78,0x1518,0x22ef0
.long 0x240,0x10a0,0x1640,0x233f8,0x248,0x10a8,0x1648,0x23900
.long 0x250,0x10b0,0x1650,0x23e08,0x258,0x10b8,0x1658,0x24310
.long 0x380,0x11e0,0x1780,0x24818,0x388,0x11e8,0x1788,0x24d20
.long 0x390,0x11f0,0x1790,0x25228,0x398,0x11f8,0x1798,0x25730
.long 0x4c0,0x1320,0x18c0,0x25c38,0x4c8,0x1328,0x18c8,0x26140
.long 0x4d0,0x1330,0x18d0,0x26648,0x4d8,0x1338,0x18d8,0x26b50
.long 0xa000,0x12000,0x15640,0x0,0xa010,0x12008,0x156f0,0x80
.long 0xa020,0x12010,0x157a0,0x100,0xa030,0x12018,0x15850,0x180
.long 0xa040,0x12020,0x15900,0x200,0xa050,0x12028,0x159b0,0x280
.long 0xa060,0x12030,0x15a60,0x300,0xa070,0x12038,0x15b10,0x380
.long 0xa080,0x12040,0x15bc0,0x0,0xa090,0x12048,0x15c70,0x80
.long 0xa0a0,0x12050,0x15d20,0x100,0xa0b0,0x12058,0x15dd0,0x180
.long 0xa0c0,0x12060,0x15e80,0x200,0xa0d0,0x12068,0x15f30,0x280
.long 0xa0e0,0x12070,0x15fe0,0x300,0xa0f0,0x12078,0x16090,0x380
.long 0xa100,0x12080,0x16140,0x0,0xa110,0x12088,0x161f0,0x80
.long 0xa120,0x12090,0x162a0,0x100,0xa130,0x12098,0x16350,0x180
.long 0xa140,0x120a0,0x16400,0x200,0xa150,0x120a8,0x164b0,0x280
.long 0xa160,0x120b0,0x16560,0x300,0xa170,0x120b8,0x16610,0x380
.long 0xa180,0x120c0,0x166c0,0x0,0xa190,0x120c8,0x16770,0x80
.long 0xa1a0,0x120d0,0x16820,0x100,0xa1b0,0x120d8,0x168d0,0x180
.long 0xa1c0,0x120e0,0x16980,0x200,0xa1d0,0x120e8,0x16a30,0x280
.long 0xa1e0,0x120f0,0x16ae0,0x300,0xa1f0,0x120f8,0x16b90,0x380
.long 0xa200,0x12100,0x15648,0x0,0xa210,0x12108,0x156f8,0x80
.long 0xa220,0x12110,0x157a8,0x100,0xa230,0x12118,0x15858,0x180
.long 0xa240,0x12120,0x15908,0x200,0xa250,0x12128,0x159b8,0x280
.long 0xa260,0x12130,0x15a68,0x300,0xa270,0x12138,0x15b18,0x380
.long 0xa280,0x12140,0x15bc8,0x0,0xa290,0x12148,0x15c78,0x80
.long 0xa2a0,0x12150,0x15d28,0x100,0xa2b0,0x12158,0x15dd8,0x180
.long 0xa2c0,0x12160,0x15e88,0x200,0xa2d0,0x12168,0x15f38,0x280
.long 0xa2e0,0x12170,0x15fe8,0x300,0xa2f0,0x12178,0x16098,0x380
.long 0xa300,0x12180,0x16148,0x0,0xa310,0x12188,0x161f8,0x80
.long 0xa320,0x12190,0x162a8,0x100,0xa330,0x12198,0x16358,0x180
.long 0xa340,0x121a0,0x16408,0x200,0xa350,0x121a8,0x164b8,0x280
.long 0xa360,0x121b0,0x16568,0x300,0xa370,0x121b8,0x16618,0x380
.long 0xa380,0x121c0,0x166c8,0x0,0xa390,0x121c8,0x16778,0x80
.long 0xa3a0,0x121d0,0x16828,0x100,0xa3b0,0x121d8,0x168d8,0x180
.long 0xa3c0,0x121e0,0x16988,0x200,0xa3d0,0x121e8,0x16a38,0x280
.long 0xa3e0,0x121f0,0x16ae8,0x300,0xa3f0,0x121f8,0x16b98,0x380
.long 0x15ec0,0x1b880,0x1c000,0x1dc00,0x15ed0,0x1b890,0x1c010,0x1dc10
.long 0x15ef0,0x1c200,0x1c020,0x1dc20,0x15f00,0x1c210,0x1c030,0x1dc30
.long 0x15f10,0x1c220,0x1c040,0x1dc40,0x15f20,0x1c230,0x1c050,0x1dc50
.long 0x15f30,0x1c240,0x1c060,0x1dc60,0x15f40,0x1c250,0x1c070,0x1dc70
.long 0x15f50,0x1c260,0x1c080,0x1dc80,0x15f60,0x1c270,0x1c090,0x1dc90
.long 0x15f70,0x1c280,0x1c0a0,0x1dca0,0x15f80,0x1c290,0x1c0b0,0x1dcb0
.long 0x15fa0,0x1cc00,0x1c0c0,0x1dcc0,0x15fb0,0x1cc10,0x1c0d0,0x1dcd0
.long 0x15fc0,0x1cc20,0x1c0e0,0x1dce0,0x15fd0,0x1cc30,0x1c0f0,0x1dcf0
.long 0x15fe0,0x1cc40,0x1c100,0x1dd00,0x15ff0,0x1cc50,0x1c110,0x1dd10
.long 0x16000,0x1cc60,0x1c120,0x1dd20,0x16010,0x1cc70,0x1c130,0x1dd30
.long 0x16020,0x1cc80,0x1c140,0x1dd40,0x16030,0x1cc90,0x1c150,0x1dd50
.long 0x16050,0x1d600,0x1c160,0x1dd60,0x16060,0x1d610,0x1c170,0x1dd70
.long 0x16070,0x1d620,0x1c180,0x1dd80,0x16080,0x1d630,0x1c190,0x1dd90
.long 0x16090,0x1d640,0x1c1a0,0x1dda0,0x160a0,0x1d650,0x1c1b0,0x1ddb0
.long 0x160b0,0x1d660,0x1c1c0,0x1ddc0,0x160c0,0x1d670,0x1c1d0,0x1ddd0
.long 0x160d0,0x1d680,0x1c1e0,0x1dde0,0x160e0,0x1d690,0x1c1f0,0x1ddf0
.long 0x16100,0x1e000,0x1c200,0x1de00,0x16110,0x1e010,0x1c210,0x1de10
.long 0x16120,0x1e020,0x1c220,0x1de20,0x16130,0x1e030,0x1c230,0x1de30
.long 0x16140,0x1e040,0x1c240,0x1de40,0x16150,0x1e050,0x1c250,0x1de50
.long 0x16160,0x1e060,0x1c260,0x1de60,0x16170,0x1e070,0x1c270,0x1de70
.long 0x16180,0x1e080,0x1c280,0x1de80,0x16190,0x1e090,0x1c290,0x1de90
.long 0x161b0,0x1ea00,0x1c2a0,0x1dea0,0x161c0,0x1ea10,0x1c2b0,0x1deb0
.long 0x161d0,0x1ea20,0x1c2c0,0x1dec0,0x161e0,0x1ea30,0x1c2d0,0x1ded0
.long 0x161f0,0x1ea40,0x1c2e0,0x1dee0,0x16200,0x1ea50,0x1c2f0,0x1def0
.long 0x16210,0x1ea60,0x1c300,0x1df00,0x16220,0x1ea70,0x1c310,0x1df10
.long 0x16230,0x1ea80,0x1c320,0x1df20,0x16240,0x1ea90,0x1c330,0x1df30
.long 0x16260,0x1f400,0x1c340,0x1df40,0x16270,0x1f410,0x1c350,0x1df50
.long 0x16280,0x1f420,0x1c360,0x1df60,0x16290,0x1f430,0x1c370,0x1df70
.long 0x162a0,0x1f440,0x1c380,0x1df80,0x162b0,0x1f450,0x1c390,0x1df90
.long 0x162c0,0x1f460,0x1c3a0,0x1dfa0,0x162d0,0x1f470,0x1c3b0,0x1dfb0
.long 0x162e0,0x1f480,0x1c3c0,0x1dfc0,0x162f0,0x1f490,0x1c3d0,0x1dfd0
.long 0x16310,0x1fe00,0x1c3e0,0x1dfe0,0x16320,0x1fe10,0x1c3f0,0x1dff0
.size tab_h, 69632
.p2align 8
.type tab_hid,@object
tab_hid:
.long 0x3f803f80,0x3f803f80,0x3f803f80,0x3f803f80,0x3f7b3f80,0x3f553f6d,0x3f0e3f35,0x3e483ec4
.long 0x3f6d3f80,0x3ec43f35,0xbec4248d,0xbf6dbf35,0x3f553f80,0xbe483ec4,0xbf7bbf35,0xbf0ebf6d
.long 0xbf803f80,0xbf803f80,0xbf803f80,0xbf803f80,0xbf7b3f80,0xbf553f6d,0xbf0e3f35,0xbe483ec4
.long 0xbf6d3f80,0xbec43f35,0x3ec4261f,0x3f6dbf35,0xbf553f80,0x3e483ec4,0x3f7bbf35,0x3f0ebf6d
.long 0x3f353f80,0xbf35248d,0xbf35bf80,0x3f35a554,0x3f0e3f80,0xbf7bbec4,0x3e48bf35,0x3f553f6d
.long 0x3ec43f80,0xbf6dbf35,0x3f6da554,0xbec43f35,0x3e483f80,0xbf0ebf6d,0x3f553f35,0xbf7bbec4
.long 0xbf353f80,0x3f3525b0,0x3f35bf80,0xbf35a742,0xbf0e3f80,0x3f7bbec4,0xbe48bf35,0xbf553f6d
.long 0xbec43f80,0x3f6dbf35,0xbf6da731,0x3ec43f35,0xbe483f80,0x3f0ebf6d,0xbf553f35,0x3f7bbec4
.long 0x248d3f80,0xa554bf80,0x25b03f80,0xa5f7bf80,0xbe483f80,0x3f0ebf6d,0xbf553f35,0x3f7bbec4
.long 0xbec43f80,0x3f6dbf35,0xbf6d25b0,0x3ec43f35,0xbf0e3f80,0x3f7bbec4,0xbe48bf35,0xbf553f6d
.long 0xa5543f80,0x261fbf80,0xa7423f80,0xa60dbf80,0x3e483f80,0xbf0ebf6d,0x3f553f35,0xbf7bbec4
.long 0x3ec43f80,0xbf6dbf35,0x3f6da68d,0xbec43f35,0x3f0e3f80,0xbf7bbec4,0x3e48bf35,0x3f553f6d
.long 0xbf353f80,0x3f35a554,0x3f35bf80,0xbf35261f,0xbf553f80,0x3e483ec4,0x3f7bbf35,0x3f0ebf6d
.long 0xbf6d3f80,0xbec43f35,0x3ec4a5f7,0x3f6dbf35,0xbf7b3f80,0xbf553f6d,0xbf0e3f35,0xbe483ec4
.long 0x3f353f80,0xbf35a5f7,0xbf35bf80,0x3f35a60d,0x3f553f80,0xbe483ec4,0xbf7bbf35,0xbf0ebf6d
.long 0x3f6d3f80,0x3ec43f35,0xbec4a742,0xbf6dbf35,0x3f7b3f80,0x3f553f6d,0x3f0e3f35,0x3e483ec4
.long 0x3f803f80,0x3f803f80,0x3f803f80,0x3f803f80,0xbe48248d,0xbf0ebec4,0xbf55bf35,0xbf7bbf6d
.long 0xbf6dbf80,0xbec4bf35,0x3ec4a554,0x3f6d3f35,0x3f0ea554,0x3f7b3f6d,0x3e483f35,0xbf55bec4
.long 0xbf803f80,0xbf803f80,0xbf803f80,0xbf803f80,0x3e48a654,0x3f0ebec4,0x3f55bf35,0x3f7bbf6d
.long 0x3f6dbf80,0x3ec4bf35,0xbec4a777,0xbf6d3f35,0xbf0ea754,0xbf7b3f6d,0xbe483f35,0x3f55bec4
.long 0x3f353f80,0xbf3525b0,0xbf35bf80,0x3f35a5f7,0xbf5525b0,0xbe48bf6d,0x3f7b3f35,0xbf0e3ec4
.long 0xbec4bf80,0x3f6d3f35,0xbf6d261f,0x3ec4bf35,0x3f7ba5f7,0xbf553ec4,0x3f0ebf35,0xbe483f6d
.long 0xbf353f80,0x3f35a58e,0x3f35bf80,0xbf35a78d,0x3f55a60d,0x3e48bf6d,0xbf7b3f35,0x3f0e3ec4
.long 0x3ec4bf80,0xbf6d3f35,0x3f6d258d,0xbec4bf35,0xbf7ba765,0x3f553ec4,0xbf0ebf35,0x3e483f6d
.long 0x261f3f80,0xa731bf80,0xa68d3f80,0xa742bf80,0xbf7b261f,0x3f553ec4,0xbf0ebf35,0x3e483f6d
.long 0x3ec4bf80,0xbf6d3f35,0x3f6da742,0xbec4bf35,0x3f55a731,0x3e48bf6d,0xbf7b3f35,0x3f0e3ec4
.long 0xa7773f80,0x2804bf80,0x27543f80,0x2889bf80,0x3f7ba58e,0xbf553ec4,0x3f0ebf35,0xbe483f6d
.long 0xbec4bf80,0x3f6d3f35,0xbf6da796,0x3ec4bf35,0xbf55a777,0xbe48bf6d,0x3f7b3f35,0xbf0e3ec4
.long 0xbf353f80,0x3f35a742,0x3f35bf80,0xbf35a60d,0xbf0ea68d,0xbf7b3f6d,0xbe483f35,0x3f55bec4
.long 0x3f6dbf80,0x3ec4bf35,0xbec4a60d,0xbf6d3f35,0x3e48a742,0x3f0ebec4,0x3f55bf35,0x3f7bbf6d
.long 0x3f353f80,0xbf35a78d,0xbf35bf80,0x3f352816,0x3f0ea137,0x3f7b3f6d,0x3e483f35,0xbf55bec4
.long 0xbf6dbf80,0xbec4bf35,0x3ec4268d,0x3f6d3f35,0xbe48a784,0xbf0ebec4,0xbf55bf35,0xbf7bbf6d
.long 0x3f803f80,0x3f803f80,0x3f803f80,0x3f803f80,0xbf7bbf80,0xbf55bf6d,0xbf0ebf35,0xbe48bec4
.long 0x3f6d3f80,0x3ec43f35,0xbec425b0,0xbf6dbf35,0xbf55bf80,0x3e48bec4,0x3f7b3f35,0x3f0e3f6d
.long 0xbf803f80,0xbf803f80,0xbf803f80,0xbf803f80,0x3f7bbf80,0x3f55bf6d,0x3f0ebf35,0x3e48bec4
.long 0xbf6d3f80,0xbec43f35,0x3ec4268d,0x3f6dbf35,0x3f55bf80,0xbe48bec4,0xbf7b3f35,0xbf0e3f6d
.long 0x3f353f80,0xbf35261f,0xbf35bf80,0x3f35a731,0xbf0ebf80,0x3f7b3ec4,0xbe483f35,0xbf55bf6d
.long 0x3ec43f80,0xbf6dbf35,0x3f6da742,0xbec43f35,0xbe48bf80,0x3f0e3f6d,0xbf55bf35,0x3f7b3ec4
.long 0xbf353f80,0x3f35268d,0x3f35bf80,0xbf35a85d,0x3f0ebf80,0xbf7b3ec4,0x3e483f35,0x3f55bf6d
.long 0xbec43f80,0x3f6dbf35,0xbf6d270d,0x3ec43f35,0x3e48bf80,0xbf0e3f6d,0x3f55bf35,0xbf7b3ec4
.long 0xa6543f80,0xa754bf80,0xa60d3f80,0xa765bf80,0x3e48bf80,0xbf0e3f6d,0x3f55bf35,0xbf7b3ec4
.long 0xbec43f80,0x3f6dbf35,0xbf6da58e,0x3ec43f35,0x3f0ebf80,0xbf7b3ec4,0x3e483f35,0x3f55bf6d
.long 0x28283f80,0x281fbf80,0x26d43f80,0x2730bf80,0xbe48bf80,0x3f0e3f6d,0xbf55bf35,0x3f7b3ec4
.long 0x3ec43f80,0xbf6dbf35,0x3f6d2828,0xbec43f35,0xbf0ebf80,0x3f7b3ec4,0xbe483f35,0xbf55bf6d
.long 0xbf353f80,0x3f35a777,0x3f35bf80,0xbf352804,0x3f55bf80,0xbe48bec4,0xbf7b3f35,0xbf0e3f6d
.long 0xbf6d3f80,0xbec43f35,0x3ec4a78d,0x3f6dbf35,0x3f7bbf80,0x3f55bf6d,0x3f0ebf35,0x3e48bec4
.long 0x3f353f80,0xbf3526d4,0xbf35bf80,0x3f35289a,0xbf55bf80,0x3e48bec4,0x3f7b3f35,0x3f0e3f6d
.long 0x3f6d3f80,0x3ec43f35,0xbec4a7e5,0xbf6dbf35,0xbf7bbf80,0xbf55bf6d,0xbf0ebf35,0xbe48bec4
.long 0x3f803f80,0x3f803f80,0x3f803f80,0x3f803f80,0x3e48a554,0x3f0e3ec4,0x3f553f35,0x3f7b3f6d
.long 0xbf6dbf80,0xbec4bf35,0x3ec4a5f7,0x3f6d3f35,0xbf0e261f,0xbf7bbf6d,0xbe48bf35,0x3f553ec4
.long 0xbf803f80,0xbf803f80,0xbf803f80,0xbf803f80,0xbe48a7b1,0xbf0e3ec4,0xbf553f35,0xbf7b3f6d
.long 0x3f6dbf80,0x3ec4bf35,0xbec426d4,0xbf6d3f35,0x3f0e281f,0x3f7bbf6d,0x3e48bf35,0xbf553ec4
.long 0x3f353f80,0xbf35a68d,0xbf35bf80,0x3f35a742,0x3f55a742,0x3e483f6d,0xbf7bbf35,0x3f0ebec4
.long 0xbec4bf80,0x3f6d3f35,0xbf6da60d,0x3ec4bf35,0xbf7ba60d,0x3f55bec4,0xbf0e3f35,0x3e48bf6d
.long 0xbf353f80,0x3f35a7b1,0x3f35bf80,0xbf35a7e5,0xbf5526d4,0xbe483f6d,0x3f7bbf35,0xbf0ebec4
.long 0x3ec4bf80,0xbf6d3f35,0x3f6d2754,0xbec4bf35,0x3f7b2730,0xbf55bec4,0x3f0e3f35,0xbe48bf6d
.long 0xa58e3f80,0xa777bf80,0xa1373f80,0xa784bf80,0x3f7ba777,0xbf55bec4,0x3f0e3f35,0xbe48bf6d
.long 0x3ec4bf80,0xbf6d3f35,0x3f6da78d,0xbec4bf35,0xbf55258d,0xbe483f6d,0x3f7bbf35,0xbf0ebec4
.long 0xa7e53f80,0x2839bf80,0xa8803f80,0x28a3bf80,0xbf7ba7e5,0x3f55bec4,0xbf0e3f35,0x3e48bf6d
.long 0xbec4bf80,0x3f6d3f35,0xbf6da804,0x3ec4bf35,0x3f552839,0x3e483f6d,0xbf7bbf35,0x3f0ebec4
.long 0xbf353f80,0x3f352754,0x3f35bf80,0xbf352889,0x3f0ea796,0x3f7bbf6d,0x3e48bf35,0xbf553ec4
.long 0x3f6dbf80,0x3ec4bf35,0xbec42816,0xbf6d3f35,0xbe48268d,0xbf0e3ec4,0xbf553f35,0xbf7b3f6d
.long 0x3f353f80,0xbf3528be,0xbf35bf80,0x3f3528ea,0xbf0ea880,0xbf7bbf6d,0xbe48bf35,0x3f553ec4
.long 0xbf6dbf80,0xbec4bf35,0x3ec4a731,0x3f6d3f35,0x3e4828a3,0x3f0e3ec4,0x3f553f35,0x3f7b3f6d
.long 0x80008000,0x80008000,0x80008000,0x80008000,0xbe488000,0xbf0ebec4,0xbf55bf35,0xbf7bbf6d
.long 0xbec48000,0xbf6dbf35,0xbf6dbf80,0xbec4bf35,0xbf0e8000,0xbf7bbf6d,0xbe48bf35,0x3f553ec4
.long 0xa50d8000,0xa5d4258d,0xa630260d,0xa6772654,0x3e488000,0x3f0ebec4,0x3f55bf35,0x3f7bbf6d
.long 0x3ec48000,0x3f6dbf35,0x3f6dbf80,0x3ec4bf35,0x3f0e8000,0x3f7bbf6d,0x3e48bf35,0xbf553ec4
.long 0xbf358000,0xbf35bf80,0x3f35a50d,0x3f353f80,0xbf558000,0xbe48bf6d,0x3f7b3f35,0xbf0e3ec4
.long 0xbf6d8000,0x3ec4bf35,0x3ec43f80,0xbf6dbf35,0xbf7b8000,0x3f55bec4,0xbf0e3f35,0x3e48bf6d
.long 0x3f358000,0x3f35bf80,0xbf35a630,0xbf353f80,0x3f558000,0x3e48bf6d,0xbf7b3f35,0x3f0e3ec4
.long 0x3f6d8000,0xbec4bf35,0xbec43f80,0x3f6dbf35,0x3f7b8000,0xbf55bec4,0x3f0e3f35,0xbe48bf6d
.long 0xbf808000,0x3f80a50d,0xbf80258d,0x3f80a5d4,0xbf7b8000,0x3f553ec4,0xbf0ebf35,0x3e483f6d
.long 0xbf6d8000,0x3ec43f35,0x3ec4bf80,0xbf6d3f35,0xbf558000,0xbe483f6d,0x3f7bbf35,0xbf0ebec4
.long 0x3f808000,0xbf80a5d4,0x3f802654,0xbf80a69f,0x3f7b8000,0xbf553ec4,0x3f0ebf35,0xbe483f6d
.long 0x3f6d8000,0xbec43f35,0xbec4bf80,0x3f6d3f35,0x3f558000,0x3e483f6d,0xbf7bbf35,0x3f0ebec4
.long 0xbf358000,0xbf353f80,0x3f35a5d4,0x3f35bf80,0xbf0e8000,0xbf7b3f6d,0xbe483f35,0x3f55bec4
.long 0xbec48000,0xbf6d3f35,0xbf6d3f80,0xbec43f35,0xbe488000,0xbf0e3ec4,0xbf553f35,0xbf7b3f6d
.long 0x3f358000,0x3f353f80,0xbf35a677,0xbf35bf80,0x3f0e8000,0x3f7b3f6d,0x3e483f35,0xbf55bec4
.long 0x3ec48000,0x3f6d3f35,0x3f6d3f80,0x3ec43f35,0x3e488000,0x3f0e3ec4,0x3f553f35,0x3f7b3f6d
.long 0x80008000,0x80008000,0x80008000,0x80008000,0xbf7bbf80,0xbf55bf6d,0xbf0ebf35,0xbe48bec4
.long 0x3ec4a50d,0x3f6d3f35,0x3f6d3f80,0x3ec43f35,0x3f553f80,0xbe483ec4,0xbf7bbf35,0xbf0ebf6d
.long 0xa69f268d,0xa7b126b0,0x270d26d4,0xa7c226f7,0x3f7bbf80,0x3f55bf6d,0x3f0ebf35,0x3e48bec4
.long 0xbec4a69f,0xbf6d3f35,0xbf6d3f80,0xbec43f35,0xbf553f80,0x3e483ec4,0x3f7bbf35,0x3f0ebf6d
.long 0xbf35258d,0xbf35bf80,0x3f35a5d4,0x3f353f80,0xbf0ebf80,0x3f7b3ec4,0xbe483f35,0xbf55bf6d
.long 0x3f6da5d4,0xbec43f35,0xbec4bf80,0x3f6d3f35,0x3e483f80,0xbf0ebf6d,0x3f553f35,0xbf7bbec4
.long 0x3f3526b0,0x3f35bf80,0xbf35a7c2,0xbf353f80,0x3f0ebf80,0xbf7b3ec4,0x3e483f35,0x3f55bf6d
.long 0xbf6da7b1,0x3ec43f35,0x3ec4bf80,0xbf6d3f35,0xbe483f80,0x3f0ebf6d,0xbf553f35,0x3f7bbec4
.long 0xbf80260d,0x3f80a630,0xbf802654,0x3f80a677,0x3e48bf80,0xbf0e3f6d,0x3f55bf35,0xbf7b3ec4
.long 0x3f6da630,0xbec4bf35,0xbec43f80,0x3f6dbf35,0xbf0e3f80,0x3f7bbec4,0xbe48bf35,0xbf553f6d
.long 0x3f8026d4,0xbf80a7c2,0x3f80271f,0xbf80268d,0xbe48bf80,0x3f0e3f6d,0xbf55bf35,0x3f7b3ec4
.long 0xbf6d270d,0x3ec4bf35,0x3ec43f80,0xbf6dbf35,0x3f0e3f80,0xbf7bbec4,0x3e48bf35,0x3f553f6d
.long 0xbf352654,0xbf353f80,0x3f35a69f,0x3f35bf80,0x3f55bf80,0xbe48bec4,0xbf7b3f35,0xbf0e3f6d
.long 0x3ec4a677,0x3f6dbf35,0x3f6dbf80,0x3ec4bf35,0xbf7b3f80,0xbf553f6d,0xbf0e3f35,0xbe483ec4
.long 0x3f3526f7,0x3f353f80,0xbf35268d,0xbf35bf80,0xbf55bf80,0x3e48bec4,0x3f7b3f35,0x3f0e3f6d
.long 0xbec4a7c2,0xbf6dbf35,0xbf6dbf80,0xbec4bf35,0x3f7b3f80,0x3f553f6d,0x3f0e3f35,0x3e483ec4
.long 0x80008000,0x80008000,0x80008000,0x80008000,0x3e48a50d,0x3f0e3ec4,0x3f553f35,0x3f7b3f6d
.long 0xbec4258d,0xbf6dbf35,0xbf6dbf80,0xbec4bf35,0x3f0ea5d4,0x3f7b3f6d,0x3e483f35,0xbf55bec4
.long 0x26d4270d,0xa7d4271f,0x268d2730,0xa7e52831,0xbe4826d4,0xbf0e3ec4,0xbf553f35,0xbf7b3f6d
.long 0x3ec4271f,0x3f6dbf35,0x3f6dbf80,0x3ec4bf35,0xbf0ea7d4,0xbf7b3f6d,0xbe483f35,0x3f55bec4
.long 0xbf35260d,0xbf35bf80,0x3f35a630,0x3f353f80,0x3f55a630,0x3e483f6d,0xbf7bbf35,0x3f0ebec4
.long 0xbf6d2654,0x3ec4bf35,0x3ec43f80,0xbf6dbf35,0x3f7ba677,0xbf553ec4,0x3f0ebf35,0xbe483f6d
.long 0x3f352730,0x3f35bf80,0xbf35260e,0xbf353f80,0xbf55268d,0xbe483f6d,0x3f7bbf35,0xbf0ebec4
.long 0x3f6d2831,0xbec4bf35,0xbec43f80,0x3f6dbf35,0xbf7ba7e5,0x3f553ec4,0xbf0ebf35,0x3e483f6d
.long 0xbf80268d,0x3f80a69f,0xbf8026b0,0x3f80a7b1,0x3f7ba69f,0xbf55bec4,0x3f0e3f35,0xbe48bf6d
.long 0xbf6d26b0,0x3ec43f35,0x3ec4bf80,0xbf6d3f35,0x3f55a7b1,0x3e48bf6d,0xbf7b3f35,0x3f0e3ec4
.long 0x3f802754,0xbf80a7f7,0x3f802842,0xbf80a884,0xbf7b260e,0x3f55bec4,0xbf0e3f35,0x3e48bf6d
.long 0x3f6da78d,0xbec43f35,0xbec4bf80,0x3f6d3f35,0xbf55a7f7,0xbe48bf6d,0x3f7b3f35,0xbf0e3ec4
.long 0xbf3526d4,0xbf353f80,0x3f35a7c2,0x3f35bf80,0x3f0e270d,0x3f7bbf6d,0x3e48bf35,0xbf553ec4
.long 0xbec426f7,0xbf6d3f35,0xbf6d3f80,0xbec43f35,0x3e48a7c2,0x3f0ebec4,0x3f55bf35,0x3f7bbf6d
.long 0x3f352777,0x3f353f80,0xbf35a80d,0xbf35bf80,0xbf0e21b7,0xbf7bbf6d,0xbe48bf35,0x3f553ec4
.long 0x3ec42842,0x3f6d3f35,0x3f6d3f80,0x3ec43f35,0xbe48a804,0xbf0ebec4,0xbf55bf35,0xbf7bbf6d
.long 0x80008000,0x80008000,0x80008000,0x80008000,0x3f7b3f80,0x3f553f6d,0x3f0e3f35,0x3e483ec4
.long 0x3ec4a5d4,0x3f6d3f35,0x3f6d3f80,0x3ec43f35,0xbf55bf80,0x3e48bec4,0x3f7b3f35,0x3f0e3f6d
.long 0x260e2754,0xa7f7a78d,0x21b72777,0xa8042842,0xbf7b3f80,0xbf553f6d,0xbf0e3f35,0xbe483ec4
.long 0xbec4a7f7,0xbf6d3f35,0xbf6d3f80,0xbec43f35,0x3f55bf80,0xbe48bec4,0xbf7b3f35,0xbf0e3f6d
.long 0xbf352654,0xbf35bf80,0x3f35a677,0x3f353f80,0x3f0e3f80,0xbf7bbec4,0x3e48bf35,0x3f553f6d
.long 0x3f6da69f,0xbec43f35,0xbec4bf80,0x3f6d3f35,0xbe48bf80,0x3f0e3f6d,0xbf55bf35,0x3f7b3ec4
.long 0x3f352842,0x3f35bf80,0xbf35a80d,0xbf353f80,0xbf0e3f80,0x3f7bbec4,0xbe48bf35,0xbf553f6d
.long 0xbf6da60d,0x3ec43f35,0x3ec4bf80,0xbf6d3f35,0x3e48bf80,0xbf0e3f6d,0x3f55bf35,0xbf7b3ec4
.long 0xbf8026d4,0x3f80270d,0xbf8026f7,0x3f80a7c2,0xbe483f80,0x3f0ebf6d,0xbf553f35,0x3f7bbec4
.long 0x3f6da7c2,0xbec4bf35,0xbec43f80,0x3f6dbf35,0x3f0ebf80,0xbf7b3ec4,0x3e483f35,0x3f55bf6d
.long 0x3f80279f,0xbf8027d4,0x3f80a70d,0xbf80a909,0x3e483f80,0xbf0ebf6d,0x3f553f35,0xbf7bbec4
.long 0xbf6da816,0x3ec4bf35,0x3ec43f80,0xbf6dbf35,0xbf0ebf80,0x3f7b3ec4,0xbe483f35,0xbf55bf6d
.long 0xbf35271f,0xbf353f80,0x3f35268d,0x3f35bf80,0xbf553f80,0x3e483ec4,0x3f7bbf35,0x3f0ebf6d
.long 0x3ec4268d,0x3f6dbf35,0x3f6dbf80,0x3ec4bf35,0x3f7bbf80,0x3f55bf6d,0x3f0ebf35,0x3e48bec4
.long 0x3f35a70d,0x3f353f80,0xbf35a896,0xbf35bf80,0x3f553f80,0xbe483ec4,0xbf7bbf35,0xbf0ebf6d
.long 0xbec4a70d,0xbf6dbf35,0xbf6dbf80,0xbec4bf35,0xbf7bbf80,0xbf55bf6d,0xbf0ebf35,0xbe48bec4
.long 0x3f800000,0x3f800000,0x3f800000,0x3f800000,0x3f800000,0x3f7ffcd7,0x3f7ff35e,0x3f7fe394
.long 0x3f800000,0x3f7ff35e,0x3f7fcd79,0x3f7f8e56,0x3f800000,0x3f7fe394,0x3f7f8e56,0x3f7f0059
.long 0x3f800000,0x3f7cd925,0x3f737871,0x3f641901,0x3f800000,0x3f7c7160,0x3f71decf,0x3f609384
.long 0x3f800000,0x3f7c0361,0x3f702d4f,0x3f5cdc29,0x3f800000,0x3f7b8f2a,0x3f6e641a,0x3f58f3c4
.long 0x3f800000,0x3f7fcd79,0x3f7f35f9,0x3f7e39bc,0x3f800000,0x3f7fb10f,0x3f7ec46d,0x3f7d3aac
.long 0x3f800000,0x3f7f8e56,0x3f7e39bc,0x3f7c0361,0x3f800000,0x3f7f654e,0x3f7d95f4,0x3f7a9421
.long 0x3f800000,0x3f7b14be,0x3f6c835e,0x3f54db31,0x3f800000,0x3f7a9421,0x3f6a8b4b,0x3f50935b
.long 0x3f800000,0x3f7a0d54,0x3f687c12,0x3f4c1d35,0x3f800000,0x3f79805c,0x3f6655e7,0x3f4779bc
.long 0x3f800000,0x3f7f35f9,0x3f7cd925,0x3f78ed3c,0x3f800000,0x3f7f0059,0x3f7c0361,0x3f770f11
.long 0x3f800000,0x3f7ec46d,0x3f7b14be,0x3f74fa0b,0x3f800000,0x3f7e8238,0x3f7a0d54,0x3f72ae9e
.long 0x3f800000,0x3f78ed3c,0x3f641901,0x3f42a9f7,0x3f800000,0x3f7853f8,0x3f61c598,0x3f3daef9
.long 0x3f800000,0x3f77b493,0x3f5f5be6,0x3f3889dc,0x3f800000,0x3f770f11,0x3f5cdc29,0x3f333bc6
.long 0x3f800000,0x3f7e39bc,0x3f78ed3c,0x3f702d4f,0x3f800000,0x3f7deafa,0x3f77b493,0x3f6d76aa
.long 0x3f800000,0x3f7d95f4,0x3f766377,0x3f6a8b4b,0x3f800000,0x3f7d3aac,0x3f74fa0b,0x3f676bd8
.long 0x3f800000,0x3f766377,0x3f5a46a0,0x3f2dc5e3,0x3f800000,0x3f75b1c9,0x3f579b8c,0x3f28296a
.long 0x3f800000,0x3f74fa0b,0x3f54db31,0x3f226799,0x3f800000,0x3f743c41,0x3f5205d4,0x3f1c81b9
.long 0x3f800000,0x3f800000,0x3f800000,0x3f800000,0x3f7fcd79,0x3f7fb10f,0x3f7f8e56,0x3f7f654e
.long 0x3f7f35f9,0x3f7ec46d,0x3f7e39bc,0x3f7d95f4,0x3f7e39bc,0x3f7d3aac,0x3f7c0361,0x3f7a9421
.long 0x3f4f1bbd,0x3f3504f3,0x3f167918,0x3ee87171,0x3f490a88,0x3f2beb4a,0x3f0a04f8,0x3ec8917e
.long 0x3f42a9f7,0x3f226799,0x3efa2c90,0x3ea7bf25,0x3f3bfc8f,0x3f187fc0,0x3edf7108,0x3e862210
.long 0x3f7cd925,0x3f7b14be,0x3f78ed3c,0x3f766377,0x3f7b14be,0x3f7853f8,0x3f74fa0b,0x3f710908
.long 0x3f78ed3c,0x3f74fa0b,0x3f702d4f,0x3f6a8b4b,0x3f766377,0x3f710908,0x3f6a8b4b,0x3f62f219
.long 0x3f3504f3,0x3f0e39da,0x3ec3ef15,0x3e47c5c2,0x3f2dc5e3,0x3f039c3d,0x3ea7bf25,0x3e0255f4
.long 0x3f26423a,0x3ef15aea,0x3e8afa3e,0x3d712283,0x3f1e7cf1,0x3edae880,0x3e5b73dc,0xbc20d8d2
.long 0x3f737871,0x3f6c835e,0x3f641901,0x3f5a46a0,0x3f702d4f,0x3f676bd8,0x3f5cdc29,0x3f50935b
.long 0x3f6c835e,0x3f61c598,0x3f54db31,0x3f45e403,0x3f687c12,0x3f5b941a,0x3f4c1d35,0x3f3a4582
.long 0x3f167918,0x3ec3ef15,0x3e20305b,0xbda0af2a,0x3f0e39da,0x3eac7cd4,0x3dc8bd36,0xbe164083
.long 0x3f05c277,0x3e94a031,0x3d20cee7,0xbe5b73dc,0x3efa2c90,0x3e78cfcc,0xbca0d6d6,0xbe8fcefe
.long 0x3f641901,0x3f54db31,0x3f42a9f7,0x3f2dc5e3,0x3f5f5be6,0x3f4d9f02,0x3f3889dc,0x3f207440
.long 0x3f5a46a0,0x3f45e403,0x3f2dc5e3,0x3f1260b2,0x3f54db31,0x3f3daef9,0x3f226799,0x3f039c3d
.long 0x3ee87171,0x3e47c5c2,0xbda0af2a,0xbeb13641,0x3ed65a92,0x3e164083,0xbe0c4cf7,0xbed1c759
.long 0x3ec3ef15,0x3dc8bd36,0xbe47c5c2,0xbef15aea,0x3eb13641,0x3d48fb30,0xbe814693,0xbf07e565
.long 0x3f800000,0x3f800000,0x3f800000,0x3f800000,0x3f7f35f9,0x3f7f0059,0x3f7ec46d,0x3f7e8238
.long 0x3f7cd925,0x3f7c0361,0x3f7b14be,0x3f7a0d54,0x3f78ed3c,0x3f770f11,0x3f74fa0b,0x3f72ae9e
.long 0x3e9e377a,0x3e20305b,0x248d3132,0xbe20305b,0x3e6f0c4d,0x3d8ca1f2,0xbdc8bd36,0xbe862210
.long 0x3e20305b,0xbca0d6d6,0xbe47c5c2,0xbeba9be1,0x3da0af2a,0xbddcbd0d,0xbe94a031,0xbeece91a
.long 0x3f737871,0x3f702d4f,0x3f6c835e,0x3f687c12,0x3f6c835e,0x3f676bd8,0x3f61c598,0x3f5b941a
.long 0x3f641901,0x3f5cdc29,0x3f54db31,0x3f4c1d35,0x3f5a46a0,0x3f50935b,0x3f45e403,0x3f3a4582
.long 0x248d3132,0xbe47c5c2,0xbec3ef15,0xbf0e39da,0xbda0af2a,0xbe8fcefe,0xbef15aea,0xbf2456f1
.long 0xbe20305b,0xbeba9be1,0xbf0e39da,0xbf3889dc,0xbe6f0c4d,0xbee3f40d,0xbf226799,0xbf4a965e
.long 0x3f4f1bbd,0x3f42a9f7,0x3f3504f3,0x3f26423a,0x3f42a9f7,0x3f333bc6,0x3f226799,0x3f104f0e
.long 0x3f3504f3,0x3f226799,0x3f0e39da,0x3ef15aea,0x3f26423a,0x3f104f0e,0x3ef15aea,0x3ebf47d7
.long 0xbe9e377a,0xbf05c277,0xbf3504f3,0xbf5a46a0,0xbec3ef15,0xbf187fc0,0xbf45e403,0xbf676bd8
.long 0xbee87171,0xbf2a0c73,0xbf54db31,0xbf71decf,0xbf05c277,0xbf3a4582,0xbf61c598,0xbf79805c
.long 0x3f167918,0x3efa2c90,0x3ec3ef15,0x3e8afa3e,0x3f05c277,0x3ed1c759,0x3e94a031,0x3e2a1c3f
.long 0x3ee87171,0x3ea7bf25,0x3e47c5c2,0x3d712283,0x3ec3ef15,0x3e78cfcc,0x3dc8bd36,0xbd48fb30
.long 0xbf167918,0xbf490a88,0xbf6c835e,0xbf7e39bc,0xbf26423a,0xbf563e03,0xbf74fa0b,0xbf7ffcd7
.long 0xbf3504f3,0xbf61c598,0xbf7b14be,0xbf7ec46d,0xbf42a9f7,0xbf6b8a3d,0xbf7ec46d,0xbf7a9421
.long 0x3f800000,0x3f800000,0x3f800000,0x3f800000,0x3f7e39bc,0x3f7deafa,0x3f7d95f4,0x3f7d3aac
.long 0x3f78ed3c,0x3f77b493,0x3f766377,0x3f74fa0b,0x3f702d4f,0x3f6d76aa,0x3f6a8b4b,0x3f676bd8
.long 0xbe9e377a,0xbee87171,0xbf167918,0xbf3504f3,0xbed65a92,0xbf104f0e,0xbf316e2c,0xbf4d9f02
.long 0xbf05c277,0xbf2a0c73,0xbf490a88,0xbf61c598,0xbf1e7cf1,0xbf4105b8,0xbf5cdc29,0xbf710908
.long 0x3f641901,0x3f5f5be6,0x3f5a46a0,0x3f54db31,0x3f54db31,0x3f4d9f02,0x3f45e403,0x3f3daef9
.long 0x3f42a9f7,0x3f3889dc,0x3f2dc5e3,0x3f226799,0x3f2dc5e3,0x3f207440,0x3f1260b2,0x3f039c3d
.long 0xbf3504f3,0xbf54db31,0xbf6c835e,0xbf7b14be,0xbf490a88,0xbf653a48,0xbf77b493,0xbf7fb10f
.long 0xbf5a46a0,0xbf71decf,0xbf7e39bc,0xbf7ec46d,0xbf687c12,0xbf7a9421,0xbf7ff35e,0xbf7853f8
.long 0x3f167918,0x3f05c277,0x3ee87171,0x3ec3ef15,0x3efa2c90,0x3ed1c759,0x3ea7bf25,0x3e78cfcc
.long 0x3ec3ef15,0x3e94a031,0x3e47c5c2,0x3dc8bd36,0x3e8afa3e,0x3e2a1c3f,0x3d712283,0xbd48fb30
.long 0xbf737871,0xbf7f35f9,0xbf7cd925,0xbf6c835e,0xbf7b14be,0xbf7fb10f,0xbf74fa0b,0xbf5b941a
.long 0xbf7f35f9,0xbf7c0361,0xbf687c12,0xbf45e403,0xbf7fcd79,0xbf743c41,0xbf579b8c,0xbf2beb4a
.long 0x3e20305b,0x3d20cee7,0xbda0af2a,0xbe47c5c2,0x3d20cee7,0xbdb4b86a,0xbe5b73dc,0xbeac7cd4
.long 0xbda0af2a,0xbe5b73dc,0xbeb13641,0xbef15aea,0xbe47c5c2,0xbeac7cd4,0xbef15aea,0xbf187fc0
.long 0xbf7cd925,0xbf687c12,0xbf42a9f7,0xbf0e39da,0xbf766377,0xbf58f3c4,0xbf2a0c73,0xbedae880
.long 0xbf6c835e,0xbf45e403,0xbf0e39da,0xbe94a031,0xbf5f5be6,0xbf2f9c32,0xbedf7108,0xbe164083
.long 0x3f800000,0x3f800000,0x3f800000,0x3f800000,0x3f7cd925,0x3f7c7160,0x3f7c0361,0x3f7b8f2a
.long 0x3f737871,0x3f71decf,0x3f702d4f,0x3f6e641a,0x3f641901,0x3f609384,0x3f5cdc29,0x3f58f3c4
.long 0xbf4f1bbd,0xbf641901,0xbf737871,0xbf7cd925,0xbf641901,0xbf743c41,0xbf7d95f4,0xbf7fe394
.long 0xbf737871,0xbf7d95f4,0xbf7fcd79,0xbf7a0d54,0xbf7cd925,0xbf7fe394,0xbf7a0d54,0xbf6b8a3d
.long 0x3f4f1bbd,0x3f490a88,0x3f42a9f7,0x3f3bfc8f,0x3f3504f3,0x3f2beb4a,0x3f226799,0x3f187fc0
.long 0x3f167918,0x3f0a04f8,0x3efa2c90,0x3edf7108,0x3ee87171,0x3ec8917e,0x3ea7bf25,0x3e862210
.long 0xbf800000,0xbf7b14be,0xbf6c835e,0xbf54db31,0xbf7cd925,0xbf6f4ba8,0xbf579b8c,0xbf36c9a9
.long 0xbf737871,0xbf5cdc29,0xbf3bfc8f,0xbf1260b2,0xbf641901,0xbf444969,0xbf1a82a4,0xbed1c759
.long 0x3e9e377a,0x3e6f0c4d,0x3e20305b,0x3da0af2a,0x3e20305b,0x3d8ca1f2,0xbca0d6d6,0xbddcbd0d
.long 0x248d3132,0xbdc8bd36,0xbe47c5c2,0xbe94a031,0xbe20305b,0xbe862210,0xbeba9be1,0xbeece91a
.long 0xbf4f1bbd,0xbf26423a,0xbee87171,0xbe6f0c4d,0xbf3504f3,0xbf039c3d,0xbe94a031,0xbd48fb30
.long 0xbf167918,0xbeba9be1,0xbdf0b772,0x3e0c4cf7,0xbee87171,0xbe519f65,0x3d712283,0x3ea2fd52
.long 0xbe9e377a,0xbed65a92,0xbf05c277,0xbf1e7cf1,0xbee87171,0xbf104f0e,0xbf2a0c73,0xbf4105b8
.long 0xbf167918,0xbf316e2c,0xbf490a88,0xbf5cdc29,0xbf3504f3,0xbf4d9f02,0xbf61c598,0xbf710908
.long 0xbe9e377a,0xbd20cee7,0x3e6f0c4d,0x3efa2c90,0xbe20305b,0x3e0255f4,0x3ecd2ef3,0x3f2456f1
.long 0xa553c9ca,0x3e94a031,0x3f0e39da,0x3f45e403,0x3e20305b,0x3ee3f40d,0x3f316e2c,0x3f609384
.long 0x0,0x0,0x0,0x0,0x0,0x0,0x0,0x0
.long 0x0,0x0,0x0,0x0,0x0,0x0,0x0,0x0
.long 0x80000000,0x80000000,0x80000000,0x80000000,0x80000000,0x80000000,0x80000000,0x80000000
.long 0x80000000,0x80000000,0x80000000,0x80000000,0x80000000,0x80000000,0x80000000,0x80000000
.long 0x0,0x0,0x0,0x0,0x0,0x0,0x0,0x0
.long 0x0,0x0,0x0,0x0,0x0,0x0,0x0,0x80000000
.long 0x80000000,0x80000000,0x80000000,0x80000000,0x80000000,0x80000000,0x80000000,0x0
.long 0x80000000,0x80000000,0x0,0x0,0x80000000,0x0,0x0,0x0
.long 0x0,0x80000000,0x80000000,0x80000000,0x80000000,0x80000000,0x80000000,0x80000000
.long 0x80000000,0x80000000,0x80000000,0x80000000,0x80000000,0x80000000,0x80000000,0x80000000
.long 0x80000000,0x0,0x0,0x0,0x0,0x0,0x0,0x0
.long 0x0,0x0,0x0,0x0,0x0,0x0,0x0,0x0
.long 0x80000000,0x80000000,0x80000000,0x80000000,0x80000000,0x80000000,0x80000000,0x80000000
.long 0x80000000,0x80000000,0x80000000,0x80000000,0x80000000,0x80000000,0x80000000,0x80000000
.long 0x0,0x0,0x0,0x0,0x0,0x0,0x0,0x0
.long 0x0,0x0,0x0,0x0,0x0,0x0,0x0,0x0
.long 0x80000000,0x80000000,0x80000000,0x80000000,0x80000000,0xbc20d8d2,0xbca0d6d6,0xbcf13d4c
.long 0x80000000,0xbca0d6d6,0xbd20cee7,0xbd712283,0x80000000,0xbcf13d4c,0xbd712283,0xbdb4b86a
.long 0x80000000,0xbe20305b,0xbe9e377a,0xbee87171,0x80000000,0xbe2a1c3f,0xbea7bf25,0xbef5c6c5
.long 0x80000000,0xbe3403f1,0xbeb13641,0xbf0172c3,0x80000000,0xbe3de731,0xbeba9be1,0xbf07e565
.long 0x80000000,0xbd20cee7,0xbda0af2a,0xbdf0b772,0x80000000,0xbd48fb30,0xbdc8bd36,0xbe164083
.long 0x80000000,0xbd712283,0xbdf0b772,0xbe3403f1,0x80000000,0xbd8ca1f2,0xbe0c4cf7,0xbe519f65
.long 0x80000000,0xbe47c5c2,0xbec3ef15,0xbf0e39da,0x80000000,0xbe519f65,0xbecd2ef3,0xbf146eba
.long 0x80000000,0xbe5b73dc,0xbed65a92,0xbf1a82a4,0x80000000,0xbe6542e9,0xbedf7108,0xbf207440
.long 0x80000000,0xbda0af2a,0xbe20305b,0xbe6f0c4d,0x80000000,0xbdb4b86a,0xbe3403f1,0xbe862210
.long 0x80000000,0xbdc8bd36,0xbe47c5c2,0xbe94a031,0x80000000,0xbddcbd0d,0xbe5b73dc,0xbea2fd52
.long 0x80000000,0xbe6f0c4d,0xbee87171,0xbf26423a,0x80000000,0xbe78cfcc,0xbef15aea,0xbf2beb4a
.long 0x80000000,0xbe814693,0xbefa2c90,0xbf316e2c,0x80000000,0xbe862210,0xbf0172c3,0xbf36c9a9
.long 0x80000000,0xbdf0b772,0xbe6f0c4d,0xbeb13641,0x80000000,0xbe0255f4,0xbe814693,0xbebf47d7
.long 0x80000000,0xbe0c4cf7,0xbe8afa3e,0xbecd2ef3,0x80000000,0xbe164083,0xbe94a031,0xbedae880
.long 0x80000000,0xbe8afa3e,0xbf05c277,0xbf3bfc8f,0x80000000,0xbe8fcefe,0xbf0a04f8,0xbf4105b8
.long 0x80000000,0xbe94a031,0xbf0e39da,0xbf45e403,0x80000000,0xbe996dba,0xbf1260b2,0xbf4a965e
.long 0x80000000,0x80000000,0x80000000,0x80000000,0xbd20cee7,0xbd48fb30,0xbd712283,0xbd8ca1f2
.long 0xbda0af2a,0xbdc8bd36,0xbdf0b772,0xbe0c4cf7,0xbdf0b772,0xbe164083,0xbe3403f1,0xbe519f65
.long 0xbf167918,0xbf3504f3,0xbf4f1bbd,0xbf641901,0xbf1e7cf1,0xbf3daef9,0xbf579b8c,0xbf6b8a3d
.long 0xbf26423a,0xbf45e403,0xbf5f5be6,0xbf71decf,0xbf2dc5e3,0xbf4d9f02,0xbf6655e7,0xbf770f11
.long 0xbe20305b,0xbe47c5c2,0xbe6f0c4d,0xbe8afa3e,0xbe47c5c2,0xbe78cfcc,0xbe94a031,0xbeac7cd4
.long 0xbe6f0c4d,0xbe94a031,0xbeb13641,0xbecd2ef3,0xbe8afa3e,0xbeac7cd4,0xbecd2ef3,0xbeece91a
.long 0xbf3504f3,0xbf54db31,0xbf6c835e,0xbf7b14be,0xbf3bfc8f,0xbf5b941a,0xbf71decf,0xbf7deafa
.long 0xbf42a9f7,0xbf61c598,0xbf766377,0xbf7f8e56,0xbf490a88,0xbf676bd8,0xbf7a0d54,0xbf7ffcd7
.long 0xbe9e377a,0xbec3ef15,0xbee87171,0xbf05c277,0xbeb13641,0xbedae880,0xbf0172c3,0xbf146eba
.long 0xbec3ef15,0xbef15aea,0xbf0e39da,0xbf226799,0xbed65a92,0xbf039c3d,0xbf1a82a4,0xbf2f9c32
.long 0xbf4f1bbd,0xbf6c835e,0xbf7cd925,0xbf7f35f9,0xbf54db31,0xbf710908,0xbf7ec46d,0xbf7d3aac
.long 0xbf5a46a0,0xbf74fa0b,0xbf7fcd79,0xbf7a0d54,0xbf5f5be6,0xbf7853f8,0xbf7ff35e,0xbf75b1c9
.long 0xbee87171,0xbf0e39da,0xbf26423a,0xbf3bfc8f,0xbefa2c90,0xbf187fc0,0xbf316e2c,0xbf4779bc
.long 0xbf05c277,0xbf226799,0xbf3bfc8f,0xbf5205d4,0xbf0e39da,0xbf2beb4a,0xbf45e403,0xbf5b941a
.long 0xbf641901,0xbf7b14be,0xbf7f35f9,0xbf702d4f,0xbf687c12,0xbf7d3aac,0xbf7d95f4,0xbf698690
.long 0xbf6c835e,0xbf7ec46d,0xbf7b14be,0xbf61c598,0xbf702d4f,0xbf7fb10f,0xbf77b493,0xbf58f3c4
.long 0x80000000,0x80000000,0x80000000,0x80000000,0xbda0af2a,0xbdb4b86a,0xbdc8bd36,0xbddcbd0d
.long 0xbe20305b,0xbe3403f1,0xbe47c5c2,0xbe5b73dc,0xbe6f0c4d,0xbe862210,0xbe94a031,0xbea2fd52
.long 0xbf737871,0xbf7cd925,0xbf800000,0xbf7cd925,0xbf78ed3c,0xbf7f654e,0xbf7ec46d,0xbf770f11
.long 0xbf7cd925,0xbf7ff35e,0xbf7b14be,0xbf6e641a,0xbf7f35f9,0xbf7e8238,0xbf74fa0b,0xbf62f219
.long 0xbe9e377a,0xbeb13641,0xbec3ef15,0xbed65a92,0xbec3ef15,0xbedae880,0xbef15aea,0xbf039c3d
.long 0xbee87171,0xbf0172c3,0xbf0e39da,0xbf1a82a4,0xbf05c277,0xbf146eba,0xbf226799,0xbf2f9c32
.long 0xbf800000,0xbf7b14be,0xbf6c835e,0xbf54db31,0xbf7f35f9,0xbf75b1c9,0xbf61c598,0xbf444969
.long 0xbf7cd925,0xbf6e641a,0xbf54db31,0xbf316e2c,0xbf78ed3c,0xbf653a48,0xbf45e403,0xbf1c81b9
.long 0xbf167918,0xbf26423a,0xbf3504f3,0xbf42a9f7,0xbf26423a,0xbf36c9a9,0xbf45e403,0xbf53731f
.long 0xbf3504f3,0xbf45e403,0xbf54db31,0xbf61c598,0xbf42a9f7,0xbf53731f,0xbf61c598,0xbf6d76aa
.long 0xbf737871,0xbf5a46a0,0xbf3504f3,0xbf05c277,0xbf6c835e,0xbf4d9f02,0xbf226799,0xbedae880
.long 0xbf641901,0xbf3f5cb5,0xbf0e39da,0xbea7bf25,0xbf5a46a0,0xbf2f9c32,0xbef15aea,0xbe6542e9
.long 0xbf4f1bbd,0xbf5f5be6,0xbf6c835e,0xbf766377,0xbf5a46a0,0xbf698690,0xbf74fa0b,0xbf7c7160
.long 0xbf641901,0xbf71decf,0xbf7b14be,0xbf7f8e56,0xbf6c835e,0xbf7853f8,0xbf7ec46d,0xbf7fb10f
.long 0xbf4f1bbd,0xbf1e7cf1,0xbec3ef15,0xbdf0b772,0xbf42a9f7,0xbf0c2124,0xbe94a031,0xbc20d8d2
.long 0xbf3504f3,0xbef15aea,0xbe47c5c2,0x3dc8bd36,0xbf26423a,0xbec8917e,0xbdc8bd36,0x3e519f65
.long 0x80000000,0x80000000,0x80000000,0x80000000,0xbdf0b772,0xbe0255f4,0xbe0c4cf7,0xbe164083
.long 0xbe6f0c4d,0xbe814693,0xbe8afa3e,0xbe94a031,0xbeb13641,0xbebf47d7,0xbecd2ef3,0xbedae880
.long 0xbf737871,0xbf641901,0xbf4f1bbd,0xbf3504f3,0xbf687c12,0xbf53731f,0xbf3889dc,0xbf187fc0
.long 0xbf5a46a0,0xbf3f5cb5,0xbf1e7cf1,0xbef15aea,0xbf490a88,0xbf28296a,0xbf0172c3,0xbeac7cd4
.long 0xbee87171,0xbefa2c90,0xbf05c277,0xbf0e39da,0xbf0e39da,0xbf187fc0,0xbf226799,0xbf2beb4a
.long 0xbf26423a,0xbf316e2c,0xbf3bfc8f,0xbf45e403,0xbf3bfc8f,0xbf4779bc,0xbf5205d4,0xbf5b941a
.long 0xbf3504f3,0xbf0e39da,0xbec3ef15,0xbe47c5c2,0xbf1e7cf1,0xbee3f40d,0xbe814693,0xbd48fb30
.long 0xbf05c277,0xbea7bf25,0xbdf0b772,0x3dc8bd36,0xbed65a92,0xbe519f65,0x3ca0d6d6,0x3e78cfcc
.long 0xbf4f1bbd,0xbf5a46a0,0xbf641901,0xbf6c835e,0xbf5f5be6,0xbf698690,0xbf71decf,0xbf7853f8
.long 0xbf6c835e,0xbf74fa0b,0xbf7b14be,0xbf7ec46d,0xbf766377,0xbf7c7160,0xbf7f8e56,0xbf7fb10f
.long 0xbe9e377a,0xbda0af2a,0x3e20305b,0x3ec3ef15,0xbe47c5c2,0x3d48fb30,0x3e94a031,0x3f039c3d
.long 0xbda0af2a,0x3e3403f1,0x3ed65a92,0x3f226799,0x3d20cee7,0x3e996dba,0x3f0a04f8,0x3f3daef9
.long 0xbf7cd925,0xbf7fcd79,0xbf7f35f9,0xbf7b14be,0xbf7fcd79,0xbf7f0059,0xbf7a0d54,0xbf710908
.long 0xbf7f35f9,0xbf7a0d54,0xbf702d4f,0xbf61c598,0xbf7b14be,0xbf710908,0xbf61c598,0xbf4d9f02
.long 0x3e20305b,0x3ed65a92,0x3f26423a,0x3f54db31,0x3e8afa3e,0x3f07e565,0x3f3f5cb5,0x3f676bd8
.long 0x3ec3ef15,0x3f226799,0x3f54db31,0x3f74fa0b,0x3efa2c90,0x3f3a4582,0x3f6655e7,0x3f7d3aac
.long 0x80000000,0x80000000,0x80000000,0x80000000,0xbe20305b,0xbe2a1c3f,0xbe3403f1,0xbe3de731
.long 0xbe9e377a,0xbea7bf25,0xbeb13641,0xbeba9be1,0xbee87171,0xbef5c6c5,0xbf0172c3,0xbf07e565
.long 0xbf167918,0xbee87171,0xbe9e377a,0xbe20305b,0xbee87171,0xbe996dba,0xbe0c4cf7,0x3cf13d4c
.long 0xbe9e377a,0xbe0c4cf7,0x3d20cee7,0x3e5b73dc,0xbe20305b,0x3cf13d4c,0x3e5b73dc,0x3ec8917e
.long 0xbf167918,0xbf1e7cf1,0xbf26423a,0xbf2dc5e3,0xbf3504f3,0xbf3daef9,0xbf45e403,0xbf4d9f02
.long 0xbf4f1bbd,0xbf579b8c,0xbf5f5be6,0xbf6655e7,0xbf641901,0xbf6b8a3d,0xbf71decf,0xbf770f11
.long 0xa50d3132,0x3e47c5c2,0x3ec3ef15,0x3f0e39da,0x3e20305b,0x3eb5eb4f,0x3f0a04f8,0x3f333bc6
.long 0x3e9e377a,0x3f0172c3,0x3f2dc5e3,0x3f5205d4,0x3ee87171,0x3f2456f1,0x3f4c1d35,0x3f698690
.long 0xbf737871,0xbf78ed3c,0xbf7cd925,0xbf7f35f9,0xbf7cd925,0xbf7f654e,0xbf7ff35e,0xbf7e8238
.long 0xbf800000,0xbf7ec46d,0xbf7b14be,0xbf74fa0b,0xbf7cd925,0xbf770f11,0xbf6e641a,0xbf62f219
.long 0x3f167918,0x3f42a9f7,0x3f641901,0x3f78ed3c,0x3f3504f3,0x3f5b941a,0x3f74fa0b,0x3f7fb10f
.long 0x3f4f1bbd,0x3f6e641a,0x3f7e39bc,0x3f7d95f4,0x3f641901,0x3f7a9421,0x3f7f8e56,0x3f72ae9e
.long 0xbf737871,0xbf687c12,0xbf5a46a0,0xbf490a88,0xbf641901,0xbf53731f,0xbf3f5cb5,0xbf28296a
.long 0xbf4f1bbd,0xbf3889dc,0xbf1e7cf1,0xbf0172c3,0xbf3504f3,0xbf187fc0,0xbef15aea,0xbeac7cd4
.long 0x3f737871,0x3f7fcd79,0x3f78ed3c,0x3f5f5be6,0x3f7cd925,0x3f7deafa,0x3f6a8b4b,0x3f444969
.long 0x3f800000,0x3f74fa0b,0x3f54db31,0x3f226799,0x3f7cd925,0x3f653a48,0x3f3889dc,0x3ef5c6c5
.long 0x80000000,0x80000000,0x80000000,0x80000000,0x80000000,0x80000000,0x80000000,0x80000000
.long 0x80000000,0x80000000,0x80000000,0x80000000,0x80000000,0x80000000,0x80000000,0x80000000
.long 0x80000000,0x0,0x0,0x0,0x0,0x0,0x0,0x0
.long 0x0,0x0,0x0,0x0,0x0,0x0,0x0,0x0
.long 0x80000000,0x80000000,0x80000000,0x80000000,0x80000000,0x80000000,0x80000000,0x80000000
.long 0x80000000,0x80000000,0x80000000,0x80000000,0x80000000,0x80000000,0x80000000,0x80000000
.long 0x0,0x0,0x0,0x0,0x0,0x0,0x0,0x0
.long 0x0,0x0,0x0,0x0,0x0,0x0,0x0,0x0
.long 0x80000000,0x80000000,0x80000000,0x80000000,0x80000000,0x80000000,0x80000000,0x80000000
.long 0x80000000,0x80000000,0x80000000,0x80000000,0x80000000,0x80000000,0x80000000,0x80000000
.long 0x0,0x0,0x0,0x0,0x0,0x0,0x0,0x0
.long 0x0,0x0,0x0,0x0,0x0,0x0,0x0,0x0
.long 0x80000000,0x80000000,0x80000000,0x80000000,0x80000000,0x80000000,0x80000000,0x80000000
.long 0x80000000,0x80000000,0x80000000,0x0,0x80000000,0x80000000,0x0,0x0
.long 0x0,0x0,0x0,0x80000000,0x0,0x0,0x0,0x80000000
.long 0x0,0x0,0x80000000,0x80000000,0x0,0x80000000,0x80000000,0x80000000
.long 0x3f803f80,0x3f803f80,0x0,0x0,0x3f733f80,0x3f163f4f,0x3e9e0000,0x3f4f3f16
.long 0x3f4f3f80,0xbe9e3e9e,0x3f160000,0x3f733f73,0x3f163f80,0xbf73be9e,0x3f4f0000,0x3e9e3f73
.long 0x3e9e3f80,0xbf4fbf4f,0x3f730000,0xbf163f16,0x248d3f80,0xa554bf80,0x3f800000,0xbf80250d
.long 0xbe9e3f80,0x3f4fbf4f,0x3f730000,0xbf16bf16,0xbf163f80,0x3f73be9e,0x3f4f0000,0x3e9ebf73
.long 0xbf4f3f80,0x3e9e3e9e,0x3f160000,0x3f73bf73,0xbf733f80,0xbf163f4f,0x3e9e0000,0x3f4fbf16
.long 0xbf803f80,0xbf803f80,0x250d0000,0x25d4a58d,0xbf733f80,0xbf163f4f,0xbe9e0000,0xbf4f3f16
.long 0xbf4f3f80,0x3e9e3e9e,0xbf160000,0xbf733f73,0xbf163f80,0x3f73be9e,0xbf4f0000,0xbe9e3f73
.long 0xbe9e3f80,0x3f4fbf4f,0xbf730000,0x3f163f16,0xa5543f80,0x261fbf80,0xbf800000,0x3f8025d4
.long 0x3e9e3f80,0xbf4fbf4f,0xbf730000,0x3f16bf16,0x3f163f80,0xbf73be9e,0xbf4f0000,0xbe9ebf73
.long 0x3f4f3f80,0xbe9e3e9e,0xbf160000,0xbf73bf73,0x3f733f80,0x3f163f4f,0xbe9e0000,0xbf4fbf16
.long 0x3f803f80,0x3f803f80,0x0,0x0,0x3f803f80,0x3f803f80,0x0,0x0
.long 0x3f803f80,0x3f803f80,0x0,0x0,0x3f803f80,0x3f803f80,0x0,0x0
.long 0x3f803f80,0x3f803f80,0x0,0x0,0x3f803f80,0x3f803f80,0x0,0x0
.long 0x3f803f80,0x3f803f80,0x0,0x0,0x3f803f80,0x3f803f80,0x0,0x0
.long 0x3f803f80,0x3f803f80,0x0,0x0,0x3f803f80,0x3f803f80,0x0,0x0
.long 0x3f803f80,0x3f803f80,0x0,0x0,0x3f803f80,0x3f803f80,0x0,0x0
.long 0x3f803f80,0x3f803f80,0x0,0x0,0x248d3e9e,0xbf16be9e,0x3f803f73,0x3f4f3f73
.long 0xbf80bf4f,0xbe9ebf4f,0x250d3f16,0xbf73bf16,0xa554bf4f,0x3f733f4f,0xbf80bf16,0x3e9ebf16
.long 0x3f803e9e,0xbf4f3e9e,0xa58dbf73,0x3f163f73,0x25b03f80,0xa5f7bf80,0x3f80a58d,0xbf8025d4
.long 0xbf803e9e,0x3f4f3e9e,0x25d43f73,0x3f16bf73,0xa5f7bf4f,0xbf733f4f,0xbf803f16,0x3e9e3f16
.long 0x3f80bf4f,0x3e9ebf4f,0xa60dbf16,0xbf733f16,0x261f3e9e,0x3f16be9e,0x3f80bf73,0x3f4fbf73
.long 0xbf803f80,0xbf803f80,0x2630a60d,0x2677a654,0x269f3e9e,0x3f16be9e,0xbf803f73,0xbf4f3f73
.long 0x3f80bf4f,0x3e9ebf4f,0xa6543f16,0x3f73bf16,0x2739bf4f,0xbf733f4f,0x3f80bf16,0xbe9ebf16
.long 0xbf803e9e,0x3f4f3e9e,0x2677bf73,0xbf163f73,0xa7423f80,0xa60dbf80,0xbf80a654,0x3f80269f
.long 0x3f803e9e,0xbf4f3e9e,0xa68d3f73,0xbf16bf73,0xa654bf4f,0x3f733f4f,0x3f803f16,0xbe9e3f16
.long 0xbf80bf4f,0xbe9ebf4f,0x269fbf16,0x3f733f16,0x26313e9e,0xbf16be9e,0xbf80bf73,0xbf4fbf73
.long 0x3f803f80,0x3f803f80,0x0,0x0,0x3f803f80,0x3f803f80,0x0,0x0
.long 0x3f803f80,0x3f803f80,0x0,0x0,0x3f803f80,0x3f803f80,0x0,0x0
.long 0x3f803f80,0x3f803f80,0x0,0x0,0x3f803f80,0x3f803f80,0x0,0x0
.long 0x3f803f80,0x3f803f80,0x0,0x0,0x3f803f80,0x3f803f80,0x0,0x0
.long 0x3f803f80,0x3f803f80,0x0,0x0,0x3f803f80,0x3f803f80,0x0,0x0
.long 0x3f803f80,0x3f803f80,0x0,0x0,0x3f803f80,0x3f803f80,0x0,0x0
.long 0x3f803f80,0x3f803f80,0x0,0x0,0xbf73bf4f,0xbf73bf80,0x3e9e3f16,0xbe9e250d
.long 0x3f4f3e9e,0x3f4f3f80,0xbf16bf73,0x3f16a58d,0xbf163e9e,0xbf16bf80,0x3f4f3f73,0xbf4f25d4
.long 0x3e9ebf4f,0x3e9e3f80,0xbf73bf16,0x3f73a60d,0x261f3f80,0xa731bf80,0x3f80a60d,0xbf802630
.long 0xbe9ebf4f,0xbe9e3f80,0xbf733f16,0x3f73a654,0x3f163e9e,0x3f16bf80,0x3f4fbf73,0xbf4f2677
.long 0xbf4f3e9e,0xbf4f3f80,0xbf163f73,0x3f16a68d,0x3f73bf4f,0x3f73bf80,0x3e9ebf16,0xbe9e269f
.long 0xbf803f80,0xbf803f80,0x269fa68d,0x27b1a6b0,0x3f73bf4f,0x3f73bf80,0xbe9e3f16,0x3e9ea71f
.long 0xbf4f3e9e,0xbf4f3f80,0x3f16bf73,0xbf16a6d4,0x3f163e9e,0x3f16bf80,0xbf4f3f73,0x3f4f27b9
.long 0xbe9ebf4f,0xbe9e3f80,0x3f73bf16,0xbf73a6f7,0xa7773f80,0x2804bf80,0xbf80a6d4,0x3f8027c2
.long 0x3e9ebf4f,0x3e9e3f80,0x3f733f16,0xbf73a70d,0xbf163e9e,0xbf16bf80,0xbf4fbf73,0x3f4fa6d4
.long 0x3f4f3e9e,0x3f4f3f80,0x3f163f73,0xbf16a71f,0xbf73bf4f,0xbf73bf80,0xbe9ebf16,0x3e9ea6b1
.long 0x3f803f80,0x3f803f80,0x0,0x0,0x3f803f80,0x3f803f80,0x0,0x0
.long 0x3f803f80,0x3f803f80,0x0,0x0,0x3f803f80,0x3f803f80,0x0,0x0
.long 0x3f803f80,0x3f803f80,0x0,0x0,0x3f803f80,0x3f803f80,0x0,0x0
.long 0x3f803f80,0x3f803f80,0x0,0x0,0x3f803f80,0x3f803f80,0x0,0x0
.long 0x3f803f80,0x3f803f80,0x0,0x0,0x3f803f80,0x3f803f80,0x0,0x0
.long 0x3f803f80,0x3f803f80,0x0,0x0,0x3f803f80,0x3f803f80,0x0,0x0
.long 0x3f803f80,0x3f803f80,0x0,0x0,0xbf16bf4f,0xa554be9e,0xbf4fbf16,0xbf80bf73
.long 0xbe9e3e9e,0xbf80bf4f,0x3f733f73,0x25d43f16,0x3f733e9e,0x27283f4f,0xbe9ebf73,0x3f803f16
.long 0xbf4fbf4f,0x3f803e9e,0xbf163f16,0xa654bf73,0xa68d3f80,0xa742bf80,0x3f80a654,0xbf802677
.long 0x3f4fbf4f,0xbf803e9e,0xbf16bf16,0x27a83f73,0xbf733e9e,0x27ee3f4f,0xbe9e3f73,0x3f80bf16
.long 0x3e9e3e9e,0x3f80bf4f,0x3f73bf73,0xa6d4bf16,0x3f16bf4f,0xa777be9e,0xbf4f3f16,0xbf803f73
.long 0xbf803f80,0xbf803f80,0xa70da6d4,0x27c2a6f7,0x3f16bf4f,0x2804be9e,0x3f4fbf16,0x3f80bf73
.long 0x3e9e3e9e,0x3f80bf4f,0xbf733f73,0xa8283f16,0xbf733e9e,0xa7963f4f,0x3e9ebf73,0xbf803f16
.long 0x3f4fbf4f,0xbf803e9e,0x3f163f16,0x286ebf73,0x27543f80,0x268dbf80,0xbf80a71f,0x3f80a68d
.long 0xbf4fbf4f,0x3f803e9e,0x3f16bf16,0xa7543f73,0x3f733e9e,0xa8ac3f4f,0x3e9e3f73,0xbf80bf16
.long 0xbe9e3e9e,0xbf80bf4f,0xbf73bf73,0x27f7bf16,0xbf16bf4f,0x281fbe9e,0x3f4f3f16,0x3f803f73
.long 0x3f803f80,0x3f803f80,0x0,0x0,0x3f803f80,0x3f803f80,0x0,0x0
.long 0x3f803f80,0x3f803f80,0x0,0x0,0x3f803f80,0x3f803f80,0x0,0x0
.long 0x3f803f80,0x3f803f80,0x0,0x0,0x3f803f80,0x3f803f80,0x0,0x0
.long 0x3f803f80,0x3f803f80,0x0,0x0,0x3f803f80,0x3f803f80,0x0,0x0
.long 0x3f803f80,0x3f803f80,0x0,0x0,0x3f803f80,0x3f803f80,0x0,0x0
.long 0x3f803f80,0x3f803f80,0x0,0x0,0x3f803f80,0x3f803f80,0x0,0x0
.long 0x3f803f80,0x3f803f80,0x0,0x0,0x3f163e9e,0x3f733f4f,0xbf4fbf73,0xbe9ebf16
.long 0xbe9ebf4f,0x3f4f3e9e,0xbf73bf16,0xbf16bf73,0xbf73bf4f,0x3f16be9e,0xbe9e3f16,0xbf4fbf73
.long 0xbf4f3e9e,0x3e9ebf4f,0x3f163f73,0xbf73bf16,0xa6543f80,0x2631bf80,0x3f80a68d,0xbf80269f
.long 0x3f4f3e9e,0xbe9ebf4f,0x3f16bf73,0xbf733f16,0x3f73bf4f,0xbf16be9e,0xbe9ebf16,0xbf4f3f73
.long 0x3e9ebf4f,0xbf4f3e9e,0xbf733f16,0xbf163f73,0xbf163e9e,0xbf733f4f,0xbf4f3f73,0xbe9e3f16
.long 0xbf803f80,0xbf803f80,0xa6d4a70d,0xa6b1a71f,0xbf163e9e,0xbf733f4f,0x3f4fbf73,0x3e9ebf16
.long 0x3e9ebf4f,0xbf4f3e9e,0x3f73bf16,0x3f16bf73,0x3f73bf4f,0xbf16be9e,0x3e9e3f16,0x3f4fbf73
.long 0x3f4f3e9e,0xbe9ebf4f,0xbf163f73,0x3f73bf16,0xa7b13f80,0x281fbf80,0xbf80a754,0x3f8027f7
.long 0xbf4f3e9e,0x3e9ebf4f,0xbf16bf73,0x3f733f16,0xbf73bf4f,0x3f16be9e,0x3e9ebf16,0x3f4f3f73
.long 0xbe9ebf4f,0x3f4f3e9e,0x3f733f16,0x3f163f73,0x3f163e9e,0x3f733f4f,0x3f4f3f73,0x3e9e3f16
.long 0x3f803f80,0x3f803f80,0x0,0x0,0x3f803f80,0x3f803f80,0x0,0x0
.long 0x3f803f80,0x3f803f80,0x0,0x0,0x3f803f80,0x3f803f80,0x0,0x0
.long 0x3f803f80,0x3f803f80,0x0,0x0,0x3f803f80,0x3f803f80,0x0,0x0
.long 0x3f803f80,0x3f803f80,0x0,0x0,0x3f803f80,0x3f803f80,0x0,0x0
.long 0x3f803f80,0x3f803f80,0x0,0x0,0x3f803f80,0x3f803f80,0x0,0x0
.long 0x3f803f80,0x3f803f80,0x0,0x0,0x3f803f80,0x3f803f80,0x0,0x0
.long 0x0,0x0,0x0,0x0,0x0,0x0,0x8000,0x0
.long 0x0,0x80000000,0x8000,0x0,0x0,0x80008000,0x8000,0x0
.long 0x0,0x80008000,0x8000,0x80000000,0x80000000,0x80008000,0x8000,0x80000000
.long 0x80000000,0x8000,0x8000,0x80008000,0x80000000,0x8000,0x8000,0x8000
.long 0x80000000,0x0,0x8000,0x8000,0x80000000,0x80000000,0x8000,0x8000
.long 0x80000000,0x80000000,0x80008000,0x8000,0x80000000,0x80000000,0x80000000,0x80000000
.long 0x80000000,0x0,0x80008000,0x80000000,0x80000000,0x8000,0x80008000,0x80000000
.long 0x80000000,0x8000,0x80008000,0x0,0x0,0x8000,0x80008000,0x0
.long 0x0,0x80008000,0x80008000,0x8000,0x0,0x80008000,0x80000000,0x80008000
.long 0x0,0x80000000,0x80008000,0x80008000,0x0,0x0,0x80000000,0x80008000
.long 0x0,0x0,0x0,0x0,0x0,0x0,0x0,0x0
.long 0x0,0x0,0x0,0x0,0x0,0x0,0x0,0x0
.long 0x0,0x0,0x0,0x0,0x0,0x0,0x0,0x0
.long 0x0,0x0,0x0,0x0,0x0,0x0,0x0,0x0
.long 0x0,0x0,0x0,0x0,0x0,0x0,0x0,0x0
.long 0x0,0x0,0x0,0x0,0x0,0x0,0x0,0x0
.long 0x0,0x0,0x0,0x0,0x3e480000,0x3f0e3ec4,0x3f553f35,0x3f7b3f6d
.long 0x3ec40000,0x3f6d3f35,0x3f6d3f80,0x3ec43f35,0x3f0e0000,0x3f7b3f6d,0x3e483f35,0xbf55bec4
.long 0x250d0000,0x25d4a58d,0x2630a60d,0x2677a654,0xbe480000,0xbf0e3ec4,0xbf553f35,0xbf7b3f6d
.long 0xbec40000,0xbf6d3f35,0xbf6d3f80,0xbec43f35,0xbf0e0000,0xbf7b3f6d,0xbe483f35,0x3f55bec4
.long 0x3f350000,0x3f353f80,0xbf35250d,0xbf35bf80,0x3f550000,0x3e483f6d,0xbf7bbf35,0x3f0ebec4
.long 0x3f6d0000,0xbec43f35,0xbec4bf80,0x3f6d3f35,0x3f7b0000,0xbf553ec4,0x3f0ebf35,0xbe483f6d
.long 0xbf350000,0xbf353f80,0x3f352630,0x3f35bf80,0xbf550000,0xbe483f6d,0x3f7bbf35,0xbf0ebec4
.long 0xbf6d0000,0x3ec43f35,0x3ec4bf80,0xbf6d3f35,0xbf7b0000,0x3f553ec4,0xbf0ebf35,0x3e483f6d
.long 0x3f800000,0xbf80250d,0x3f80a58d,0xbf8025d4,0x3f7b0000,0xbf55bec4,0x3f0e3f35,0xbe48bf6d
.long 0x3f6d0000,0xbec4bf35,0xbec43f80,0x3f6dbf35,0x3f550000,0x3e48bf6d,0xbf7b3f35,0x3f0e3ec4
.long 0xbf800000,0x3f8025d4,0xbf80a654,0x3f80269f,0xbf7b0000,0x3f55bec4,0xbf0e3f35,0x3e48bf6d
.long 0xbf6d0000,0x3ec4bf35,0x3ec43f80,0xbf6dbf35,0xbf550000,0xbe48bf6d,0x3f7b3f35,0xbf0e3ec4
.long 0x3f350000,0x3f35bf80,0xbf3525d4,0xbf353f80,0x3f0e0000,0x3f7bbf6d,0x3e48bf35,0xbf553ec4
.long 0x3ec40000,0x3f6dbf35,0x3f6dbf80,0x3ec4bf35,0x3e480000,0x3f0ebec4,0x3f55bf35,0x3f7bbf6d
.long 0xbf350000,0xbf35bf80,0x3f352677,0x3f353f80,0xbf0e0000,0xbf7bbf6d,0xbe48bf35,0x3f553ec4
.long 0xbec40000,0xbf6dbf35,0xbf6dbf80,0xbec4bf35,0xbe480000,0xbf0ebec4,0xbf55bf35,0xbf7bbf6d
.long 0x0,0x0,0x0,0x0,0x3f7b3f80,0x3f553f6d,0x3f0e3f35,0x3e483ec4
.long 0xbec4250d,0xbf6dbf35,0xbf6dbf80,0xbec4bf35,0xbf55bf80,0x3e48bec4,0x3f7b3f35,0x3f0e3f6d
.long 0x269fa68d,0x27b1a6b0,0xa70da6d4,0x27c2a6f7,0xbf7b3f80,0xbf553f6d,0xbf0e3f35,0xbe483ec4
.long 0x3ec4269f,0x3f6dbf35,0x3f6dbf80,0x3ec4bf35,0x3f55bf80,0xbe48bec4,0xbf7b3f35,0xbf0e3f6d
.long 0x3f35a58d,0x3f353f80,0xbf3525d4,0xbf35bf80,0x3f0e3f80,0xbf7bbec4,0x3e48bf35,0x3f553f6d
.long 0xbf6d25d4,0x3ec4bf35,0x3ec43f80,0xbf6dbf35,0xbe48bf80,0x3f0e3f6d,0xbf55bf35,0x3f7b3ec4
.long 0xbf35a6b0,0xbf353f80,0x3f3527c2,0x3f35bf80,0xbf0e3f80,0x3f7bbec4,0xbe48bf35,0xbf553f6d
.long 0x3f6d27b1,0xbec4bf35,0xbec43f80,0x3f6dbf35,0x3e48bf80,0xbf0e3f6d,0x3f55bf35,0xbf7b3ec4
.long 0x3f80a60d,0xbf802630,0x3f80a654,0xbf802677,0xbe483f80,0x3f0ebf6d,0xbf553f35,0x3f7bbec4
.long 0xbf6d2630,0x3ec43f35,0x3ec4bf80,0xbf6d3f35,0x3f0ebf80,0xbf7b3ec4,0x3e483f35,0x3f55bf6d
.long 0xbf80a6d4,0x3f8027c2,0xbf80a71f,0x3f80a68d,0x3e483f80,0xbf0ebf6d,0x3f553f35,0xbf7bbec4
.long 0x3f6da70d,0xbec43f35,0xbec4bf80,0x3f6d3f35,0xbf0ebf80,0x3f7b3ec4,0xbe483f35,0xbf55bf6d
.long 0x3f35a654,0x3f35bf80,0xbf35269f,0xbf353f80,0xbf553f80,0x3e483ec4,0x3f7bbf35,0x3f0ebf6d
.long 0xbec42677,0xbf6d3f35,0xbf6d3f80,0xbec43f35,0x3f7bbf80,0x3f55bf6d,0x3f0ebf35,0x3e48bec4
.long 0xbf35a6f7,0xbf35bf80,0x3f35a68d,0x3f353f80,0x3f553f80,0xbe483ec4,0xbf7bbf35,0xbf0ebf6d
.long 0x3ec427c2,0x3f6d3f35,0x3f6d3f80,0x3ec43f35,0xbf7bbf80,0xbf55bf6d,0xbf0ebf35,0xbe48bec4
.long 0x0,0x0,0x0,0x0,0xbe48250d,0xbf0ebec4,0xbf55bf35,0xbf7bbf6d
.long 0x3ec4a58d,0x3f6d3f35,0x3f6d3f80,0x3ec43f35,0xbf0e25d4,0xbf7bbf6d,0xbe48bf35,0x3f553ec4
.long 0xa6d4a70d,0x27d4a71f,0xa68da730,0x27e5a831,0x3e48a6d4,0x3f0ebec4,0x3f55bf35,0x3f7bbf6d
.long 0xbec4a71f,0xbf6d3f35,0xbf6d3f80,0xbec43f35,0x3f0e27d4,0x3f7bbf6d,0x3e48bf35,0xbf553ec4
.long 0x3f35a60d,0x3f353f80,0xbf352630,0xbf35bf80,0xbf552630,0xbe48bf6d,0x3f7b3f35,0xbf0e3ec4
.long 0x3f6da654,0xbec43f35,0xbec4bf80,0x3f6d3f35,0xbf7b2677,0x3f55bec4,0xbf0e3f35,0x3e48bf6d
.long 0xbf35a730,0xbf353f80,0x3f35a60e,0x3f35bf80,0x3f55a68d,0x3e48bf6d,0xbf7b3f35,0x3f0e3ec4
.long 0xbf6da831,0x3ec43f35,0x3ec4bf80,0xbf6d3f35,0x3f7b27e5,0xbf55bec4,0x3f0e3f35,0xbe48bf6d
.long 0x3f80a68d,0xbf80269f,0x3f80a6b0,0xbf8027b1,0xbf7b269f,0x3f553ec4,0xbf0ebf35,0x3e483f6d
.long 0x3f6da6b0,0xbec4bf35,0xbec43f80,0x3f6dbf35,0xbf5527b1,0xbe483f6d,0x3f7bbf35,0xbf0ebec4
.long 0xbf80a754,0x3f8027f7,0xbf80a842,0x3f802884,0x3f7ba60e,0xbf553ec4,0x3f0ebf35,0xbe483f6d
.long 0xbf6d278d,0x3ec4bf35,0x3ec43f80,0xbf6dbf35,0x3f5527f7,0x3e483f6d,0xbf7bbf35,0x3f0ebec4
.long 0x3f35a6d4,0x3f35bf80,0xbf3527c2,0xbf353f80,0xbf0ea70d,0xbf7b3f6d,0xbe483f35,0x3f55bec4
.long 0x3ec4a6f7,0x3f6dbf35,0x3f6dbf80,0x3ec4bf35,0xbe4827c2,0xbf0e3ec4,0xbf553f35,0xbf7b3f6d
.long 0xbf35a777,0xbf35bf80,0x3f35280d,0x3f353f80,0x3f0ea1b7,0x3f7b3f6d,0x3e483f35,0xbf55bec4
.long 0xbec4a842,0xbf6dbf35,0xbf6dbf80,0xbec4bf35,0x3e482804,0x3f0e3ec4,0x3f553f35,0x3f7b3f6d
.long 0x0,0x0,0x0,0x0,0xbf7bbf80,0xbf55bf6d,0xbf0ebf35,0xbe48bec4
.long 0xbec425d4,0xbf6dbf35,0xbf6dbf80,0xbec4bf35,0x3f553f80,0xbe483ec4,0xbf7bbf35,0xbf0ebf6d
.long 0xa60ea754,0x27f7278d,0xa1b7a777,0x2804a842,0x3f7bbf80,0x3f55bf6d,0x3f0ebf35,0x3e48bec4
.long 0x3ec427f7,0x3f6dbf35,0x3f6dbf80,0x3ec4bf35,0xbf553f80,0x3e483ec4,0x3f7bbf35,0x3f0ebf6d
.long 0x3f35a654,0x3f353f80,0xbf352677,0xbf35bf80,0xbf0ebf80,0x3f7b3ec4,0xbe483f35,0xbf55bf6d
.long 0xbf6d269f,0x3ec4bf35,0x3ec43f80,0xbf6dbf35,0x3e483f80,0xbf0ebf6d,0x3f553f35,0xbf7bbec4
.long 0xbf35a842,0xbf353f80,0x3f35280d,0x3f35bf80,0x3f0ebf80,0xbf7b3ec4,0x3e483f35,0x3f55bf6d
.long 0x3f6d260d,0xbec4bf35,0xbec43f80,0x3f6dbf35,0xbe483f80,0x3f0ebf6d,0xbf553f35,0x3f7bbec4
.long 0x3f80a6d4,0xbf80a70d,0x3f80a6f7,0xbf8027c2,0x3e48bf80,0xbf0e3f6d,0x3f55bf35,0xbf7b3ec4
.long 0xbf6d27c2,0x3ec43f35,0x3ec4bf80,0xbf6d3f35,0xbf0e3f80,0x3f7bbec4,0xbe48bf35,0xbf553f6d
.long 0xbf80a79f,0x3f80a7d4,0xbf80270d,0x3f802909,0xbe48bf80,0x3f0e3f6d,0xbf55bf35,0x3f7b3ec4
.long 0x3f6d2816,0xbec43f35,0xbec4bf80,0x3f6d3f35,0x3f0e3f80,0xbf7bbec4,0x3e48bf35,0x3f553f6d
.long 0x3f35a71f,0x3f35bf80,0xbf35a68d,0xbf353f80,0x3f55bf80,0xbe48bec4,0xbf7b3f35,0xbf0e3f6d
.long 0xbec4a68d,0xbf6d3f35,0xbf6d3f80,0xbec43f35,0xbf7b3f80,0xbf553f6d,0xbf0e3f35,0xbe483ec4
.long 0xbf35270d,0xbf35bf80,0x3f352896,0x3f353f80,0xbf55bf80,0x3e48bec4,0x3f7b3f35,0x3f0e3f6d
.long 0x3ec4270d,0x3f6d3f35,0x3f6d3f80,0x3ec43f35,0x3f7b3f80,0x3f553f6d,0x3f0e3f35,0x3e483ec4
.size tab_hid, 15360
L_tabend:
.section .rodata,"a"
.p2align 6
.amdhsa_kernel concat_heads__spectral_fnet__grouped_kv_mqa__prompt_kernel
  .amdhsa_next_free_vgpr 256
  .amdhsa_next_free_sgpr 102
  .amdhsa_accum_offset 256
  .amdhsa_group_segment_fixed_size 0
  .amdhsa_kernarg_size 104
  .amdhsa_user_sgpr_count 2
  .amdhsa_user_sgpr_kernarg_segment_ptr 1
  .amdhsa_system_sgpr_workgroup_id_x 1
.end_amdhsa_kernel
```
